```python
import torch

def _softmax(x, axis=-1):
    return torch.softmax(x, dim=axis)

def _gelu(x):
    return torch.nn.functional.gelu(x, approximate='tanh')

def _silu(x):
    return torch.nn.functional.silu(x)

def _sigmoid(x):
    return torch.sigmoid(x)

def _layernorm(x, axis=-1, eps=1e-05):
    m = x.mean(dim=axis, keepdim=True)
    v = x.var(dim=axis, keepdim=True, unbiased=False)
    return (x - m) / torch.sqrt(v + eps)

def _scatter_add(tgt, idx, src, axis=0):
    return tgt.clone().index_add_(axis, idx, src)

def _segment_sum(src, seg, n):
    out = torch.zeros((n,) + src.shape[1:], dtype=src.dtype)
    return out.index_add_(0, seg, src)

def _pad(x, pw):
    flat = tuple((v for pair in reversed(pw) for v in pair))
    return torch.nn.functional.pad(x, flat)
kernel_name = 'interleave_layers__spectral_gfnet__memory_aug_recurrent_mem_tr__prompt'

def setup_inputs():

    _w = lambda a: (lambda t: t.to(torch.bfloat16) if t.is_floating_point() else t)(torch.as_tensor(a))

    def _A_setup():
        B, S, D = (1, 2048, 448)
        Df = D // 2 + 1
        return {'x': _w((lambda *s: torch.randn(*s, dtype=torch.bfloat16) * 0.05)(B, S, D)), 'w_r': _w((lambda *s: torch.randn(*s, dtype=torch.bfloat16) * 0.4)(S, Df) * 0.02), 'w_i': _w((lambda *s: torch.randn(*s, dtype=torch.bfloat16) * 0.4)(S, Df) * 0.02)}
    _A_in = _A_setup()

    def _B_setup():
        B, S, Dm = (1, 2048, 448)
        H, Dh = (16, 256)
        M, seg = (8, 32)
        seg = min(seg, S)
        S = S // seg * seg
        return {'x': _w((lambda *s: torch.randn(*s, dtype=torch.bfloat16) * 0.05)(B, S, Dm)), 'mem0': _w((lambda *s: torch.randn(*s, dtype=torch.bfloat16) * 0.2)(B, M, Dm)), 'Wq': _w((lambda *s: torch.randn(*s, dtype=torch.bfloat16) * 1.6)(Dm, H, Dh) * Dm ** (-0.5)), 'Wk': _w((lambda *s: torch.randn(*s, dtype=torch.bfloat16) * 1.6)(Dm, H, Dh) * Dm ** (-0.5)), 'Wv': _w((lambda *s: torch.randn(*s, dtype=torch.bfloat16) * 0.2)(Dm, H, Dh) * Dm ** (-0.5)), 'Wo': _w((lambda *s: torch.randn(*s, dtype=torch.bfloat16) * 0.2)(H, Dh, Dm) * (H * Dh) ** (-0.5)), 'seg_len': seg}
    _B_in = _B_setup()
    return {'A_x': _A_in['x'], 'A_w_r': _A_in['w_r'], 'A_w_i': _A_in['w_i'], 'B_x': _B_in['x'], 'B_mem0': _B_in['mem0'], 'B_Wq': _B_in['Wq'], 'B_Wk': _B_in['Wk'], 'B_Wv': _B_in['Wv'], 'B_Wo': _B_in['Wo'], 'B_seg_len': _B_in['seg_len']}

def reference(A_x, A_w_r, A_w_i, B_x, B_mem0, B_Wq, B_Wk, B_Wv, B_Wo, B_seg_len):

    def _A_ref(x, w_r, w_i):
        B, S, D = x.shape
        X = (lambda x, axes=(-2, -1): torch.fft.rfft2(x.float(), dim=axes))(x, axes=(-2, -1))
        W = w_r + 1j * w_i
        X = X * W
        y = (lambda x, s, axes=(-2, -1): torch.fft.irfft2(x, s=s, dim=axes).to(torch.bfloat16))(X, (S, D), axes=(-2, -1))
        return y

    def _B_ref(x, mem0, Wq, Wk, Wv, Wo, seg_len):
        B, S, Dm = x.shape
        H, Dh = (Wq.shape[1], Wq.shape[2])
        M = mem0.shape[1]
        scale = Dh ** (-0.5)
        n_seg = S // seg_len
        L = M + seg_len
        idx = torch.arange(L)
        mask = (idx[:, None] < M) | (idx[:, None] >= idx[None, :])
        mem = mem0
        outs = []
        for s in range(n_seg):
            xs = x[:, s * seg_len:(s + 1) * seg_len, :].clone()
            h = torch.concatenate([mem, xs], axis=1)
            q = torch.einsum('btd,dhe->bhte', h, Wq)
            k = torch.einsum('btd,dhe->bhte', h, Wk)
            v = torch.einsum('btd,dhe->bhte', h, Wv)
            scores = torch.einsum('bhqe,bhke->bhqk', q, k) * scale
            scores = torch.where(mask[None, None], scores, -1000000000.0)
            p = _softmax(scores, axis=-1)
            o = torch.einsum('bhqk,bhke->bhqe', p, v)
            o = torch.einsum('bhte,hed->btd', o, Wo)
            mem = o[:, :M, :].clone()
            outs.append(o[:, M:, :])
        return torch.concatenate(outs, axis=1)
    x = A_x
    x = x + _A_ref(_layernorm(x, axis=-1), A_w_r, A_w_i)
    x = x + _B_ref(_layernorm(x, axis=-1), B_mem0, B_Wq, B_Wk, B_Wv, B_Wo, B_seg_len)
    x = x + _A_ref(_layernorm(x, axis=-1), A_w_r, A_w_i)
    x = x + _B_ref(_layernorm(x, axis=-1), B_mem0, B_Wq, B_Wk, B_Wv, B_Wo, B_seg_len)
    return x
```

```asm
; @launch grid=(256,1,1) block=(256,1,1) lds=98304
.amdgcn_target "amdgcn-amd-amdhsa--gfx950"
.text
.globl interleave_layers__spectral_gfnet__memory_aug_recurrent_mem_tr__prompt_kernel
.p2align 8
.type interleave_layers__spectral_gfnet__memory_aug_recurrent_mem_tr__prompt_kernel,@function
interleave_layers__spectral_gfnet__memory_aug_recurrent_mem_tr__prompt_kernel:
    s_cmp_lt_u32 s2, 256
    s_cbranch_scc1 K_go
    s_endpgm
K_go:
    s_load_dwordx2 s[68:69], s[0:1], 96
    s_load_dwordx2 s[70:71], s[0:1], 88
    s_load_dwordx2 s[72:73], s[0:1], 80
    s_load_dwordx2 s[74:75], s[0:1], 0
    s_getreg_b32 s66, hwreg(HW_REG_XCC_ID, 0, 4)
    v_accvgpr_write_b32 a255, v0
    v_lshrrev_b32 v1, 6, v0
    s_nop 0
    v_readfirstlane_b32 s76, v1
    s_mov_b32 s65, 0
    s_waitcnt lgkmcnt(0)
    s_mov_b32 s56, s68
    s_and_b32 s57, s69, 0xffff
    s_mov_b32 s58, 268435456
    s_mov_b32 s59, 0x20000
    s_mov_b32 s8, s70
    s_and_b32 s9, s71, 0xffff
    s_mov_b32 s10, 256
    s_mov_b32 s11, 0x20000
    s_mul_i32 s53, s65, 79691776
    s_add_u32 s53, s53, 30408704
    s_add_u32 s4, s68, s53
    s_addc_u32 s5, s69, 0
    s_and_b32 s5, s5, 0xffff
    s_mov_b32 s6, 79691776
    s_mov_b32 s7, 0x20000
    s_and_b32 s66, s66, 7
    s_cmp_eq_u32 s76, 0
    s_cbranch_scc0 K_norole
    v_mov_b32 v1, 1
    s_and_b32 s37, s66, 3
    s_lshl_b32 s37, s37, 2
    s_lshr_b32 s38, s66, 2
    s_lshl_b32 s38, s38, 7
    s_add_u32 s37, s37, s38
    v_mov_b32 v2, s37
    s_mov_b64 exec, 1
    buffer_atomic_add v1, v2, s[8:11], 0 offen sc0
    s_waitcnt vmcnt(0)
    v_mov_b32 v2, 0
    ds_write_b32 v2, v1
    s_waitcnt lgkmcnt(0)
    s_mov_b64 exec, -1
K_norole:
    s_barrier
    v_mov_b32 v2, 0
    ds_read_b32 v1, v2
    s_waitcnt lgkmcnt(0)
    v_readfirstlane_b32 s67, v1
    s_barrier
    s_cmp_lt_u32 s67, 32
    s_cbranch_scc1 K_tick
    s_endpgm
K_tick:
    s_cmp_eq_u32 s66, 0
    s_cbranch_scc0 K_bulk
    v_accvgpr_read_b32 v0, a255
    s_lshl_b32 s3, s67, 8
    v_add_u32 v1, s3, v0
    v_lshlrev_b32 v38, 4, v1
    v_mov_b32 v4, -1
    v_mov_b32 v5, -1
    v_mov_b32 v6, -1
    v_mov_b32 v7, -1
    v_mov_b32 v8, 0
    v_mov_b32 v9, 0
    v_mov_b32 v10, 0
    v_mov_b32 v11, 0
    v_add_u32 v2, 0, v38
    v_mov_b32 v36, 180224
    v_cmp_gt_u32 vcc, v36, v2
    v_mov_b32 v37, 0x7fffffff
    s_nop 0
    v_cndmask_b32 v2, v37, v2, vcc
    s_mov_b32 s31, 108892160
    buffer_store_dwordx4 v[8:11], v2, s[56:59], s31 offen sc1
    v_add_u32 v2, 131072, v38
    v_mov_b32 v36, 180224
    v_cmp_gt_u32 vcc, v36, v2
    v_mov_b32 v37, 0x7fffffff
    s_nop 0
    v_cndmask_b32 v2, v37, v2, vcc
    s_mov_b32 s31, 108892160
    buffer_store_dwordx4 v[8:11], v2, s[56:59], s31 offen sc1
    v_add_u32 v2, 0, v38
    v_mov_b32 v36, 180224
    v_cmp_gt_u32 vcc, v36, v2
    v_mov_b32 v37, 0x7fffffff
    s_nop 0
    v_cndmask_b32 v2, v37, v2, vcc
    s_mov_b32 s31, 188583936
    buffer_store_dwordx4 v[8:11], v2, s[56:59], s31 offen sc1
    v_add_u32 v2, 131072, v38
    v_mov_b32 v36, 180224
    v_cmp_gt_u32 vcc, v36, v2
    v_mov_b32 v37, 0x7fffffff
    s_nop 0
    v_cndmask_b32 v2, v37, v2, vcc
    s_mov_b32 s31, 188583936
    buffer_store_dwordx4 v[8:11], v2, s[56:59], s31 offen sc1
    s_waitcnt vmcnt(0)
    s_barrier
    s_cmp_eq_u32 s76, 0
    s_cbranch_scc0 X0_noadd
    s_mov_b64 exec, 1
    v_mov_b32 v1, 1
    v_mov_b32 v2, 64
    buffer_atomic_add v1, v2, s[8:11], 0 offen sc1
    s_mov_b64 exec, -1
X0_noadd:
    s_mul_i32 s55, s67, 7
    s_add_u32 s55, s55, 3
    s_add_u32 s51, s67, 96
    s_mov_b32 s77, 1
    s_branch K_prep
X0_back:
    s_mov_b32 s13, s67
    s_mov_b32 s14, s76
    s_cmp_ge_u32 s13, 30
    s_cbranch_scc1 C_rolePF
    s_cmp_ge_u32 s13, 16
    s_cbranch_scc1 C_roleB
    v_accvgpr_read_b32 v0, a255
    v_and_b32 v118, 63, v0
    v_and_b32 v72, 2, v118
    v_cmp_ne_u32 vcc, 0, v72
    v_mov_b32 v1, 0x4444
    v_mov_b32 v72, 0xeeee
    v_cndmask_b32 v1, v1, v72, vcc
    v_and_b32 v72, 8, v118
    v_cmp_ne_u32 vcc, 0, v72
    s_nop 0
    s_mov_b64 s[32:33], vcc
    v_lshlrev_b32 v104, 4, v118
    v_bfe_u32 v72, v118, 3, 2
    v_lshlrev_b32 v105, 8, v72
    v_bfe_u32 v72, v118, 1, 2
    v_lshl_add_u32 v105, v72, 6, v105
    v_lshrrev_b32 v72, 5, v118
    v_lshl_add_u32 v105, v72, 5, v105
    v_and_b32 v72, 1, v118
    v_lshl_add_u32 v105, v72, 4, v105
    v_add_u32 v105, 0, v105
    v_lshlrev_b32 v106, 4, v118
    v_add_u32 v106, 0, v106
    v_bfe_u32 v72, v118, 2, 2
    v_lshlrev_b32 v107, 6, v72
    v_and_b32 v72, 1, v118
    v_lshl_add_u32 v107, v72, 5, v107
    v_lshrrev_b32 v72, 4, v118
    v_lshl_add_u32 v107, v72, 3, v107
    v_bfe_u32 v72, v118, 1, 1
    v_lshl_add_u32 v107, v72, 2, v107
    s_mul_i32 s18, s14, 384
    s_add_u32 s18, s18, 8192
    v_add_u32 v107, s18, v107
    v_lshrrev_b32 v72, 4, v118
    v_mul_u32_u24 v108, 384, v72
    v_bfe_u32 v72, v118, 3, 1
    v_lshl_add_u32 v108, v72, 6, v108
    v_bfe_u32 v72, v118, 2, 1
    v_lshl_add_u32 v108, v72, 5, v108
    v_and_b32 v72, 3, v118
    v_lshl_add_u32 v108, v72, 3, v108
    v_add_u32 v108, 8192, v108
    v_lshrrev_b32 v72, 4, v118
    v_lshlrev_b32 v110, 8, v72
    v_bfe_u32 v72, v118, 1, 2
    v_lshl_add_u32 v110, v72, 6, v110
    v_and_b32 v72, 1, v118
    v_lshl_add_u32 v110, v72, 4, v110
    v_add_u32 v110, 0, v110
    v_lshrrev_b32 v72, 4, v118
    v_lshlrev_b32 v109, 8, v72
    v_bfe_u32 v72, v118, 1, 2
    v_lshl_add_u32 v109, v72, 6, v109
    v_bfe_u32 v72, v118, 3, 1
    v_lshl_add_u32 v109, v72, 5, v109
    v_and_b32 v72, 1, v118
    v_lshl_add_u32 v109, v72, 4, v109
    s_sub_u32 s18, s14, 1
    s_and_b32 s18, s18, 1
    s_mul_i32 s18, s18, 14336
    v_add_u32 v109, s18, v109
    v_lshlrev_b32 v113, 3, v118
    v_add_u32 v113, 19456, v113
    v_lshrrev_b32 v72, 4, v118
    v_bfe_u32 v73, v118, 2, 2
    v_lshlrev_b32 v111, 8, v73
    v_lshl_add_u32 v111, v72, 6, v111
    v_and_b32 v73, 3, v118
    v_lshl_add_u32 v111, v73, 2, v111
    s_and_b32 s18, s13, 1
    s_lshl_b32 s19, s18, 5
    v_add_u32 v111, s19, v111
    v_bfe_u32 v73, v118, 1, 2
    v_lshlrev_b32 v112, 6, v73
    v_lshl_add_u32 v112, v72, 4, v112
    s_lshl_b32 s19, s18, 3
    v_add_u32 v112, s19, v112
    s_bfe_u32 s18, s13, 0x10001
    s_mul_i32 s18, s18, -768
    s_add_u32 s18, s18, 2048
    v_add_u32 v112, s18, v112
    v_and_b32 v73, 9, v118
    v_cmp_ne_u32 vcc, 0, v73
    v_mov_b32 v74, 0x7fffffff
    s_nop 0
    v_cndmask_b32 v112, v112, v74, vcc
    v_min_u32 v117, 55, v118
    v_lshlrev_b32 v117, 7, v117
    s_lshl_b32 s18, s13, 2
    s_add_u32 s18, s18, s14
    s_mul_i32 s18, s18, 100352
    s_add_u32 s18, s18, 0
    s_cmp_eq_u32 s76, 0
    s_cbranch_scc0 A_wprep0_ok
    v_mbcnt_lo_u32_b32 v72, -1, 0
    v_mbcnt_hi_u32_b32 v72, -1, v72
    v_add_u32 v73, 0, v72
    v_min_u32 v73, 127, v73
    v_lshlrev_b32 v73, 4, v73
    v_add_u32 v74, 64, v72
    v_min_u32 v74, 127, v74
    v_lshlrev_b32 v74, 4, v74
    s_mov_b32 s53, 78622720
    s_mov_b32 s54, 1048576
A_wprep0:
    buffer_load_dword v75, v73, s[4:7], s53 offen sc1
    buffer_load_dword v76, v74, s[4:7], s53 offen sc1
    s_mov_b32 s90, 1
    s_sub_u32 s54, s54, 1
    s_cmp_eq_u32 s54, 0
    s_cbranch_scc1 L_abort0
    s_waitcnt vmcnt(0)
    v_and_b32 v75, v75, v76
    v_cmp_ne_u32 vcc, 1, v75
    s_cbranch_vccz A_wprep0_ok
    s_sleep 8
    s_branch A_wprep0
A_wprep0_ok:
    s_barrier
    s_add_u32 s19, s18, 0
    buffer_load_dwordx4 a[0:3], v104, s[56:59], s19 offen sc1
    buffer_load_dwordx4 a[4:7], v104, s[56:59], s19 offen offset:1024 sc1
    s_add_u32 s19, s18, 2048
    buffer_load_dwordx4 a[8:11], v104, s[56:59], s19 offen sc1
    buffer_load_dwordx4 a[12:15], v104, s[56:59], s19 offen offset:1024 sc1
    s_add_u32 s19, s18, 4096
    buffer_load_dwordx4 a[16:19], v104, s[56:59], s19 offen sc1
    buffer_load_dwordx4 a[20:23], v104, s[56:59], s19 offen offset:1024 sc1
    s_add_u32 s19, s18, 6144
    buffer_load_dwordx4 a[24:27], v104, s[56:59], s19 offen sc1
    buffer_load_dwordx4 a[28:31], v104, s[56:59], s19 offen offset:1024 sc1
    s_add_u32 s19, s18, 14336
    buffer_load_dwordx4 a[56:59], v104, s[56:59], s19 offen sc1
    buffer_load_dwordx4 a[60:63], v104, s[56:59], s19 offen offset:1024 sc1
    s_add_u32 s19, s18, 16384
    buffer_load_dwordx4 a[64:67], v104, s[56:59], s19 offen sc1
    buffer_load_dwordx4 a[68:71], v104, s[56:59], s19 offen offset:1024 sc1
    s_add_u32 s19, s18, 18432
    buffer_load_dwordx4 a[72:75], v104, s[56:59], s19 offen sc1
    buffer_load_dwordx4 a[76:79], v104, s[56:59], s19 offen offset:1024 sc1
    s_add_u32 s19, s18, 20480
    buffer_load_dwordx4 a[80:83], v104, s[56:59], s19 offen sc1
    buffer_load_dwordx4 a[84:87], v104, s[56:59], s19 offen offset:1024 sc1
    s_add_u32 s19, s18, 28672
    buffer_load_dwordx4 a[112:115], v104, s[56:59], s19 offen sc1
    buffer_load_dwordx4 a[116:119], v104, s[56:59], s19 offen offset:1024 sc1
    s_add_u32 s19, s18, 30720
    buffer_load_dwordx4 a[120:123], v104, s[56:59], s19 offen sc1
    buffer_load_dwordx4 a[124:127], v104, s[56:59], s19 offen offset:1024 sc1
    s_add_u32 s19, s18, 32768
    buffer_load_dwordx4 a[128:131], v104, s[56:59], s19 offen sc1
    buffer_load_dwordx4 a[132:135], v104, s[56:59], s19 offen offset:1024 sc1
    s_add_u32 s19, s18, 34816
    buffer_load_dwordx4 a[136:139], v104, s[56:59], s19 offen sc1
    buffer_load_dwordx4 a[140:143], v104, s[56:59], s19 offen offset:1024 sc1
    s_add_u32 s19, s18, 43008
    buffer_load_dwordx4 a[168:171], v104, s[56:59], s19 offen sc1
    buffer_load_dwordx4 a[172:175], v104, s[56:59], s19 offen offset:1024 sc1
    s_add_u32 s19, s18, 45056
    buffer_load_dwordx4 a[176:179], v104, s[56:59], s19 offen sc1
    buffer_load_dwordx4 a[180:183], v104, s[56:59], s19 offen offset:1024 sc1
    s_add_u32 s19, s18, 47104
    buffer_load_dwordx4 a[184:187], v104, s[56:59], s19 offen sc1
    buffer_load_dwordx4 a[188:191], v104, s[56:59], s19 offen offset:1024 sc1
    s_add_u32 s19, s18, 49152
    buffer_load_dwordx4 a[192:195], v104, s[56:59], s19 offen sc1
    buffer_load_dwordx4 a[196:199], v104, s[56:59], s19 offen offset:1024 sc1
    s_waitcnt vmcnt(32)
    s_add_u32 s19, s18, 57344
    buffer_load_dwordx4 a[224:227], v104, s[56:59], s19 offen sc1
    buffer_load_dwordx4 a[228:231], v104, s[56:59], s19 offen offset:1024 sc1
    s_add_u32 s19, s18, 59392
    buffer_load_dwordx4 a[232:235], v104, s[56:59], s19 offen sc1
    buffer_load_dwordx4 a[236:239], v104, s[56:59], s19 offen offset:1024 sc1
    s_add_u32 s19, s18, 61440
    buffer_load_dwordx4 a[240:243], v104, s[56:59], s19 offen sc1
    buffer_load_dwordx4 a[244:247], v104, s[56:59], s19 offen offset:1024 sc1
    s_add_u32 s19, s18, 63488
    buffer_load_dwordx4 a[248:251], v104, s[56:59], s19 offen sc1
    buffer_load_dwordx4 a[252:255], v104, s[56:59], s19 offen offset:1024 sc1
    s_add_u32 s19, s18, 71680
    buffer_load_dwordx4 v[144:147], v104, s[56:59], s19 offen sc1
    buffer_load_dwordx4 v[148:151], v104, s[56:59], s19 offen offset:1024 sc1
    s_add_u32 s19, s18, 73728
    buffer_load_dwordx4 v[152:155], v104, s[56:59], s19 offen sc1
    buffer_load_dwordx4 v[156:159], v104, s[56:59], s19 offen offset:1024 sc1
    s_add_u32 s19, s18, 75776
    buffer_load_dwordx4 v[160:163], v104, s[56:59], s19 offen sc1
    buffer_load_dwordx4 v[164:167], v104, s[56:59], s19 offen offset:1024 sc1
    s_add_u32 s19, s18, 77824
    buffer_load_dwordx4 v[168:171], v104, s[56:59], s19 offen sc1
    buffer_load_dwordx4 v[172:175], v104, s[56:59], s19 offen offset:1024 sc1
    s_add_u32 s19, s18, 86016
    buffer_load_dwordx4 v[200:203], v104, s[56:59], s19 offen sc1
    buffer_load_dwordx4 v[204:207], v104, s[56:59], s19 offen offset:1024 sc1
    s_add_u32 s19, s18, 88064
    buffer_load_dwordx4 v[208:211], v104, s[56:59], s19 offen sc1
    buffer_load_dwordx4 v[212:215], v104, s[56:59], s19 offen offset:1024 sc1
    s_add_u32 s19, s18, 90112
    buffer_load_dwordx4 v[216:219], v104, s[56:59], s19 offen sc1
    buffer_load_dwordx4 v[220:223], v104, s[56:59], s19 offen offset:1024 sc1
    s_add_u32 s19, s18, 92160
    buffer_load_dwordx4 v[224:227], v104, s[56:59], s19 offen sc1
    buffer_load_dwordx4 v[228:231], v104, s[56:59], s19 offen offset:1024 sc1
    s_cmp_eq_u32 s76, 0
    s_cbranch_scc0 A_wprep1_ok
    v_mbcnt_lo_u32_b32 v72, -1, 0
    v_mbcnt_hi_u32_b32 v72, -1, v72
    v_add_u32 v73, 0, v72
    v_min_u32 v73, 95, v73
    v_lshlrev_b32 v73, 4, v73
    v_add_u32 v74, 64, v72
    v_min_u32 v74, 95, v74
    v_lshlrev_b32 v74, 4, v74
    s_mov_b32 s53, 78647296
    s_mov_b32 s54, 1048576
A_wprep1:
    buffer_load_dword v75, v73, s[4:7], s53 offen sc1
    buffer_load_dword v76, v74, s[4:7], s53 offen sc1
    s_mov_b32 s90, 2
    s_sub_u32 s54, s54, 1
    s_cmp_eq_u32 s54, 0
    s_cbranch_scc1 L_abort0
    s_waitcnt vmcnt(0)
    v_and_b32 v75, v75, v76
    v_cmp_ne_u32 vcc, 1, v75
    s_cbranch_vccz A_wprep1_ok
    s_sleep 8
    s_branch A_wprep1
A_wprep1_ok:
    s_barrier
    s_add_u32 s19, s18, 8192
    buffer_load_dwordx4 a[32:35], v104, s[56:59], s19 offen sc1
    buffer_load_dwordx4 a[36:39], v104, s[56:59], s19 offen offset:1024 sc1
    s_add_u32 s19, s18, 10240
    buffer_load_dwordx4 a[40:43], v104, s[56:59], s19 offen sc1
    buffer_load_dwordx4 a[44:47], v104, s[56:59], s19 offen offset:1024 sc1
    s_add_u32 s19, s18, 12288
    buffer_load_dwordx4 a[48:51], v104, s[56:59], s19 offen sc1
    buffer_load_dwordx4 a[52:55], v104, s[56:59], s19 offen offset:1024 sc1
    s_add_u32 s19, s18, 22528
    buffer_load_dwordx4 a[88:91], v104, s[56:59], s19 offen sc1
    buffer_load_dwordx4 a[92:95], v104, s[56:59], s19 offen offset:1024 sc1
    s_add_u32 s19, s18, 24576
    buffer_load_dwordx4 a[96:99], v104, s[56:59], s19 offen sc1
    buffer_load_dwordx4 a[100:103], v104, s[56:59], s19 offen offset:1024 sc1
    s_add_u32 s19, s18, 26624
    buffer_load_dwordx4 a[104:107], v104, s[56:59], s19 offen sc1
    buffer_load_dwordx4 a[108:111], v104, s[56:59], s19 offen offset:1024 sc1
    s_add_u32 s19, s18, 36864
    buffer_load_dwordx4 a[144:147], v104, s[56:59], s19 offen sc1
    buffer_load_dwordx4 a[148:151], v104, s[56:59], s19 offen offset:1024 sc1
    s_add_u32 s19, s18, 38912
    buffer_load_dwordx4 a[152:155], v104, s[56:59], s19 offen sc1
    buffer_load_dwordx4 a[156:159], v104, s[56:59], s19 offen offset:1024 sc1
    s_add_u32 s19, s18, 40960
    buffer_load_dwordx4 a[160:163], v104, s[56:59], s19 offen sc1
    buffer_load_dwordx4 a[164:167], v104, s[56:59], s19 offen offset:1024 sc1
    s_add_u32 s19, s18, 51200
    buffer_load_dwordx4 a[200:203], v104, s[56:59], s19 offen sc1
    buffer_load_dwordx4 a[204:207], v104, s[56:59], s19 offen offset:1024 sc1
    s_add_u32 s19, s18, 53248
    buffer_load_dwordx4 a[208:211], v104, s[56:59], s19 offen sc1
    buffer_load_dwordx4 a[212:215], v104, s[56:59], s19 offen offset:1024 sc1
    s_add_u32 s19, s18, 55296
    buffer_load_dwordx4 a[216:219], v104, s[56:59], s19 offen sc1
    buffer_load_dwordx4 a[220:223], v104, s[56:59], s19 offen offset:1024 sc1
    s_add_u32 s19, s18, 65536
    buffer_load_dwordx4 v[120:123], v104, s[56:59], s19 offen sc1
    buffer_load_dwordx4 v[124:127], v104, s[56:59], s19 offen offset:1024 sc1
    s_add_u32 s19, s18, 67584
    buffer_load_dwordx4 v[128:131], v104, s[56:59], s19 offen sc1
    buffer_load_dwordx4 v[132:135], v104, s[56:59], s19 offen offset:1024 sc1
    s_add_u32 s19, s18, 69632
    buffer_load_dwordx4 v[136:139], v104, s[56:59], s19 offen sc1
    buffer_load_dwordx4 v[140:143], v104, s[56:59], s19 offen offset:1024 sc1
    s_add_u32 s19, s18, 79872
    buffer_load_dwordx4 v[176:179], v104, s[56:59], s19 offen sc1
    buffer_load_dwordx4 v[180:183], v104, s[56:59], s19 offen offset:1024 sc1
    s_waitcnt vmcnt(32)
    s_add_u32 s19, s18, 81920
    buffer_load_dwordx4 v[184:187], v104, s[56:59], s19 offen sc1
    buffer_load_dwordx4 v[188:191], v104, s[56:59], s19 offen offset:1024 sc1
    s_add_u32 s19, s18, 83968
    buffer_load_dwordx4 v[192:195], v104, s[56:59], s19 offen sc1
    buffer_load_dwordx4 v[196:199], v104, s[56:59], s19 offen offset:1024 sc1
    s_add_u32 s19, s18, 94208
    buffer_load_dwordx4 v[232:235], v104, s[56:59], s19 offen sc1
    buffer_load_dwordx4 v[236:239], v104, s[56:59], s19 offen offset:1024 sc1
    s_add_u32 s19, s18, 96256
    buffer_load_dwordx4 v[240:243], v104, s[56:59], s19 offen sc1
    buffer_load_dwordx4 v[244:247], v104, s[56:59], s19 offen offset:1024 sc1
    s_add_u32 s19, s18, 98304
    buffer_load_dwordx4 v[248:251], v104, s[56:59], s19 offen sc1
    buffer_load_dwordx4 v[252:255], v104, s[56:59], s19 offen offset:1024 sc1
    s_cmp_eq_u32 s76, 0
    s_cbranch_scc0 A_wfill_ok
    v_mbcnt_lo_u32_b32 v72, -1, 0
    v_mbcnt_hi_u32_b32 v72, -1, v72
    v_add_u32 v73, 0, v72
    v_min_u32 v73, 14, v73
    v_lshlrev_b32 v73, 4, v73
    s_mov_b32 s53, 78639104
    s_mov_b32 s54, 1048576
A_wfill:
    buffer_load_dword v74, v73, s[4:7], s53 offen sc1
    s_mov_b32 s90, 3
    s_sub_u32 s54, s54, 1
    s_cmp_eq_u32 s54, 0
    s_cbranch_scc1 L_abort0
    s_waitcnt vmcnt(0)
    v_cmp_ne_u32 vcc, 1, v74
    s_cbranch_vccz A_wfill_ok
    s_sleep 8
    s_branch A_wfill
A_wfill_ok:
    s_barrier
A_layer:
    s_mul_i32 s53, s65, 79691776
    s_add_u32 s53, s53, 30408704
    s_add_u32 s4, s68, s53
    s_addc_u32 s5, s69, 0
    s_and_b32 s5, s5, 0xffff
    s_mov_b32 s6, 79691776
    s_mov_b32 s7, 0x20000
    s_mov_b32 s15, 0
    s_mov_b32 s16, 2064384
    s_lshr_b32 s17, s13, 2
    s_mul_i32 s17, s17, 2560
    s_bfe_u32 s18, s13, 0x10001
    s_lshl_b32 s18, s18, 10
    s_add_u32 s17, s17, s18
    s_add_u32 s17, s17, 2621440
    s_mov_b32 s22, 0
    s_mov_b32 s30, 20480
    s_lshl_b32 s31, s13, 2
    s_add_u32 s31, s31, s14
    s_mul_i32 s31, s31, 7168
    s_add_u32 s31, s31, 11112448
    s_mov_b32 s25, 78618624
    s_mov_b32 s24, 0
    s_cmp_eq_u32 s76, 0
    s_cbranch_scc0 A_wf3_ok
    v_mbcnt_lo_u32_b32 v72, -1, 0
    v_mbcnt_hi_u32_b32 v72, -1, v72
    v_add_u32 v73, 0, v72
    v_min_u32 v73, 63, v73
    v_lshlrev_b32 v73, 4, v73
    s_mov_b32 s53, 78635008
    s_mov_b32 s54, 1048576
A_wf3:
    buffer_load_dword v74, v73, s[4:7], s53 offen sc1
    s_mov_b32 s90, 4
    s_sub_u32 s54, s54, 1
    s_cmp_eq_u32 s54, 0
    s_cbranch_scc1 L_abort0
    s_waitcnt vmcnt(0)
    v_cmp_ne_u32 vcc, 1, v74
    s_cbranch_vccz A_wf3_ok
    s_sleep 2
    s_branch A_wf3
A_wf3_ok:
    s_barrier
    s_cmp_ge_u32 s14, 2
    s_cbranch_scc0 A_init_d
    s_cmp_eq_u32 s14, 2
    s_cbranch_scc0 A_init_3
    s_add_u32 m0, s30, 0
    s_add_u32 s19, s22, 0
    buffer_load_dwordx4 v104, s[4:7], s19 offen sc1 lds
    s_add_u32 m0, s30, 1024
    s_add_u32 s19, s22, 1024
    buffer_load_dwordx4 v104, s[4:7], s19 offen sc1 lds
    s_add_u32 m0, s30, 2048
    s_add_u32 s19, s22, 2048
    buffer_load_dwordx4 v104, s[4:7], s19 offen sc1 lds
    s_add_u32 m0, s30, 3072
    s_add_u32 s19, s22, 3072
    buffer_load_dwordx4 v104, s[4:7], s19 offen sc1 lds
    s_add_u32 m0, s30, 4096
    s_add_u32 s19, s22, 4096
    buffer_load_dwordx4 v104, s[4:7], s19 offen sc1 lds
    s_add_u32 m0, s30, 5120
    s_add_u32 s19, s22, 5120
    buffer_load_dwordx4 v104, s[4:7], s19 offen sc1 lds
    s_add_u32 m0, s30, 6144
    s_add_u32 s19, s22, 6144
    buffer_load_dwordx4 v104, s[4:7], s19 offen sc1 lds
    s_add_u32 m0, s30, 7168
    s_add_u32 s19, s22, 7168
    buffer_load_dwordx4 v104, s[4:7], s19 offen sc1 lds
    s_add_u32 m0, s30, 8192
    s_add_u32 s19, s22, 8192
    buffer_load_dwordx4 v104, s[4:7], s19 offen sc1 lds
    s_add_u32 m0, s30, 9216
    s_add_u32 s19, s22, 9216
    buffer_load_dwordx4 v104, s[4:7], s19 offen sc1 lds
    s_add_u32 m0, s30, 10240
    s_add_u32 s19, s22, 10240
    buffer_load_dwordx4 v104, s[4:7], s19 offen sc1 lds
    s_add_u32 m0, s30, 11264
    s_add_u32 s19, s22, 11264
    buffer_load_dwordx4 v104, s[4:7], s19 offen sc1 lds
    s_add_u32 m0, s30, 12288
    s_add_u32 s19, s22, 12288
    buffer_load_dwordx4 v104, s[4:7], s19 offen sc1 lds
    s_add_u32 m0, s30, 13312
    s_add_u32 s19, s22, 13312
    buffer_load_dwordx4 v104, s[4:7], s19 offen sc1 lds
    s_branch A_init_d
A_init_3:
    s_add_u32 m0, s30, 14336
    s_add_u32 s19, s22, 14336
    buffer_load_dwordx4 v104, s[4:7], s19 offen sc1 lds
    s_add_u32 m0, s30, 15360
    s_add_u32 s19, s22, 15360
    buffer_load_dwordx4 v104, s[4:7], s19 offen sc1 lds
    s_add_u32 m0, s30, 16384
    s_add_u32 s19, s22, 16384
    buffer_load_dwordx4 v104, s[4:7], s19 offen sc1 lds
    s_add_u32 m0, s30, 17408
    s_add_u32 s19, s22, 17408
    buffer_load_dwordx4 v104, s[4:7], s19 offen sc1 lds
    s_add_u32 m0, s30, 18432
    s_add_u32 s19, s22, 18432
    buffer_load_dwordx4 v104, s[4:7], s19 offen sc1 lds
    s_add_u32 m0, s30, 19456
    s_add_u32 s19, s22, 19456
    buffer_load_dwordx4 v104, s[4:7], s19 offen sc1 lds
    s_add_u32 m0, s30, 20480
    s_add_u32 s19, s22, 20480
    buffer_load_dwordx4 v104, s[4:7], s19 offen sc1 lds
    s_add_u32 m0, s30, 21504
    s_add_u32 s19, s22, 21504
    buffer_load_dwordx4 v104, s[4:7], s19 offen sc1 lds
    s_add_u32 m0, s30, 22528
    s_add_u32 s19, s22, 22528
    buffer_load_dwordx4 v104, s[4:7], s19 offen sc1 lds
    s_add_u32 m0, s30, 23552
    s_add_u32 s19, s22, 23552
    buffer_load_dwordx4 v104, s[4:7], s19 offen sc1 lds
    s_add_u32 m0, s30, 24576
    s_add_u32 s19, s22, 24576
    buffer_load_dwordx4 v104, s[4:7], s19 offen sc1 lds
    s_add_u32 m0, s30, 25600
    s_add_u32 s19, s22, 25600
    buffer_load_dwordx4 v104, s[4:7], s19 offen sc1 lds
    s_add_u32 m0, s30, 26624
    s_add_u32 s19, s22, 26624
    buffer_load_dwordx4 v104, s[4:7], s19 offen sc1 lds
    s_add_u32 m0, s30, 27648
    s_add_u32 s19, s22, 27648
    buffer_load_dwordx4 v104, s[4:7], s19 offen sc1 lds
A_init_d:
    v_mov_b64 v[32:33], 0
    v_mov_b64 v[34:35], 0
    v_mov_b64 v[36:37], 0
    v_mov_b64 v[38:39], 0
    v_mov_b64 v[40:41], 0
    v_mov_b64 v[42:43], 0
    v_mov_b64 v[44:45], 0
    v_mov_b64 v[46:47], 0
    v_mov_b64 v[48:49], 0
    v_mov_b64 v[50:51], 0
    v_mov_b64 v[52:53], 0
    v_mov_b64 v[54:55], 0
    v_mov_b64 v[56:57], 0
    v_mov_b64 v[58:59], 0
    v_mov_b64 v[60:61], 0
    v_mov_b64 v[62:63], 0
    s_waitcnt vmcnt(0)
    s_add_u32 s22, s22, 28672
A_loop:
    s_add_u32 s20, s16, 4096
    s_waitcnt vmcnt(0)
    s_cmp_eq_u32 s14, 1
    s_cbranch_scc1 A_w1
    s_cmp_eq_u32 s14, 2
    s_cbranch_scc1 A_w2
    s_cmp_eq_u32 s14, 3
    s_cbranch_scc1 A_w3
    s_mov_b32 s23, 65536
    buffer_load_dwordx4 v[72:75], v104, s[4:7], s16 offen offset:0 sc1
    buffer_load_dwordx4 v[76:79], v104, s[4:7], s16 offen offset:1024 sc1
    s_sleep 1
    s_nop 3
    s_nop 3
A_mp0:
    buffer_load_dwordx4 v[80:83], v104, s[4:7], s16 offen offset:0 sc1
    buffer_load_dwordx4 v[84:87], v104, s[4:7], s16 offen offset:1024 sc1
    s_waitcnt vmcnt(3)
    ds_write_b128 v105, v[72:75] offset:0
    s_waitcnt vmcnt(2)
    ds_write_b128 v105, v[76:79] offset:1024
    v_max3_u32 v2, v72, v73, v74
    v_max3_u32 v2, v2, v75, v76
    v_max3_u32 v2, v2, v77, v78
    v_max_u32 v2, v2, v79
    v_cmp_eq_u32 vcc, -1, v2
    s_cbranch_vccz A_mp0_ok
    buffer_load_dwordx4 v[72:75], v104, s[4:7], s16 offen offset:0 sc1
    buffer_load_dwordx4 v[76:79], v104, s[4:7], s16 offen offset:1024 sc1
    s_mov_b32 s90, 5
    s_sub_u32 s23, s23, 1
    s_cmp_eq_u32 s23, 0
    s_cbranch_scc1 L_abort0
    s_waitcnt vmcnt(3)
    ds_write_b128 v105, v[80:83] offset:0
    s_waitcnt vmcnt(2)
    ds_write_b128 v105, v[84:87] offset:1024
    v_max3_u32 v2, v80, v81, v82
    v_max3_u32 v2, v2, v83, v84
    v_max3_u32 v2, v2, v85, v86
    v_max_u32 v2, v2, v87
    v_cmp_eq_u32 vcc, -1, v2
    s_cbranch_vccnz A_mp0_b
    s_branch A_mp0_ok
A_mp0_b:
    s_branch A_mp0
A_mp0_ok:
    s_waitcnt lgkmcnt(0)
    s_barrier
    ds_read_b128 v[4:7], v106 offset:0
    ds_read_b128 v[8:11], v106 offset:1024
    ds_read_b128 v[12:15], v106 offset:2048
    ds_read_b128 v[16:19], v106 offset:3072
    ds_read_b128 v[20:23], v106 offset:4096
    ds_read_b128 v[24:27], v106 offset:5120
    ds_read_b128 v[28:31], v106 offset:6144
    s_waitcnt lgkmcnt(6)
    v_smfmac_f32_16x16x64_bf16 v[32:35], v[4:7], a[0:7], v1
    s_waitcnt lgkmcnt(5)
    v_smfmac_f32_16x16x64_bf16 v[32:35], v[8:11], a[8:15], v1
    s_waitcnt lgkmcnt(4)
    v_smfmac_f32_16x16x64_bf16 v[32:35], v[12:15], a[16:23], v1
    s_waitcnt lgkmcnt(3)
    v_smfmac_f32_16x16x64_bf16 v[32:35], v[16:19], a[24:31], v1
    s_waitcnt lgkmcnt(2)
    v_smfmac_f32_16x16x64_bf16 v[32:35], v[20:23], a[32:39], v1
    s_waitcnt lgkmcnt(1)
    v_smfmac_f32_16x16x64_bf16 v[32:35], v[24:27], a[40:47], v1
    s_waitcnt lgkmcnt(0)
    v_smfmac_f32_16x16x64_bf16 v[32:35], v[28:31], a[48:55], v1
    v_smfmac_f32_16x16x64_bf16 v[36:39], v[4:7], a[56:63], v1
    ds_read_b128 v[72:75], v110 offset:0
    v_smfmac_f32_16x16x64_bf16 v[36:39], v[8:11], a[64:71], v1
    v_smfmac_f32_16x16x64_bf16 v[36:39], v[12:15], a[72:79], v1
    v_smfmac_f32_16x16x64_bf16 v[36:39], v[16:19], a[80:87], v1
    v_smfmac_f32_16x16x64_bf16 v[36:39], v[20:23], a[88:95], v1
    v_smfmac_f32_16x16x64_bf16 v[36:39], v[24:27], a[96:103], v1
    ds_read_b128 v[76:79], v110 offset:32
    v_smfmac_f32_16x16x64_bf16 v[36:39], v[28:31], a[104:111], v1
    v_smfmac_f32_16x16x64_bf16 v[40:43], v[4:7], a[112:119], v1
    ds_read_b128 v[80:83], v110 offset:1024
    v_smfmac_f32_16x16x64_bf16 v[40:43], v[8:11], a[120:127], v1
    v_add_f32 v32, v32, v34
    v_smfmac_f32_16x16x64_bf16 v[40:43], v[12:15], a[128:135], v1
    v_add_f32 v33, v33, v35
    v_smfmac_f32_16x16x64_bf16 v[40:43], v[16:19], a[136:143], v1
    v_cvt_pk_bf16_f32 v114, v32, v33
    v_smfmac_f32_16x16x64_bf16 v[40:43], v[20:23], a[144:151], v1
    ds_write_b32 v107, v114 offset:0
    v_smfmac_f32_16x16x64_bf16 v[40:43], v[24:27], a[152:159], v1
    ds_read_b128 v[84:87], v110 offset:1056
    v_smfmac_f32_16x16x64_bf16 v[40:43], v[28:31], a[160:167], v1
    v_smfmac_f32_16x16x64_bf16 v[44:47], v[4:7], a[168:175], v1
    ds_read_b128 v[88:91], v110 offset:2048
    v_smfmac_f32_16x16x64_bf16 v[44:47], v[8:11], a[176:183], v1
    v_add_f32 v36, v36, v38
    v_smfmac_f32_16x16x64_bf16 v[44:47], v[12:15], a[184:191], v1
    v_add_f32 v37, v37, v39
    v_smfmac_f32_16x16x64_bf16 v[44:47], v[16:19], a[192:199], v1
    v_cvt_pk_bf16_f32 v115, v36, v37
    v_smfmac_f32_16x16x64_bf16 v[44:47], v[20:23], a[200:207], v1
    ds_write_b32 v107, v115 offset:1536
    v_smfmac_f32_16x16x64_bf16 v[44:47], v[24:27], a[208:215], v1
    ds_read_b128 v[92:95], v110 offset:2080
    v_smfmac_f32_16x16x64_bf16 v[44:47], v[28:31], a[216:223], v1
    v_smfmac_f32_16x16x64_bf16 v[48:51], v[4:7], a[224:231], v1
    ds_read_b128 v[96:99], v110 offset:3072
    v_smfmac_f32_16x16x64_bf16 v[48:51], v[8:11], a[232:239], v1
    v_add_f32 v40, v40, v42
    v_smfmac_f32_16x16x64_bf16 v[48:51], v[12:15], a[240:247], v1
    v_add_f32 v41, v41, v43
    v_smfmac_f32_16x16x64_bf16 v[48:51], v[16:19], a[248:255], v1
    v_cvt_pk_bf16_f32 v114, v40, v41
    v_smfmac_f32_16x16x64_bf16 v[48:51], v[20:23], v[120:127], v1
    ds_write_b32 v107, v114 offset:3072
    v_smfmac_f32_16x16x64_bf16 v[48:51], v[24:27], v[128:135], v1
    ds_read_b128 v[100:103], v110 offset:3104
    v_smfmac_f32_16x16x64_bf16 v[48:51], v[28:31], v[136:143], v1
    v_smfmac_f32_16x16x64_bf16 v[52:55], v[4:7], v[144:151], v1
    v_smfmac_f32_16x16x64_bf16 v[52:55], v[8:11], v[152:159], v1
    v_add_f32 v44, v44, v46
    v_smfmac_f32_16x16x64_bf16 v[52:55], v[12:15], v[160:167], v1
    v_add_f32 v45, v45, v47
    v_smfmac_f32_16x16x64_bf16 v[52:55], v[16:19], v[168:175], v1
    v_cvt_pk_bf16_f32 v115, v44, v45
    v_smfmac_f32_16x16x64_bf16 v[52:55], v[20:23], v[176:183], v1
    ds_write_b32 v107, v115 offset:4608
    v_smfmac_f32_16x16x64_bf16 v[52:55], v[24:27], v[184:191], v1
    v_smfmac_f32_16x16x64_bf16 v[52:55], v[28:31], v[192:199], v1
    v_smfmac_f32_16x16x64_bf16 v[56:59], v[4:7], v[200:207], v1
    v_smfmac_f32_16x16x64_bf16 v[56:59], v[8:11], v[208:215], v1
    v_add_f32 v48, v48, v50
    v_smfmac_f32_16x16x64_bf16 v[56:59], v[12:15], v[216:223], v1
    v_add_f32 v49, v49, v51
    v_smfmac_f32_16x16x64_bf16 v[56:59], v[16:19], v[224:231], v1
    v_cvt_pk_bf16_f32 v114, v48, v49
    v_smfmac_f32_16x16x64_bf16 v[56:59], v[20:23], v[232:239], v1
    ds_write_b32 v107, v114 offset:6144
    v_smfmac_f32_16x16x64_bf16 v[56:59], v[24:27], v[240:247], v1
    v_smfmac_f32_16x16x64_bf16 v[56:59], v[28:31], v[248:255], v1
    ds_read_b128 v[4:7], v110 offset:4096
    ds_read_b128 v[8:11], v110 offset:4128
    ds_read_b128 v[12:15], v110 offset:5120
    ds_read_b128 v[16:19], v110 offset:5152
    ds_read_b128 v[20:23], v110 offset:6144
    ds_read_b128 v[24:27], v110 offset:6176
    v_add_f32 v52, v52, v54
    v_add_f32 v53, v53, v55
    v_cvt_pk_bf16_f32 v115, v52, v53
    ds_write_b32 v107, v115 offset:7680
    v_add_f32 v56, v56, v58
    v_add_f32 v57, v57, v59
    v_cvt_pk_bf16_f32 v114, v56, v57
    ds_write_b32 v107, v114 offset:9216
    s_waitcnt lgkmcnt(0)
    s_barrier
    ds_read_b64_tr_b16 v[32:33], v108 offset:0
    ds_read_b64_tr_b16 v[34:35], v108 offset:128
    ds_read_b64_tr_b16 v[36:37], v108 offset:1536
    ds_read_b64_tr_b16 v[38:39], v108 offset:1664
    ds_read_b64_tr_b16 v[40:41], v108 offset:3072
    ds_read_b64_tr_b16 v[42:43], v108 offset:3200
    ds_read_b64_tr_b16 v[44:45], v108 offset:4608
    ds_read_b64_tr_b16 v[46:47], v108 offset:4736
    ds_read_b64_tr_b16 v[48:49], v108 offset:6144
    ds_read_b64_tr_b16 v[50:51], v108 offset:6272
    ds_read_b64_tr_b16 v[52:53], v108 offset:7680
    ds_read_b64_tr_b16 v[54:55], v108 offset:7808
    ds_read_b64_tr_b16 v[56:57], v108 offset:9216
    ds_read_b64_tr_b16 v[58:59], v108 offset:9344
    s_waitcnt lgkmcnt(12)
    v_smfmac_f32_16x16x64_bf16 v[60:63], v[32:35], v[72:79], v1
    s_waitcnt lgkmcnt(10)
    v_smfmac_f32_16x16x64_bf16 v[60:63], v[36:39], v[80:87], v1
    s_waitcnt lgkmcnt(8)
    v_smfmac_f32_16x16x64_bf16 v[60:63], v[40:43], v[88:95], v1
    s_waitcnt lgkmcnt(6)
    v_smfmac_f32_16x16x64_bf16 v[60:63], v[44:47], v[96:103], v1
    s_waitcnt lgkmcnt(4)
    v_smfmac_f32_16x16x64_bf16 v[60:63], v[48:51], v[4:11], v1
    s_waitcnt lgkmcnt(2)
    v_smfmac_f32_16x16x64_bf16 v[60:63], v[52:55], v[12:19], v1
    s_waitcnt lgkmcnt(0)
    v_smfmac_f32_16x16x64_bf16 v[60:63], v[56:59], v[20:27], v1
    s_nop 7
    v_pk_add_f32 v[60:61], v[60:61], v[62:63]
    s_barrier
    ds_read_b64 v[64:65], v113
    ds_read_b64 v[68:69], v113 offset:512
    s_waitcnt lgkmcnt(0)
    v_max3_f32 v72, v60, v64, v68
    v_max3_f32 v73, v61, v65, v69
    s_nop 0
    v_max_f32_dpp v72, v72, v72 row_ror:8 row_mask:0xf bank_mask:0xf
    v_max_f32_dpp v73, v73, v73 row_ror:8 row_mask:0xf bank_mask:0xf
    s_nop 0
    v_max_f32_dpp v72, v72, v72 row_ror:4 row_mask:0xf bank_mask:0xf
    v_max_f32_dpp v73, v73, v73 row_ror:4 row_mask:0xf bank_mask:0xf
    s_nop 0
    v_max_f32_dpp v72, v72, v72 row_ror:2 row_mask:0xf bank_mask:0xf
    v_max_f32_dpp v73, v73, v73 row_ror:2 row_mask:0xf bank_mask:0xf
    s_nop 0
    v_max_f32_dpp v72, v72, v72 row_ror:1 row_mask:0xf bank_mask:0xf
    v_max_f32_dpp v73, v73, v73 row_ror:1 row_mask:0xf bank_mask:0xf
    v_pk_add_f32 v[64:65], v[64:65], v[72:73] neg_lo:[0,1] neg_hi:[0,1]
    v_pk_add_f32 v[68:69], v[68:69], v[72:73] neg_lo:[0,1] neg_hi:[0,1]
    v_pk_add_f32 v[60:61], v[60:61], v[72:73] neg_lo:[0,1] neg_hi:[0,1]
    v_exp_f32 v60, v60
    v_exp_f32 v61, v61
    v_exp_f32 v64, v64
    v_exp_f32 v65, v65
    v_exp_f32 v68, v68
    v_exp_f32 v69, v69
    v_pk_mul_f32 v[72:73], v[60:61], 0.5 op_sel_hi:[1,0]
    v_pk_add_f32 v[74:75], v[64:65], v[68:69]
    v_pk_add_f32 v[72:73], v[72:73], v[74:75]
    v_mov_b32_dpp v62, v60 row_shl:1 row_mask:0xf bank_mask:0xf
    v_mov_b32_dpp v63, v61 row_shl:1 row_mask:0xf bank_mask:0xf
    v_add_f32_dpp v72, v72, v72 row_ror:8 row_mask:0xf bank_mask:0xf
    v_add_f32_dpp v73, v73, v73 row_ror:8 row_mask:0xf bank_mask:0xf
    s_nop 0
    v_add_f32_dpp v72, v72, v72 row_ror:4 row_mask:0xf bank_mask:0xf
    v_add_f32_dpp v73, v73, v73 row_ror:4 row_mask:0xf bank_mask:0xf
    s_nop 0
    v_add_f32_dpp v72, v72, v72 row_ror:2 row_mask:0xf bank_mask:0xf
    v_add_f32_dpp v73, v73, v73 row_ror:2 row_mask:0xf bank_mask:0xf
    s_nop 0
    v_add_f32_dpp v72, v72, v72 row_ror:1 row_mask:0xf bank_mask:0xf
    v_add_f32_dpp v73, v73, v73 row_ror:1 row_mask:0xf bank_mask:0xf
    v_rcp_f32 v72, v72
    v_rcp_f32 v73, v73
    s_nop 0
    v_pk_mul_f32 v[64:65], v[64:65], v[72:73]
    v_pk_mul_f32 v[68:69], v[68:69], v[72:73]
    v_cvt_pk_bf16_f32 v66, |v64|, |v68|
    v_cvt_pk_bf16_f32 v67, |v65|, |v69|
    buffer_store_dword v66, v111, s[4:7], s17 offen
    v_pk_mul_f32 v[60:61], v[60:61], v[72:73]
    buffer_store_dword v67, v111, s[4:7], s17 offen offset:16
    v_pk_mul_f32 v[62:63], v[62:63], v[72:73]
    v_cvt_pk_bf16_f32 v60, |v60|, |v62|
    v_cvt_pk_bf16_f32 v61, |v61|, |v63|
    buffer_store_dword v60, v112, s[4:7], s17 offen
    buffer_store_dword v61, v112, s[4:7], s17 offen offset:4
    s_xor_b32 s30, s30, 36864
    s_barrier
    v_mov_b64 v[32:33], 0
    v_mov_b64 v[34:35], 0
    v_mov_b64 v[36:37], 0
    v_mov_b64 v[38:39], 0
    v_mov_b64 v[40:41], 0
    v_mov_b64 v[42:43], 0
    v_mov_b64 v[44:45], 0
    v_mov_b64 v[46:47], 0
    v_mov_b64 v[48:49], 0
    v_mov_b64 v[50:51], 0
    v_mov_b64 v[52:53], 0
    v_mov_b64 v[54:55], 0
    v_mov_b64 v[56:57], 0
    v_mov_b64 v[58:59], 0
    v_mov_b64 v[60:61], 0
    v_mov_b64 v[62:63], 0
    s_branch A_tail
A_w1:
    s_mov_b32 s23, 65536
    buffer_load_dwordx4 v[72:75], v104, s[4:7], s16 offen offset:2048 sc1
    buffer_load_dwordx4 v[76:79], v104, s[4:7], s16 offen offset:3072 sc1
    s_sleep 1
    s_nop 3
    s_nop 3
A_mp1:
    buffer_load_dwordx4 v[80:83], v104, s[4:7], s16 offen offset:2048 sc1
    buffer_load_dwordx4 v[84:87], v104, s[4:7], s16 offen offset:3072 sc1
    s_waitcnt vmcnt(3)
    ds_write_b128 v105, v[72:75] offset:2048
    s_waitcnt vmcnt(2)
    ds_write_b128 v105, v[76:79] offset:3072
    v_max3_u32 v2, v72, v73, v74
    v_max3_u32 v2, v2, v75, v76
    v_max3_u32 v2, v2, v77, v78
    v_max_u32 v2, v2, v79
    v_cmp_eq_u32 vcc, -1, v2
    s_cbranch_vccz A_mp1_ok
    buffer_load_dwordx4 v[72:75], v104, s[4:7], s16 offen offset:2048 sc1
    buffer_load_dwordx4 v[76:79], v104, s[4:7], s16 offen offset:3072 sc1
    s_mov_b32 s90, 6
    s_sub_u32 s23, s23, 1
    s_cmp_eq_u32 s23, 0
    s_cbranch_scc1 L_abort0
    s_waitcnt vmcnt(3)
    ds_write_b128 v105, v[80:83] offset:2048
    s_waitcnt vmcnt(2)
    ds_write_b128 v105, v[84:87] offset:3072
    v_max3_u32 v2, v80, v81, v82
    v_max3_u32 v2, v2, v83, v84
    v_max3_u32 v2, v2, v85, v86
    v_max_u32 v2, v2, v87
    v_cmp_eq_u32 vcc, -1, v2
    s_cbranch_vccnz A_mp1_b
    s_branch A_mp1_ok
A_mp1_b:
    s_branch A_mp1
A_mp1_ok:
    s_waitcnt lgkmcnt(0)
    s_barrier
    ds_read_b128 v[4:7], v106 offset:0
    ds_read_b128 v[8:11], v106 offset:1024
    ds_read_b128 v[12:15], v106 offset:2048
    ds_read_b128 v[16:19], v106 offset:3072
    ds_read_b128 v[20:23], v106 offset:4096
    ds_read_b128 v[24:27], v106 offset:5120
    ds_read_b128 v[28:31], v106 offset:6144
    v_add_u32 v116, s30, v109
    s_waitcnt lgkmcnt(6)
    v_smfmac_f32_16x16x64_bf16 v[32:35], v[4:7], a[0:7], v1
    s_waitcnt lgkmcnt(5)
    v_smfmac_f32_16x16x64_bf16 v[32:35], v[8:11], a[8:15], v1
    s_waitcnt lgkmcnt(4)
    v_smfmac_f32_16x16x64_bf16 v[32:35], v[12:15], a[16:23], v1
    s_waitcnt lgkmcnt(3)
    v_smfmac_f32_16x16x64_bf16 v[32:35], v[16:19], a[24:31], v1
    s_waitcnt lgkmcnt(2)
    v_smfmac_f32_16x16x64_bf16 v[32:35], v[20:23], a[32:39], v1
    s_waitcnt lgkmcnt(1)
    v_smfmac_f32_16x16x64_bf16 v[32:35], v[24:27], a[40:47], v1
    s_waitcnt lgkmcnt(0)
    v_smfmac_f32_16x16x64_bf16 v[32:35], v[28:31], a[48:55], v1
    v_smfmac_f32_16x16x64_bf16 v[36:39], v[4:7], a[56:63], v1
    ds_read_b128 v[72:75], v116 offset:0
    v_smfmac_f32_16x16x64_bf16 v[36:39], v[8:11], a[64:71], v1
    v_smfmac_f32_16x16x64_bf16 v[36:39], v[12:15], a[72:79], v1
    v_smfmac_f32_16x16x64_bf16 v[36:39], v[16:19], a[80:87], v1
    v_smfmac_f32_16x16x64_bf16 v[36:39], v[20:23], a[88:95], v1
    v_smfmac_f32_16x16x64_bf16 v[36:39], v[24:27], a[96:103], v1
    ds_read_b128 v[76:79], v116 offset:1024
    v_smfmac_f32_16x16x64_bf16 v[36:39], v[28:31], a[104:111], v1
    v_smfmac_f32_16x16x64_bf16 v[40:43], v[4:7], a[112:119], v1
    ds_read_b128 v[80:83], v116 offset:2048
    v_smfmac_f32_16x16x64_bf16 v[40:43], v[8:11], a[120:127], v1
    v_add_f32 v32, v32, v34
    v_smfmac_f32_16x16x64_bf16 v[40:43], v[12:15], a[128:135], v1
    v_add_f32 v33, v33, v35
    v_smfmac_f32_16x16x64_bf16 v[40:43], v[16:19], a[136:143], v1
    v_cvt_pk_bf16_f32 v114, v32, v33
    v_smfmac_f32_16x16x64_bf16 v[40:43], v[20:23], a[144:151], v1
    ds_write_b32 v107, v114 offset:0
    v_smfmac_f32_16x16x64_bf16 v[40:43], v[24:27], a[152:159], v1
    ds_read_b128 v[84:87], v116 offset:3072
    v_smfmac_f32_16x16x64_bf16 v[40:43], v[28:31], a[160:167], v1
    v_smfmac_f32_16x16x64_bf16 v[44:47], v[4:7], a[168:175], v1
    ds_read_b128 v[88:91], v116 offset:4096
    v_smfmac_f32_16x16x64_bf16 v[44:47], v[8:11], a[176:183], v1
    v_add_f32 v36, v36, v38
    v_smfmac_f32_16x16x64_bf16 v[44:47], v[12:15], a[184:191], v1
    v_add_f32 v37, v37, v39
    v_smfmac_f32_16x16x64_bf16 v[44:47], v[16:19], a[192:199], v1
    v_cvt_pk_bf16_f32 v115, v36, v37
    v_smfmac_f32_16x16x64_bf16 v[44:47], v[20:23], a[200:207], v1
    ds_write_b32 v107, v115 offset:1536
    v_smfmac_f32_16x16x64_bf16 v[44:47], v[24:27], a[208:215], v1
    ds_read_b128 v[92:95], v116 offset:5120
    v_smfmac_f32_16x16x64_bf16 v[44:47], v[28:31], a[216:223], v1
    v_smfmac_f32_16x16x64_bf16 v[48:51], v[4:7], a[224:231], v1
    ds_read_b128 v[96:99], v116 offset:6144
    v_smfmac_f32_16x16x64_bf16 v[48:51], v[8:11], a[232:239], v1
    v_add_f32 v40, v40, v42
    v_smfmac_f32_16x16x64_bf16 v[48:51], v[12:15], a[240:247], v1
    v_add_f32 v41, v41, v43
    v_smfmac_f32_16x16x64_bf16 v[48:51], v[16:19], a[248:255], v1
    v_cvt_pk_bf16_f32 v114, v40, v41
    v_smfmac_f32_16x16x64_bf16 v[48:51], v[20:23], v[120:127], v1
    ds_write_b32 v107, v114 offset:3072
    v_smfmac_f32_16x16x64_bf16 v[48:51], v[24:27], v[128:135], v1
    ds_read_b128 v[100:103], v116 offset:7168
    v_smfmac_f32_16x16x64_bf16 v[48:51], v[28:31], v[136:143], v1
    v_smfmac_f32_16x16x64_bf16 v[52:55], v[4:7], v[144:151], v1
    v_smfmac_f32_16x16x64_bf16 v[52:55], v[8:11], v[152:159], v1
    v_add_f32 v44, v44, v46
    v_smfmac_f32_16x16x64_bf16 v[52:55], v[12:15], v[160:167], v1
    v_add_f32 v45, v45, v47
    v_smfmac_f32_16x16x64_bf16 v[52:55], v[16:19], v[168:175], v1
    v_cvt_pk_bf16_f32 v115, v44, v45
    v_smfmac_f32_16x16x64_bf16 v[52:55], v[20:23], v[176:183], v1
    ds_write_b32 v107, v115 offset:4608
    v_smfmac_f32_16x16x64_bf16 v[52:55], v[24:27], v[184:191], v1
    v_smfmac_f32_16x16x64_bf16 v[52:55], v[28:31], v[192:199], v1
    v_smfmac_f32_16x16x64_bf16 v[56:59], v[4:7], v[200:207], v1
    v_smfmac_f32_16x16x64_bf16 v[56:59], v[8:11], v[208:215], v1
    v_add_f32 v48, v48, v50
    v_smfmac_f32_16x16x64_bf16 v[56:59], v[12:15], v[216:223], v1
    v_add_f32 v49, v49, v51
    v_smfmac_f32_16x16x64_bf16 v[56:59], v[16:19], v[224:231], v1
    v_cvt_pk_bf16_f32 v114, v48, v49
    v_smfmac_f32_16x16x64_bf16 v[56:59], v[20:23], v[232:239], v1
    ds_write_b32 v107, v114 offset:6144
    v_smfmac_f32_16x16x64_bf16 v[56:59], v[24:27], v[240:247], v1
    v_smfmac_f32_16x16x64_bf16 v[56:59], v[28:31], v[248:255], v1
    ds_read_b128 v[4:7], v116 offset:8192
    ds_read_b128 v[8:11], v116 offset:9216
    ds_read_b128 v[12:15], v116 offset:10240
    ds_read_b128 v[16:19], v116 offset:11264
    ds_read_b128 v[20:23], v116 offset:12288
    ds_read_b128 v[24:27], v116 offset:13312
    v_add_f32 v52, v52, v54
    v_add_f32 v53, v53, v55
    v_cvt_pk_bf16_f32 v115, v52, v53
    ds_write_b32 v107, v115 offset:7680
    v_add_f32 v56, v56, v58
    v_add_f32 v57, v57, v59
    v_cvt_pk_bf16_f32 v114, v56, v57
    ds_write_b32 v107, v114 offset:9216
    s_waitcnt lgkmcnt(0)
    s_barrier
    ds_read_b64_tr_b16 v[32:33], v108 offset:0
    ds_read_b64_tr_b16 v[34:35], v108 offset:128
    ds_read_b64_tr_b16 v[36:37], v108 offset:1536
    ds_read_b64_tr_b16 v[38:39], v108 offset:1664
    ds_read_b64_tr_b16 v[40:41], v108 offset:3072
    ds_read_b64_tr_b16 v[42:43], v108 offset:3200
    ds_read_b64_tr_b16 v[44:45], v108 offset:4608
    ds_read_b64_tr_b16 v[46:47], v108 offset:4736
    ds_read_b64_tr_b16 v[48:49], v108 offset:6144
    ds_read_b64_tr_b16 v[50:51], v108 offset:6272
    ds_read_b64_tr_b16 v[52:53], v108 offset:7680
    ds_read_b64_tr_b16 v[54:55], v108 offset:7808
    ds_read_b64_tr_b16 v[56:57], v108 offset:9216
    ds_read_b64_tr_b16 v[58:59], v108 offset:9344
    s_waitcnt lgkmcnt(12)
    v_smfmac_f32_16x16x64_bf16 v[60:63], v[32:35], v[72:79], v1
    s_waitcnt lgkmcnt(10)
    v_smfmac_f32_16x16x64_bf16 v[60:63], v[36:39], v[80:87], v1
    s_waitcnt lgkmcnt(8)
    v_smfmac_f32_16x16x64_bf16 v[60:63], v[40:43], v[88:95], v1
    s_waitcnt lgkmcnt(6)
    v_smfmac_f32_16x16x64_bf16 v[60:63], v[44:47], v[96:103], v1
    s_waitcnt lgkmcnt(4)
    v_smfmac_f32_16x16x64_bf16 v[60:63], v[48:51], v[4:11], v1
    s_waitcnt lgkmcnt(2)
    v_smfmac_f32_16x16x64_bf16 v[60:63], v[52:55], v[12:19], v1
    s_waitcnt lgkmcnt(0)
    v_smfmac_f32_16x16x64_bf16 v[60:63], v[56:59], v[20:27], v1
    s_nop 7
    v_pk_add_f32 v[60:61], v[60:61], v[62:63]
    ds_write_b64 v113, v[60:61] offset:0
    s_waitcnt lgkmcnt(0)
    s_barrier
    v_mov_b64 v[32:33], 0
    v_mov_b64 v[34:35], 0
    v_mov_b64 v[36:37], 0
    v_mov_b64 v[38:39], 0
    v_mov_b64 v[40:41], 0
    v_mov_b64 v[42:43], 0
    v_mov_b64 v[44:45], 0
    v_mov_b64 v[46:47], 0
    v_mov_b64 v[48:49], 0
    v_mov_b64 v[50:51], 0
    v_mov_b64 v[52:53], 0
    v_mov_b64 v[54:55], 0
    v_mov_b64 v[56:57], 0
    v_mov_b64 v[58:59], 0
    v_mov_b64 v[60:61], 0
    v_mov_b64 v[62:63], 0
    s_xor_b32 s30, s30, 36864
    s_barrier
    s_branch A_tail
A_w2:
    s_mov_b32 s23, 65536
    buffer_load_dwordx4 v[72:75], v104, s[4:7], s20 offen offset:0 sc1
    buffer_load_dwordx4 v[76:79], v104, s[4:7], s20 offen offset:1024 sc1
    s_sleep 1
    s_nop 3
    s_nop 3
A_mp2:
    buffer_load_dwordx4 v[80:83], v104, s[4:7], s20 offen offset:0 sc1
    buffer_load_dwordx4 v[84:87], v104, s[4:7], s20 offen offset:1024 sc1
    s_waitcnt vmcnt(3)
    ds_write_b128 v105, v[72:75] offset:4096
    s_waitcnt vmcnt(2)
    ds_write_b128 v105, v[76:79] offset:5120
    v_max3_u32 v2, v72, v73, v74
    v_max3_u32 v2, v2, v75, v76
    v_max3_u32 v2, v2, v77, v78
    v_max_u32 v2, v2, v79
    v_cmp_eq_u32 vcc, -1, v2
    s_cbranch_vccz A_mp2_ok
    buffer_load_dwordx4 v[72:75], v104, s[4:7], s20 offen offset:0 sc1
    buffer_load_dwordx4 v[76:79], v104, s[4:7], s20 offen offset:1024 sc1
    s_mov_b32 s90, 7
    s_sub_u32 s23, s23, 1
    s_cmp_eq_u32 s23, 0
    s_cbranch_scc1 L_abort0
    s_waitcnt vmcnt(3)
    ds_write_b128 v105, v[80:83] offset:4096
    s_waitcnt vmcnt(2)
    ds_write_b128 v105, v[84:87] offset:5120
    v_max3_u32 v2, v80, v81, v82
    v_max3_u32 v2, v2, v83, v84
    v_max3_u32 v2, v2, v85, v86
    v_max_u32 v2, v2, v87
    v_cmp_eq_u32 vcc, -1, v2
    s_cbranch_vccnz A_mp2_b
    s_branch A_mp2_ok
A_mp2_b:
    s_branch A_mp2
A_mp2_ok:
    s_waitcnt lgkmcnt(0)
    s_barrier
    ds_read_b128 v[4:7], v106 offset:0
    ds_read_b128 v[8:11], v106 offset:1024
    ds_read_b128 v[12:15], v106 offset:2048
    ds_read_b128 v[16:19], v106 offset:3072
    ds_read_b128 v[20:23], v106 offset:4096
    ds_read_b128 v[24:27], v106 offset:5120
    ds_read_b128 v[28:31], v106 offset:6144
    v_add_u32 v116, s30, v109
    s_waitcnt lgkmcnt(6)
    v_smfmac_f32_16x16x64_bf16 v[32:35], v[4:7], a[0:7], v1
    s_waitcnt lgkmcnt(5)
    v_smfmac_f32_16x16x64_bf16 v[32:35], v[8:11], a[8:15], v1
    s_waitcnt lgkmcnt(4)
    v_smfmac_f32_16x16x64_bf16 v[32:35], v[12:15], a[16:23], v1
    s_waitcnt lgkmcnt(3)
    v_smfmac_f32_16x16x64_bf16 v[32:35], v[16:19], a[24:31], v1
    s_waitcnt lgkmcnt(2)
    v_smfmac_f32_16x16x64_bf16 v[32:35], v[20:23], a[32:39], v1
    s_waitcnt lgkmcnt(1)
    v_smfmac_f32_16x16x64_bf16 v[32:35], v[24:27], a[40:47], v1
    s_waitcnt lgkmcnt(0)
    v_smfmac_f32_16x16x64_bf16 v[32:35], v[28:31], a[48:55], v1
    v_smfmac_f32_16x16x64_bf16 v[36:39], v[4:7], a[56:63], v1
    ds_read_b128 v[72:75], v116 offset:0
    v_smfmac_f32_16x16x64_bf16 v[36:39], v[8:11], a[64:71], v1
    v_smfmac_f32_16x16x64_bf16 v[36:39], v[12:15], a[72:79], v1
    v_smfmac_f32_16x16x64_bf16 v[36:39], v[16:19], a[80:87], v1
    v_smfmac_f32_16x16x64_bf16 v[36:39], v[20:23], a[88:95], v1
    v_smfmac_f32_16x16x64_bf16 v[36:39], v[24:27], a[96:103], v1
    ds_read_b128 v[76:79], v116 offset:1024
    v_smfmac_f32_16x16x64_bf16 v[36:39], v[28:31], a[104:111], v1
    v_smfmac_f32_16x16x64_bf16 v[40:43], v[4:7], a[112:119], v1
    ds_read_b128 v[80:83], v116 offset:2048
    v_smfmac_f32_16x16x64_bf16 v[40:43], v[8:11], a[120:127], v1
    v_add_f32 v32, v32, v34
    v_smfmac_f32_16x16x64_bf16 v[40:43], v[12:15], a[128:135], v1
    v_add_f32 v33, v33, v35
    v_smfmac_f32_16x16x64_bf16 v[40:43], v[16:19], a[136:143], v1
    v_cvt_pk_bf16_f32 v114, v32, v33
    v_smfmac_f32_16x16x64_bf16 v[40:43], v[20:23], a[144:151], v1
    ds_write_b32 v107, v114 offset:0
    v_smfmac_f32_16x16x64_bf16 v[40:43], v[24:27], a[152:159], v1
    ds_read_b128 v[84:87], v116 offset:3072
    v_smfmac_f32_16x16x64_bf16 v[40:43], v[28:31], a[160:167], v1
    v_smfmac_f32_16x16x64_bf16 v[44:47], v[4:7], a[168:175], v1
    ds_read_b128 v[88:91], v116 offset:4096
    v_smfmac_f32_16x16x64_bf16 v[44:47], v[8:11], a[176:183], v1
    v_add_f32 v36, v36, v38
    v_smfmac_f32_16x16x64_bf16 v[44:47], v[12:15], a[184:191], v1
    v_add_f32 v37, v37, v39
    v_smfmac_f32_16x16x64_bf16 v[44:47], v[16:19], a[192:199], v1
    v_cvt_pk_bf16_f32 v115, v36, v37
    v_smfmac_f32_16x16x64_bf16 v[44:47], v[20:23], a[200:207], v1
    ds_write_b32 v107, v115 offset:1536
    v_smfmac_f32_16x16x64_bf16 v[44:47], v[24:27], a[208:215], v1
    ds_read_b128 v[92:95], v116 offset:5120
    v_smfmac_f32_16x16x64_bf16 v[44:47], v[28:31], a[216:223], v1
    v_smfmac_f32_16x16x64_bf16 v[48:51], v[4:7], a[224:231], v1
    ds_read_b128 v[96:99], v116 offset:6144
    v_smfmac_f32_16x16x64_bf16 v[48:51], v[8:11], a[232:239], v1
    v_add_f32 v40, v40, v42
    v_smfmac_f32_16x16x64_bf16 v[48:51], v[12:15], a[240:247], v1
    v_add_f32 v41, v41, v43
    v_smfmac_f32_16x16x64_bf16 v[48:51], v[16:19], a[248:255], v1
    v_cvt_pk_bf16_f32 v114, v40, v41
    v_smfmac_f32_16x16x64_bf16 v[48:51], v[20:23], v[120:127], v1
    ds_write_b32 v107, v114 offset:3072
    v_smfmac_f32_16x16x64_bf16 v[48:51], v[24:27], v[128:135], v1
    ds_read_b128 v[100:103], v116 offset:7168
    v_smfmac_f32_16x16x64_bf16 v[48:51], v[28:31], v[136:143], v1
    v_smfmac_f32_16x16x64_bf16 v[52:55], v[4:7], v[144:151], v1
    v_smfmac_f32_16x16x64_bf16 v[52:55], v[8:11], v[152:159], v1
    v_add_f32 v44, v44, v46
    v_smfmac_f32_16x16x64_bf16 v[52:55], v[12:15], v[160:167], v1
    v_add_f32 v45, v45, v47
    v_smfmac_f32_16x16x64_bf16 v[52:55], v[16:19], v[168:175], v1
    v_cvt_pk_bf16_f32 v115, v44, v45
    v_smfmac_f32_16x16x64_bf16 v[52:55], v[20:23], v[176:183], v1
    ds_write_b32 v107, v115 offset:4608
    v_smfmac_f32_16x16x64_bf16 v[52:55], v[24:27], v[184:191], v1
    v_smfmac_f32_16x16x64_bf16 v[52:55], v[28:31], v[192:199], v1
    v_smfmac_f32_16x16x64_bf16 v[56:59], v[4:7], v[200:207], v1
    v_smfmac_f32_16x16x64_bf16 v[56:59], v[8:11], v[208:215], v1
    v_add_f32 v48, v48, v50
    v_smfmac_f32_16x16x64_bf16 v[56:59], v[12:15], v[216:223], v1
    v_add_f32 v49, v49, v51
    v_smfmac_f32_16x16x64_bf16 v[56:59], v[16:19], v[224:231], v1
    v_cvt_pk_bf16_f32 v114, v48, v49
    v_smfmac_f32_16x16x64_bf16 v[56:59], v[20:23], v[232:239], v1
    ds_write_b32 v107, v114 offset:6144
    v_smfmac_f32_16x16x64_bf16 v[56:59], v[24:27], v[240:247], v1
    v_smfmac_f32_16x16x64_bf16 v[56:59], v[28:31], v[248:255], v1
    ds_read_b128 v[4:7], v116 offset:8192
    ds_read_b128 v[8:11], v116 offset:9216
    ds_read_b128 v[12:15], v116 offset:10240
    ds_read_b128 v[16:19], v116 offset:11264
    ds_read_b128 v[20:23], v116 offset:12288
    ds_read_b128 v[24:27], v116 offset:13312
    v_add_f32 v52, v52, v54
    v_add_f32 v53, v53, v55
    v_cvt_pk_bf16_f32 v115, v52, v53
    ds_write_b32 v107, v115 offset:7680
    v_add_f32 v56, v56, v58
    v_add_f32 v57, v57, v59
    v_cvt_pk_bf16_f32 v114, v56, v57
    ds_write_b32 v107, v114 offset:9216
    s_waitcnt lgkmcnt(0)
    s_barrier
    ds_read_b64_tr_b16 v[32:33], v108 offset:0
    ds_read_b64_tr_b16 v[34:35], v108 offset:128
    ds_read_b64_tr_b16 v[36:37], v108 offset:1536
    ds_read_b64_tr_b16 v[38:39], v108 offset:1664
    ds_read_b64_tr_b16 v[40:41], v108 offset:3072
    ds_read_b64_tr_b16 v[42:43], v108 offset:3200
    ds_read_b64_tr_b16 v[44:45], v108 offset:4608
    ds_read_b64_tr_b16 v[46:47], v108 offset:4736
    ds_read_b64_tr_b16 v[48:49], v108 offset:6144
    ds_read_b64_tr_b16 v[50:51], v108 offset:6272
    ds_read_b64_tr_b16 v[52:53], v108 offset:7680
    ds_read_b64_tr_b16 v[54:55], v108 offset:7808
    ds_read_b64_tr_b16 v[56:57], v108 offset:9216
    ds_read_b64_tr_b16 v[58:59], v108 offset:9344
    s_waitcnt lgkmcnt(12)
    v_smfmac_f32_16x16x64_bf16 v[60:63], v[32:35], v[72:79], v1
    s_waitcnt lgkmcnt(10)
    v_smfmac_f32_16x16x64_bf16 v[60:63], v[36:39], v[80:87], v1
    s_waitcnt lgkmcnt(8)
    v_smfmac_f32_16x16x64_bf16 v[60:63], v[40:43], v[88:95], v1
    s_waitcnt lgkmcnt(6)
    v_smfmac_f32_16x16x64_bf16 v[60:63], v[44:47], v[96:103], v1
    s_waitcnt lgkmcnt(4)
    v_smfmac_f32_16x16x64_bf16 v[60:63], v[48:51], v[4:11], v1
    s_waitcnt lgkmcnt(2)
    v_smfmac_f32_16x16x64_bf16 v[60:63], v[52:55], v[12:19], v1
    s_waitcnt lgkmcnt(0)
    v_smfmac_f32_16x16x64_bf16 v[60:63], v[56:59], v[20:27], v1
    s_nop 7
    v_pk_add_f32 v[60:61], v[60:61], v[62:63]
    ds_write_b64 v113, v[60:61] offset:512
    s_waitcnt lgkmcnt(0)
    s_barrier
    v_mov_b64 v[32:33], 0
    v_mov_b64 v[34:35], 0
    v_mov_b64 v[36:37], 0
    v_mov_b64 v[38:39], 0
    v_mov_b64 v[40:41], 0
    v_mov_b64 v[42:43], 0
    v_mov_b64 v[44:45], 0
    v_mov_b64 v[46:47], 0
    v_mov_b64 v[48:49], 0
    v_mov_b64 v[50:51], 0
    v_mov_b64 v[52:53], 0
    v_mov_b64 v[54:55], 0
    v_mov_b64 v[56:57], 0
    v_mov_b64 v[58:59], 0
    v_mov_b64 v[60:61], 0
    v_mov_b64 v[62:63], 0
    s_xor_b32 s30, s30, 36864
    s_barrier
    s_cmp_ge_u32 s15, 62
    s_cbranch_scc1 A_xl_d2
    s_add_u32 m0, s30, 0
    s_add_u32 s19, s22, 0
    buffer_load_dwordx4 v104, s[4:7], s19 offen sc1 lds
    s_add_u32 m0, s30, 1024
    s_add_u32 s19, s22, 1024
    buffer_load_dwordx4 v104, s[4:7], s19 offen sc1 lds
    s_add_u32 m0, s30, 2048
    s_add_u32 s19, s22, 2048
    buffer_load_dwordx4 v104, s[4:7], s19 offen sc1 lds
    s_add_u32 m0, s30, 3072
    s_add_u32 s19, s22, 3072
    buffer_load_dwordx4 v104, s[4:7], s19 offen sc1 lds
    s_add_u32 m0, s30, 4096
    s_add_u32 s19, s22, 4096
    buffer_load_dwordx4 v104, s[4:7], s19 offen sc1 lds
    s_add_u32 m0, s30, 5120
    s_add_u32 s19, s22, 5120
    buffer_load_dwordx4 v104, s[4:7], s19 offen sc1 lds
    s_add_u32 m0, s30, 6144
    s_add_u32 s19, s22, 6144
    buffer_load_dwordx4 v104, s[4:7], s19 offen sc1 lds
    s_add_u32 m0, s30, 7168
    s_add_u32 s19, s22, 7168
    buffer_load_dwordx4 v104, s[4:7], s19 offen sc1 lds
    s_add_u32 m0, s30, 8192
    s_add_u32 s19, s22, 8192
    buffer_load_dwordx4 v104, s[4:7], s19 offen sc1 lds
    s_add_u32 m0, s30, 9216
    s_add_u32 s19, s22, 9216
    buffer_load_dwordx4 v104, s[4:7], s19 offen sc1 lds
    s_add_u32 m0, s30, 10240
    s_add_u32 s19, s22, 10240
    buffer_load_dwordx4 v104, s[4:7], s19 offen sc1 lds
    s_add_u32 m0, s30, 11264
    s_add_u32 s19, s22, 11264
    buffer_load_dwordx4 v104, s[4:7], s19 offen sc1 lds
    s_add_u32 m0, s30, 12288
    s_add_u32 s19, s22, 12288
    buffer_load_dwordx4 v104, s[4:7], s19 offen sc1 lds
    s_add_u32 m0, s30, 13312
    s_add_u32 s19, s22, 13312
    buffer_load_dwordx4 v104, s[4:7], s19 offen sc1 lds
A_xl_d2:
    s_branch A_tail
A_w3:
    s_mov_b32 s23, 65536
    buffer_load_dwordx4 v[72:75], v104, s[4:7], s20 offen offset:2048 sc1
    s_sleep 1
    s_nop 3
    s_nop 3
A_mp3:
    buffer_load_dwordx4 v[76:79], v104, s[4:7], s20 offen offset:2048 sc1
    s_waitcnt vmcnt(1)
    ds_write_b128 v105, v[72:75] offset:6144
    v_max3_u32 v2, v72, v73, v74
    v_max_u32 v2, v2, v75
    v_cmp_eq_u32 vcc, -1, v2
    s_cbranch_vccz A_mp3_ok
    buffer_load_dwordx4 v[72:75], v104, s[4:7], s20 offen offset:2048 sc1
    s_mov_b32 s90, 8
    s_sub_u32 s23, s23, 1
    s_cmp_eq_u32 s23, 0
    s_cbranch_scc1 L_abort0
    s_waitcnt vmcnt(1)
    ds_write_b128 v105, v[76:79] offset:6144
    v_max3_u32 v2, v76, v77, v78
    v_max_u32 v2, v2, v79
    v_cmp_eq_u32 vcc, -1, v2
    s_cbranch_vccnz A_mp3_b
    s_branch A_mp3_ok
A_mp3_b:
    s_branch A_mp3
A_mp3_ok:
    s_waitcnt lgkmcnt(0)
    s_barrier
    ds_read_b128 v[4:7], v106 offset:0
    ds_read_b128 v[8:11], v106 offset:1024
    ds_read_b128 v[12:15], v106 offset:2048
    ds_read_b128 v[16:19], v106 offset:3072
    ds_read_b128 v[20:23], v106 offset:4096
    ds_read_b128 v[24:27], v106 offset:5120
    ds_read_b128 v[28:31], v106 offset:6144
    s_waitcnt lgkmcnt(6)
    v_smfmac_f32_16x16x64_bf16 v[32:35], v[4:7], a[0:7], v1
    s_waitcnt lgkmcnt(5)
    v_smfmac_f32_16x16x64_bf16 v[32:35], v[8:11], a[8:15], v1
    s_waitcnt lgkmcnt(4)
    v_smfmac_f32_16x16x64_bf16 v[32:35], v[12:15], a[16:23], v1
    s_waitcnt lgkmcnt(3)
    v_smfmac_f32_16x16x64_bf16 v[32:35], v[16:19], a[24:31], v1
    s_waitcnt lgkmcnt(2)
    v_smfmac_f32_16x16x64_bf16 v[32:35], v[20:23], a[32:39], v1
    s_waitcnt lgkmcnt(1)
    v_smfmac_f32_16x16x64_bf16 v[32:35], v[24:27], a[40:47], v1
    s_waitcnt lgkmcnt(0)
    v_smfmac_f32_16x16x64_bf16 v[32:35], v[28:31], a[48:55], v1
    v_smfmac_f32_16x16x64_bf16 v[36:39], v[4:7], a[56:63], v1
    v_smfmac_f32_16x16x64_bf16 v[36:39], v[8:11], a[64:71], v1
    v_smfmac_f32_16x16x64_bf16 v[36:39], v[12:15], a[72:79], v1
    v_smfmac_f32_16x16x64_bf16 v[36:39], v[16:19], a[80:87], v1
    v_smfmac_f32_16x16x64_bf16 v[36:39], v[20:23], a[88:95], v1
    v_smfmac_f32_16x16x64_bf16 v[36:39], v[24:27], a[96:103], v1
    v_smfmac_f32_16x16x64_bf16 v[36:39], v[28:31], a[104:111], v1
    v_smfmac_f32_16x16x64_bf16 v[40:43], v[4:7], a[112:119], v1
    v_smfmac_f32_16x16x64_bf16 v[40:43], v[8:11], a[120:127], v1
    v_add_f32 v32, v32, v34
    v_smfmac_f32_16x16x64_bf16 v[40:43], v[12:15], a[128:135], v1
    v_add_f32 v33, v33, v35
    v_smfmac_f32_16x16x64_bf16 v[40:43], v[16:19], a[136:143], v1
    v_cvt_pk_bf16_f32 v114, v32, v33
    v_smfmac_f32_16x16x64_bf16 v[40:43], v[20:23], a[144:151], v1
    ds_write_b32 v107, v114 offset:0
    v_smfmac_f32_16x16x64_bf16 v[40:43], v[24:27], a[152:159], v1
    v_smfmac_f32_16x16x64_bf16 v[40:43], v[28:31], a[160:167], v1
    v_smfmac_f32_16x16x64_bf16 v[44:47], v[4:7], a[168:175], v1
    v_smfmac_f32_16x16x64_bf16 v[44:47], v[8:11], a[176:183], v1
    v_add_f32 v36, v36, v38
    v_smfmac_f32_16x16x64_bf16 v[44:47], v[12:15], a[184:191], v1
    v_add_f32 v37, v37, v39
    v_smfmac_f32_16x16x64_bf16 v[44:47], v[16:19], a[192:199], v1
    v_cvt_pk_bf16_f32 v115, v36, v37
    v_smfmac_f32_16x16x64_bf16 v[44:47], v[20:23], a[200:207], v1
    ds_write_b32 v107, v115 offset:1536
    v_smfmac_f32_16x16x64_bf16 v[44:47], v[24:27], a[208:215], v1
    v_smfmac_f32_16x16x64_bf16 v[44:47], v[28:31], a[216:223], v1
    v_smfmac_f32_16x16x64_bf16 v[48:51], v[4:7], a[224:231], v1
    v_smfmac_f32_16x16x64_bf16 v[48:51], v[8:11], a[232:239], v1
    v_add_f32 v40, v40, v42
    v_smfmac_f32_16x16x64_bf16 v[48:51], v[12:15], a[240:247], v1
    v_add_f32 v41, v41, v43
    v_smfmac_f32_16x16x64_bf16 v[48:51], v[16:19], a[248:255], v1
    v_cvt_pk_bf16_f32 v114, v40, v41
    v_smfmac_f32_16x16x64_bf16 v[48:51], v[20:23], v[120:127], v1
    ds_write_b32 v107, v114 offset:3072
    v_smfmac_f32_16x16x64_bf16 v[48:51], v[24:27], v[128:135], v1
    v_smfmac_f32_16x16x64_bf16 v[48:51], v[28:31], v[136:143], v1
    v_smfmac_f32_16x16x64_bf16 v[52:55], v[4:7], v[144:151], v1
    v_smfmac_f32_16x16x64_bf16 v[52:55], v[8:11], v[152:159], v1
    v_add_f32 v44, v44, v46
    v_smfmac_f32_16x16x64_bf16 v[52:55], v[12:15], v[160:167], v1
    v_add_f32 v45, v45, v47
    v_smfmac_f32_16x16x64_bf16 v[52:55], v[16:19], v[168:175], v1
    v_cvt_pk_bf16_f32 v115, v44, v45
    v_smfmac_f32_16x16x64_bf16 v[52:55], v[20:23], v[176:183], v1
    ds_write_b32 v107, v115 offset:4608
    v_smfmac_f32_16x16x64_bf16 v[52:55], v[24:27], v[184:191], v1
    v_smfmac_f32_16x16x64_bf16 v[52:55], v[28:31], v[192:199], v1
    v_smfmac_f32_16x16x64_bf16 v[56:59], v[4:7], v[200:207], v1
    v_smfmac_f32_16x16x64_bf16 v[56:59], v[8:11], v[208:215], v1
    v_add_f32 v48, v48, v50
    v_smfmac_f32_16x16x64_bf16 v[56:59], v[12:15], v[216:223], v1
    v_add_f32 v49, v49, v51
    v_smfmac_f32_16x16x64_bf16 v[56:59], v[16:19], v[224:231], v1
    v_cvt_pk_bf16_f32 v114, v48, v49
    v_smfmac_f32_16x16x64_bf16 v[56:59], v[20:23], v[232:239], v1
    ds_write_b32 v107, v114 offset:6144
    v_smfmac_f32_16x16x64_bf16 v[56:59], v[24:27], v[240:247], v1
    v_smfmac_f32_16x16x64_bf16 v[56:59], v[28:31], v[248:255], v1
    v_add_f32 v52, v52, v54
    v_add_f32 v53, v53, v55
    v_cvt_pk_bf16_f32 v115, v52, v53
    ds_write_b32 v107, v115 offset:7680
    s_nop 3
    v_add_f32 v56, v56, v58
    v_add_f32 v57, v57, v59
    v_cvt_pk_bf16_f32 v114, v56, v57
    ds_write_b32 v107, v114 offset:9216
    s_waitcnt lgkmcnt(0)
    s_barrier
    s_barrier
    v_mov_b64 v[32:33], 0
    v_mov_b64 v[34:35], 0
    v_mov_b64 v[36:37], 0
    v_mov_b64 v[38:39], 0
    v_mov_b64 v[40:41], 0
    v_mov_b64 v[42:43], 0
    v_mov_b64 v[44:45], 0
    v_mov_b64 v[46:47], 0
    v_mov_b64 v[48:49], 0
    v_mov_b64 v[50:51], 0
    v_mov_b64 v[52:53], 0
    v_mov_b64 v[54:55], 0
    v_mov_b64 v[56:57], 0
    v_mov_b64 v[58:59], 0
    s_xor_b32 s30, s30, 36864
    s_barrier
    s_cmp_ge_u32 s15, 62
    s_cbranch_scc1 A_xl_d3
    s_add_u32 m0, s30, 14336
    s_add_u32 s19, s22, 14336
    buffer_load_dwordx4 v104, s[4:7], s19 offen sc1 lds
    s_add_u32 m0, s30, 15360
    s_add_u32 s19, s22, 15360
    buffer_load_dwordx4 v104, s[4:7], s19 offen sc1 lds
    s_add_u32 m0, s30, 16384
    s_add_u32 s19, s22, 16384
    buffer_load_dwordx4 v104, s[4:7], s19 offen sc1 lds
    s_add_u32 m0, s30, 17408
    s_add_u32 s19, s22, 17408
    buffer_load_dwordx4 v104, s[4:7], s19 offen sc1 lds
    s_add_u32 m0, s30, 18432
    s_add_u32 s19, s22, 18432
    buffer_load_dwordx4 v104, s[4:7], s19 offen sc1 lds
    s_add_u32 m0, s30, 19456
    s_add_u32 s19, s22, 19456
    buffer_load_dwordx4 v104, s[4:7], s19 offen sc1 lds
    s_add_u32 m0, s30, 20480
    s_add_u32 s19, s22, 20480
    buffer_load_dwordx4 v104, s[4:7], s19 offen sc1 lds
    s_add_u32 m0, s30, 21504
    s_add_u32 s19, s22, 21504
    buffer_load_dwordx4 v104, s[4:7], s19 offen sc1 lds
    s_add_u32 m0, s30, 22528
    s_add_u32 s19, s22, 22528
    buffer_load_dwordx4 v104, s[4:7], s19 offen sc1 lds
    s_add_u32 m0, s30, 23552
    s_add_u32 s19, s22, 23552
    buffer_load_dwordx4 v104, s[4:7], s19 offen sc1 lds
    s_add_u32 m0, s30, 24576
    s_add_u32 s19, s22, 24576
    buffer_load_dwordx4 v104, s[4:7], s19 offen sc1 lds
    s_add_u32 m0, s30, 25600
    s_add_u32 s19, s22, 25600
    buffer_load_dwordx4 v104, s[4:7], s19 offen sc1 lds
    s_add_u32 m0, s30, 26624
    s_add_u32 s19, s22, 26624
    buffer_load_dwordx4 v104, s[4:7], s19 offen sc1 lds
    s_add_u32 m0, s30, 27648
    s_add_u32 s19, s22, 27648
    buffer_load_dwordx4 v104, s[4:7], s19 offen sc1 lds
A_xl_d3:
A_tail:
    s_add_u32 s15, s15, 1
    s_add_u32 s16, s16, 8192
    s_add_u32 s17, s17, 10240
    s_add_u32 s22, s22, 28672
    s_cmp_ge_u32 s15, 63
    s_cbranch_scc1 A_end
    s_sleep 13
    s_branch A_loop
A_end:
    s_barrier
    s_add_u32 s65, s65, 1
    s_cmp_lt_u32 s65, 2
    s_cbranch_scc1 A_layer
    s_endpgm
C_roleB:
    s_sub_u32 s13, s13, 16
    v_accvgpr_read_b32 v0, a255
    v_and_b32 v0, 63, v0
    v_and_b32 v88, 2, v0
    v_cmp_ne_u32 vcc, 0, v88
    v_mov_b32 v1, 0x4444
    v_mov_b32 v88, 0xeeee
    v_cndmask_b32 v1, v1, v88, vcc
    v_lshlrev_b32 v108, 4, v0
    v_bfe_u32 v88, v0, 3, 2
    v_lshlrev_b32 v109, 8, v88
    v_bfe_u32 v88, v0, 1, 2
    v_lshl_add_u32 v109, v88, 6, v109
    v_lshrrev_b32 v88, 5, v0
    v_lshl_add_u32 v109, v88, 5, v109
    v_and_b32 v88, 1, v0
    v_lshl_add_u32 v109, v88, 4, v109
    v_add_u32 v109, 0, v109
    v_add_u32 v112, 0, v108
    s_mul_i32 s18, s14, 14336
    s_add_u32 s18, s18, 16384
    v_add_u32 v113, s18, v108
    v_bfe_u32 v88, v0, 2, 2
    v_lshlrev_b32 v88, 1, v88
    v_and_b32 v89, 1, v0
    v_or_b32 v88, v88, v89
    v_bfe_u32 v89, v0, 1, 1
    v_lshrrev_b32 v90, 4, v0
    s_mul_i32 s18, s14, 2560
    v_add_u32 v114, s18, v108
    v_lshlrev_b32 v115, 2, v0
    s_add_u32 s18, s18, 2048
    v_add_u32 v115, s18, v115
    v_mul_u32_u24 v116, 320, v90
    v_and_b32 v92, 15, v0
    v_lshl_add_u32 v116, v92, 2, v116
    s_mul_i32 s18, s14, 1280
    s_add_u32 s18, s18, 8192
    v_add_u32 v116, s18, v116
    v_bfe_u32 v91, v0, 1, 3
    v_mul_u32_u24 v117, 160, v91
    v_lshl_add_u32 v117, v90, 5, v117
    v_and_b32 v92, 1, v0
    v_lshl_add_u32 v117, v92, 4, v117
    v_add_u32 v117, 8192, v117
    v_lshlrev_b32 v119, 7, v90
    v_lshl_add_u32 v119, v91, 4, v119
    v_lshl_add_u32 v119, v92, 3, v119
    s_lshl_b32 s18, s13, 9
    v_add_u32 v119, s18, v119
    v_mul_u32_u24 v3, 896, v91
    v_lshl_add_u32 v3, v90, 4, v3
    v_lshl_add_u32 v3, v92, 3, v3
    s_lshl_b32 s18, s13, 6
    v_add_u32 v3, s18, v3
    s_lshl_b32 s18, s13, 2
    s_add_u32 s18, s18, s14
    s_mul_i32 s18, s18, 114688
    s_add_u32 s18, s18, 6422528
    s_mul_i32 s20, s14, 14336
    s_add_u32 s20, s20, 16384
    s_cmp_eq_u32 s76, 0
    s_cbranch_scc0 B_wprep0_ok
    v_mbcnt_lo_u32_b32 v88, -1, 0
    v_mbcnt_hi_u32_b32 v88, -1, v88
    v_add_u32 v89, 0, v88
    v_min_u32 v89, 127, v89
    v_lshlrev_b32 v89, 4, v89
    v_add_u32 v90, 64, v88
    v_min_u32 v90, 127, v90
    v_lshlrev_b32 v90, 4, v90
    s_mov_b32 s53, 78622720
    s_mov_b32 s54, 1048576
B_wprep0:
    buffer_load_dword v91, v89, s[4:7], s53 offen sc1
    buffer_load_dword v92, v90, s[4:7], s53 offen sc1
    s_mov_b32 s90, 9
    s_sub_u32 s54, s54, 1
    s_cmp_eq_u32 s54, 0
    s_cbranch_scc1 L_abort0
    s_waitcnt vmcnt(0)
    v_and_b32 v91, v91, v92
    v_cmp_ne_u32 vcc, 1, v91
    s_cbranch_vccz B_wprep0_ok
    s_sleep 8
    s_branch B_wprep0
B_wprep0_ok:
    s_barrier
    s_add_u32 s19, s18, 0
    buffer_load_dwordx4 a[0:3], v108, s[56:59], s19 offen sc1
    buffer_load_dwordx4 a[4:7], v108, s[56:59], s19 offen offset:1024 sc1
    s_add_u32 s19, s18, 2048
    buffer_load_dwordx4 a[8:11], v108, s[56:59], s19 offen sc1
    buffer_load_dwordx4 a[12:15], v108, s[56:59], s19 offen offset:1024 sc1
    s_add_u32 s19, s18, 4096
    buffer_load_dwordx4 a[16:19], v108, s[56:59], s19 offen sc1
    buffer_load_dwordx4 a[20:23], v108, s[56:59], s19 offen offset:1024 sc1
    s_add_u32 s19, s18, 6144
    buffer_load_dwordx4 a[24:27], v108, s[56:59], s19 offen sc1
    buffer_load_dwordx4 a[28:31], v108, s[56:59], s19 offen offset:1024 sc1
    s_add_u32 s19, s18, 14336
    buffer_load_dwordx4 a[56:59], v108, s[56:59], s19 offen sc1
    buffer_load_dwordx4 a[60:63], v108, s[56:59], s19 offen offset:1024 sc1
    s_add_u32 s19, s18, 16384
    buffer_load_dwordx4 a[64:67], v108, s[56:59], s19 offen sc1
    buffer_load_dwordx4 a[68:71], v108, s[56:59], s19 offen offset:1024 sc1
    s_add_u32 s19, s18, 18432
    buffer_load_dwordx4 a[72:75], v108, s[56:59], s19 offen sc1
    buffer_load_dwordx4 a[76:79], v108, s[56:59], s19 offen offset:1024 sc1
    s_add_u32 s19, s18, 20480
    buffer_load_dwordx4 a[80:83], v108, s[56:59], s19 offen sc1
    buffer_load_dwordx4 a[84:87], v108, s[56:59], s19 offen offset:1024 sc1
    s_add_u32 s19, s18, 28672
    buffer_load_dwordx4 a[112:115], v108, s[56:59], s19 offen sc1
    buffer_load_dwordx4 a[116:119], v108, s[56:59], s19 offen offset:1024 sc1
    s_add_u32 s19, s18, 30720
    buffer_load_dwordx4 a[120:123], v108, s[56:59], s19 offen sc1
    buffer_load_dwordx4 a[124:127], v108, s[56:59], s19 offen offset:1024 sc1
    s_add_u32 s19, s18, 32768
    buffer_load_dwordx4 a[128:131], v108, s[56:59], s19 offen sc1
    buffer_load_dwordx4 a[132:135], v108, s[56:59], s19 offen offset:1024 sc1
    s_add_u32 s19, s18, 34816
    buffer_load_dwordx4 a[136:139], v108, s[56:59], s19 offen sc1
    buffer_load_dwordx4 a[140:143], v108, s[56:59], s19 offen offset:1024 sc1
    s_add_u32 s19, s18, 43008
    buffer_load_dwordx4 a[168:171], v108, s[56:59], s19 offen sc1
    buffer_load_dwordx4 a[172:175], v108, s[56:59], s19 offen offset:1024 sc1
    s_add_u32 s19, s18, 45056
    buffer_load_dwordx4 a[176:179], v108, s[56:59], s19 offen sc1
    buffer_load_dwordx4 a[180:183], v108, s[56:59], s19 offen offset:1024 sc1
    s_add_u32 s19, s18, 47104
    buffer_load_dwordx4 a[184:187], v108, s[56:59], s19 offen sc1
    buffer_load_dwordx4 a[188:191], v108, s[56:59], s19 offen offset:1024 sc1
    s_add_u32 s19, s18, 49152
    buffer_load_dwordx4 a[192:195], v108, s[56:59], s19 offen sc1
    buffer_load_dwordx4 a[196:199], v108, s[56:59], s19 offen offset:1024 sc1
    s_waitcnt vmcnt(32)
    s_add_u32 s19, s18, 57344
    buffer_load_dwordx4 a[224:227], v108, s[56:59], s19 offen sc1
    buffer_load_dwordx4 a[228:231], v108, s[56:59], s19 offen offset:1024 sc1
    s_add_u32 s19, s18, 59392
    buffer_load_dwordx4 a[232:235], v108, s[56:59], s19 offen sc1
    buffer_load_dwordx4 a[236:239], v108, s[56:59], s19 offen offset:1024 sc1
    s_add_u32 s19, s18, 61440
    buffer_load_dwordx4 a[240:243], v108, s[56:59], s19 offen sc1
    buffer_load_dwordx4 a[244:247], v108, s[56:59], s19 offen offset:1024 sc1
    s_add_u32 s19, s18, 63488
    buffer_load_dwordx4 a[248:251], v108, s[56:59], s19 offen sc1
    buffer_load_dwordx4 a[252:255], v108, s[56:59], s19 offen offset:1024 sc1
    s_add_u32 s19, s18, 71680
    buffer_load_dwordx4 v[144:147], v108, s[56:59], s19 offen sc1
    buffer_load_dwordx4 v[148:151], v108, s[56:59], s19 offen offset:1024 sc1
    s_add_u32 s19, s18, 73728
    buffer_load_dwordx4 v[152:155], v108, s[56:59], s19 offen sc1
    buffer_load_dwordx4 v[156:159], v108, s[56:59], s19 offen offset:1024 sc1
    s_add_u32 s19, s18, 75776
    buffer_load_dwordx4 v[160:163], v108, s[56:59], s19 offen sc1
    buffer_load_dwordx4 v[164:167], v108, s[56:59], s19 offen offset:1024 sc1
    s_add_u32 s19, s18, 77824
    buffer_load_dwordx4 v[168:171], v108, s[56:59], s19 offen sc1
    buffer_load_dwordx4 v[172:175], v108, s[56:59], s19 offen offset:1024 sc1
    s_add_u32 s19, s18, 86016
    buffer_load_dwordx4 v[200:203], v108, s[56:59], s19 offen sc1
    buffer_load_dwordx4 v[204:207], v108, s[56:59], s19 offen offset:1024 sc1
    s_add_u32 s19, s18, 88064
    buffer_load_dwordx4 v[208:211], v108, s[56:59], s19 offen sc1
    buffer_load_dwordx4 v[212:215], v108, s[56:59], s19 offen offset:1024 sc1
    s_add_u32 s19, s18, 90112
    buffer_load_dwordx4 v[216:219], v108, s[56:59], s19 offen sc1
    buffer_load_dwordx4 v[220:223], v108, s[56:59], s19 offen offset:1024 sc1
    s_add_u32 s19, s18, 92160
    buffer_load_dwordx4 v[224:227], v108, s[56:59], s19 offen sc1
    buffer_load_dwordx4 v[228:231], v108, s[56:59], s19 offen offset:1024 sc1
    s_add_u32 s19, s18, 100352
    s_add_u32 m0, s20, 0
    s_add_u32 s21, s19, 0
    buffer_load_dwordx4 v108, s[56:59], s21 offen sc1 lds
    s_add_u32 m0, s20, 1024
    s_add_u32 s21, s19, 1024
    buffer_load_dwordx4 v108, s[56:59], s21 offen sc1 lds
    s_add_u32 s19, s18, 102400
    s_add_u32 m0, s20, 2048
    s_add_u32 s21, s19, 0
    buffer_load_dwordx4 v108, s[56:59], s21 offen sc1 lds
    s_add_u32 m0, s20, 3072
    s_add_u32 s21, s19, 1024
    buffer_load_dwordx4 v108, s[56:59], s21 offen sc1 lds
    s_add_u32 s19, s18, 104448
    s_add_u32 m0, s20, 4096
    s_add_u32 s21, s19, 0
    buffer_load_dwordx4 v108, s[56:59], s21 offen sc1 lds
    s_add_u32 m0, s20, 5120
    s_add_u32 s21, s19, 1024
    buffer_load_dwordx4 v108, s[56:59], s21 offen sc1 lds
    s_add_u32 s19, s18, 106496
    s_add_u32 m0, s20, 6144
    s_add_u32 s21, s19, 0
    buffer_load_dwordx4 v108, s[56:59], s21 offen sc1 lds
    s_add_u32 m0, s20, 7168
    s_add_u32 s21, s19, 1024
    buffer_load_dwordx4 v108, s[56:59], s21 offen sc1 lds
    s_waitcnt vmcnt(32)
    s_cmp_eq_u32 s76, 0
    s_cbranch_scc0 B_wprep1_ok
    v_mbcnt_lo_u32_b32 v88, -1, 0
    v_mbcnt_hi_u32_b32 v88, -1, v88
    v_add_u32 v89, 0, v88
    v_min_u32 v89, 95, v89
    v_lshlrev_b32 v89, 4, v89
    v_add_u32 v90, 64, v88
    v_min_u32 v90, 95, v90
    v_lshlrev_b32 v90, 4, v90
    s_mov_b32 s53, 78647296
    s_mov_b32 s54, 1048576
B_wprep1:
    buffer_load_dword v91, v89, s[4:7], s53 offen sc1
    buffer_load_dword v92, v90, s[4:7], s53 offen sc1
    s_mov_b32 s90, 10
    s_sub_u32 s54, s54, 1
    s_cmp_eq_u32 s54, 0
    s_cbranch_scc1 L_abort0
    s_waitcnt vmcnt(0)
    v_and_b32 v91, v91, v92
    v_cmp_ne_u32 vcc, 1, v91
    s_cbranch_vccz B_wprep1_ok
    s_sleep 8
    s_branch B_wprep1
B_wprep1_ok:
    s_barrier
    s_add_u32 s19, s18, 8192
    buffer_load_dwordx4 a[32:35], v108, s[56:59], s19 offen sc1
    buffer_load_dwordx4 a[36:39], v108, s[56:59], s19 offen offset:1024 sc1
    s_add_u32 s19, s18, 10240
    buffer_load_dwordx4 a[40:43], v108, s[56:59], s19 offen sc1
    buffer_load_dwordx4 a[44:47], v108, s[56:59], s19 offen offset:1024 sc1
    s_add_u32 s19, s18, 12288
    buffer_load_dwordx4 a[48:51], v108, s[56:59], s19 offen sc1
    buffer_load_dwordx4 a[52:55], v108, s[56:59], s19 offen offset:1024 sc1
    s_add_u32 s19, s18, 22528
    buffer_load_dwordx4 a[88:91], v108, s[56:59], s19 offen sc1
    buffer_load_dwordx4 a[92:95], v108, s[56:59], s19 offen offset:1024 sc1
    s_add_u32 s19, s18, 24576
    buffer_load_dwordx4 a[96:99], v108, s[56:59], s19 offen sc1
    buffer_load_dwordx4 a[100:103], v108, s[56:59], s19 offen offset:1024 sc1
    s_add_u32 s19, s18, 26624
    buffer_load_dwordx4 a[104:107], v108, s[56:59], s19 offen sc1
    buffer_load_dwordx4 a[108:111], v108, s[56:59], s19 offen offset:1024 sc1
    s_add_u32 s19, s18, 36864
    buffer_load_dwordx4 a[144:147], v108, s[56:59], s19 offen sc1
    buffer_load_dwordx4 a[148:151], v108, s[56:59], s19 offen offset:1024 sc1
    s_add_u32 s19, s18, 38912
    buffer_load_dwordx4 a[152:155], v108, s[56:59], s19 offen sc1
    buffer_load_dwordx4 a[156:159], v108, s[56:59], s19 offen offset:1024 sc1
    s_add_u32 s19, s18, 40960
    buffer_load_dwordx4 a[160:163], v108, s[56:59], s19 offen sc1
    buffer_load_dwordx4 a[164:167], v108, s[56:59], s19 offen offset:1024 sc1
    s_add_u32 s19, s18, 51200
    buffer_load_dwordx4 a[200:203], v108, s[56:59], s19 offen sc1
    buffer_load_dwordx4 a[204:207], v108, s[56:59], s19 offen offset:1024 sc1
    s_add_u32 s19, s18, 53248
    buffer_load_dwordx4 a[208:211], v108, s[56:59], s19 offen sc1
    buffer_load_dwordx4 a[212:215], v108, s[56:59], s19 offen offset:1024 sc1
    s_add_u32 s19, s18, 55296
    buffer_load_dwordx4 a[216:219], v108, s[56:59], s19 offen sc1
    buffer_load_dwordx4 a[220:223], v108, s[56:59], s19 offen offset:1024 sc1
    s_add_u32 s19, s18, 65536
    buffer_load_dwordx4 v[120:123], v108, s[56:59], s19 offen sc1
    buffer_load_dwordx4 v[124:127], v108, s[56:59], s19 offen offset:1024 sc1
    s_add_u32 s19, s18, 67584
    buffer_load_dwordx4 v[128:131], v108, s[56:59], s19 offen sc1
    buffer_load_dwordx4 v[132:135], v108, s[56:59], s19 offen offset:1024 sc1
    s_add_u32 s19, s18, 69632
    buffer_load_dwordx4 v[136:139], v108, s[56:59], s19 offen sc1
    buffer_load_dwordx4 v[140:143], v108, s[56:59], s19 offen offset:1024 sc1
    s_add_u32 s19, s18, 79872
    buffer_load_dwordx4 v[176:179], v108, s[56:59], s19 offen sc1
    buffer_load_dwordx4 v[180:183], v108, s[56:59], s19 offen offset:1024 sc1
    s_waitcnt vmcnt(32)
    s_add_u32 s19, s18, 81920
    buffer_load_dwordx4 v[184:187], v108, s[56:59], s19 offen sc1
    buffer_load_dwordx4 v[188:191], v108, s[56:59], s19 offen offset:1024 sc1
    s_add_u32 s19, s18, 83968
    buffer_load_dwordx4 v[192:195], v108, s[56:59], s19 offen sc1
    buffer_load_dwordx4 v[196:199], v108, s[56:59], s19 offen offset:1024 sc1
    s_add_u32 s19, s18, 94208
    buffer_load_dwordx4 v[232:235], v108, s[56:59], s19 offen sc1
    buffer_load_dwordx4 v[236:239], v108, s[56:59], s19 offen offset:1024 sc1
    s_add_u32 s19, s18, 96256
    buffer_load_dwordx4 v[240:243], v108, s[56:59], s19 offen sc1
    buffer_load_dwordx4 v[244:247], v108, s[56:59], s19 offen offset:1024 sc1
    s_add_u32 s19, s18, 98304
    buffer_load_dwordx4 v[248:251], v108, s[56:59], s19 offen sc1
    buffer_load_dwordx4 v[252:255], v108, s[56:59], s19 offen offset:1024 sc1
    s_add_u32 s19, s18, 108544
    s_add_u32 m0, s20, 8192
    s_add_u32 s21, s19, 0
    buffer_load_dwordx4 v108, s[56:59], s21 offen sc1 lds
    s_add_u32 m0, s20, 9216
    s_add_u32 s21, s19, 1024
    buffer_load_dwordx4 v108, s[56:59], s21 offen sc1 lds
    s_add_u32 s19, s18, 110592
    s_add_u32 m0, s20, 10240
    s_add_u32 s21, s19, 0
    buffer_load_dwordx4 v108, s[56:59], s21 offen sc1 lds
    s_add_u32 m0, s20, 11264
    s_add_u32 s21, s19, 1024
    buffer_load_dwordx4 v108, s[56:59], s21 offen sc1 lds
    s_add_u32 s19, s18, 112640
    s_add_u32 m0, s20, 12288
    s_add_u32 s21, s19, 0
    buffer_load_dwordx4 v108, s[56:59], s21 offen sc1 lds
    s_add_u32 m0, s20, 13312
    s_add_u32 s21, s19, 1024
    buffer_load_dwordx4 v108, s[56:59], s21 offen sc1 lds
    s_waitcnt vmcnt(0)
    s_cmp_eq_u32 s76, 0
    s_cbranch_scc0 B_wfill_ok
    v_mbcnt_lo_u32_b32 v88, -1, 0
    v_mbcnt_hi_u32_b32 v88, -1, v88
    v_add_u32 v89, 0, v88
    v_min_u32 v89, 14, v89
    v_lshlrev_b32 v89, 4, v89
    s_mov_b32 s53, 78639104
    s_mov_b32 s54, 1048576
B_wfill:
    buffer_load_dword v90, v89, s[4:7], s53 offen sc1
    s_mov_b32 s90, 11
    s_sub_u32 s54, s54, 1
    s_cmp_eq_u32 s54, 0
    s_cbranch_scc1 L_abort0
    s_waitcnt vmcnt(0)
    v_cmp_ne_u32 vcc, 1, v90
    s_cbranch_vccz B_wfill_ok
    s_sleep 8
    s_branch B_wfill
B_wfill_ok:
    s_barrier
    s_add_u32 s84, s13, 16
B_layer:
    s_mul_i32 s53, s65, 79691776
    s_add_u32 s53, s53, 30408704
    s_add_u32 s4, s68, s53
    s_addc_u32 s5, s69, 0
    s_and_b32 s5, s5, 0xffff
    s_mov_b32 s6, 79691776
    s_mov_b32 s7, 0x20000
    s_mov_b32 s15, 0
    s_mov_b32 s16, 2064384
    s_mov_b32 s17, 2621440
    s_lshl_b32 s18, s13, 2
    s_add_u32 s18, s18, s14
    s_lshl_b32 s27, s18, 13
    s_add_u32 s27, s27, 11112448
    s_lshl_b32 s28, s18, 11
    s_add_u32 s28, s28, 3194880
    s_mov_b32 s29, 10649600
    s_mov_b32 s37, 78483456
    s_lshl_b32 s39, s13, 7
    s_add_u32 s39, s39, 78614528
    v_mov_b64 v[32:33], 0
    v_mov_b64 v[34:35], 0
    v_mov_b64 v[36:37], 0
    v_mov_b64 v[38:39], 0
    v_mov_b64 v[40:41], 0
    v_mov_b64 v[42:43], 0
    v_mov_b64 v[44:45], 0
    v_mov_b64 v[46:47], 0
    v_mov_b64 v[104:105], 0
    v_mov_b64 v[106:107], 0
    s_waitcnt vmcnt(0)
    s_add_u32 s25, s37, 135168
    s_mov_b32 s24, 0
    s_barrier
B_loop:
    s_add_u32 s20, s16, 4096
    s_cmp_eq_u32 s14, 0
    s_cbranch_scc0 B_mw0
    s_mov_b32 s23, 65536
B_mp0:
    buffer_load_dwordx4 v[88:91], v108, s[4:7], s16 offen offset:0 sc1
    buffer_load_dwordx4 v[92:95], v108, s[4:7], s16 offen offset:1024 sc1
    s_mov_b32 s90, 12
    s_sub_u32 s23, s23, 1
    s_cmp_eq_u32 s23, 0
    s_cbranch_scc1 L_abort0
    s_waitcnt vmcnt(1)
    ds_write_b128 v109, v[88:91] offset:0
    s_waitcnt vmcnt(0)
    ds_write_b128 v109, v[92:95] offset:1024
    v_max3_u32 v96, v88, v89, v90
    v_max3_u32 v96, v96, v91, v92
    v_max3_u32 v96, v96, v93, v94
    v_max_u32 v96, v96, v95
    v_cmp_eq_u32 vcc, -1, v96
    s_cbranch_vccnz B_mp0
    s_waitcnt lgkmcnt(0)
    s_branch B_mdone
B_mw0:
    s_cmp_eq_u32 s14, 1
    s_cbranch_scc0 B_mw1
    s_mov_b32 s23, 65536
B_mp1:
    buffer_load_dwordx4 v[88:91], v108, s[4:7], s16 offen offset:2048 sc1
    buffer_load_dwordx4 v[92:95], v108, s[4:7], s16 offen offset:3072 sc1
    s_mov_b32 s90, 13
    s_sub_u32 s23, s23, 1
    s_cmp_eq_u32 s23, 0
    s_cbranch_scc1 L_abort0
    s_waitcnt vmcnt(1)
    ds_write_b128 v109, v[88:91] offset:2048
    s_waitcnt vmcnt(0)
    ds_write_b128 v109, v[92:95] offset:3072
    v_max3_u32 v96, v88, v89, v90
    v_max3_u32 v96, v96, v91, v92
    v_max3_u32 v96, v96, v93, v94
    v_max_u32 v96, v96, v95
    v_cmp_eq_u32 vcc, -1, v96
    s_cbranch_vccnz B_mp1
    s_waitcnt lgkmcnt(0)
    s_branch B_mdone
B_mw1:
    s_cmp_eq_u32 s14, 2
    s_cbranch_scc0 B_mw2
    s_mov_b32 s23, 65536
B_mp2:
    buffer_load_dwordx4 v[88:91], v108, s[4:7], s20 offen offset:0 sc1
    buffer_load_dwordx4 v[92:95], v108, s[4:7], s20 offen offset:1024 sc1
    s_mov_b32 s90, 14
    s_sub_u32 s23, s23, 1
    s_cmp_eq_u32 s23, 0
    s_cbranch_scc1 L_abort0
    s_waitcnt vmcnt(1)
    ds_write_b128 v109, v[88:91] offset:4096
    s_waitcnt vmcnt(0)
    ds_write_b128 v109, v[92:95] offset:5120
    v_max3_u32 v96, v88, v89, v90
    v_max3_u32 v96, v96, v91, v92
    v_max3_u32 v96, v96, v93, v94
    v_max_u32 v96, v96, v95
    v_cmp_eq_u32 vcc, -1, v96
    s_cbranch_vccnz B_mp2
    s_waitcnt lgkmcnt(0)
    s_branch B_mdone
B_mw2:
    s_cmp_eq_u32 s14, 3
    s_cbranch_scc0 B_mw3
    s_mov_b32 s23, 65536
B_mp3:
    buffer_load_dwordx4 v[88:91], v108, s[4:7], s20 offen offset:2048 sc1
    s_mov_b32 s90, 15
    s_sub_u32 s23, s23, 1
    s_cmp_eq_u32 s23, 0
    s_cbranch_scc1 L_abort0
    s_waitcnt vmcnt(0)
    ds_write_b128 v109, v[88:91] offset:6144
    v_max3_u32 v96, v88, v89, v90
    v_max_u32 v96, v96, v91
    v_cmp_eq_u32 vcc, -1, v96
    s_cbranch_vccnz B_mp3
    s_waitcnt lgkmcnt(0)
B_mw3:
B_mdone:
    s_barrier
    ds_read_b128 v[4:7], v112 offset:0
    ds_read_b128 v[8:11], v112 offset:1024
    ds_read_b128 v[12:15], v112 offset:2048
    ds_read_b128 v[16:19], v112 offset:3072
    ds_read_b128 v[20:23], v112 offset:4096
    ds_read_b128 v[24:27], v112 offset:5120
    ds_read_b128 v[28:31], v112 offset:6144
    ds_read_b128 v[88:91], v113 offset:0
    ds_read_b128 v[92:95], v113 offset:1024
    s_cmp_eq_u32 s15, 0
    s_cbranch_scc1 B_nopub
    buffer_store_dwordx4 v[48:51], v108, s[4:7], s28 offen sc1
    buffer_store_dwordx4 v[52:55], v108, s[4:7], s28 offen offset:1024 sc1
    s_cmp_eq_u32 s14, 0
    s_cbranch_scc0 B_nopub
    buffer_store_dwordx2 v[110:111], v119, s[4:7], s29 offen sc1
B_nopub:
    s_add_u32 s18, s15, 1
    s_cmp_ge_u32 s24, s18
    s_cselect_b32 s34, 1, 0
    s_add_u32 s19, s27, 4096
    s_cmp_eq_u32 s34, 1
    s_waitcnt lgkmcnt(8)
    v_smfmac_f32_16x16x64_bf16 v[32:35], v[4:7], a[0:7], v1
    s_waitcnt lgkmcnt(7)
    v_smfmac_f32_16x16x64_bf16 v[32:35], v[8:11], a[8:15], v1
    s_waitcnt lgkmcnt(6)
    v_smfmac_f32_16x16x64_bf16 v[32:35], v[12:15], a[16:23], v1
    s_cbranch_scc0 B_vs1
    buffer_load_dwordx4 v[56:59], v108, s[4:7], s27 offen offset:0 sc1
B_vs1:
    s_waitcnt lgkmcnt(5)
    v_smfmac_f32_16x16x64_bf16 v[32:35], v[16:19], a[24:31], v1
    s_cbranch_scc0 B_vs2
    buffer_load_dwordx4 v[60:63], v108, s[4:7], s27 offen offset:1024 sc1
B_vs2:
    s_waitcnt lgkmcnt(4)
    v_smfmac_f32_16x16x64_bf16 v[32:35], v[20:23], a[32:39], v1
    s_cbranch_scc0 B_vs3
    buffer_load_dwordx4 v[64:67], v108, s[4:7], s27 offen offset:2048 sc1
B_vs3:
    s_waitcnt lgkmcnt(3)
    v_smfmac_f32_16x16x64_bf16 v[32:35], v[24:27], a[40:47], v1
    s_cbranch_scc0 B_vs4
    buffer_load_dwordx4 v[68:71], v108, s[4:7], s27 offen offset:3072 sc1
B_vs4:
    s_waitcnt lgkmcnt(2)
    v_smfmac_f32_16x16x64_bf16 v[32:35], v[28:31], a[48:55], v1
    s_cbranch_scc0 B_vs5
    buffer_load_dwordx4 v[72:75], v108, s[4:7], s19 offen offset:0 sc1
B_vs5:
    s_waitcnt lgkmcnt(0)
    v_smfmac_f32_16x16x64_bf16 v[104:107], v[4:7], v[88:95], v1
    ds_read_b128 v[96:99], v113 offset:2048
    ds_read_b128 v[100:103], v113 offset:3072
    v_smfmac_f32_16x16x64_bf16 v[36:39], v[4:7], a[56:63], v1
    v_smfmac_f32_16x16x64_bf16 v[36:39], v[8:11], a[64:71], v1
    v_smfmac_f32_16x16x64_bf16 v[36:39], v[12:15], a[72:79], v1
    s_cbranch_scc0 B_vs6
    buffer_load_dwordx4 v[76:79], v108, s[4:7], s19 offen offset:1024 sc1
B_vs6:
    v_smfmac_f32_16x16x64_bf16 v[36:39], v[16:19], a[80:87], v1
    s_cbranch_scc0 B_vs7
    buffer_load_dwordx4 v[80:83], v108, s[4:7], s19 offen offset:2048 sc1
B_vs7:
    v_smfmac_f32_16x16x64_bf16 v[36:39], v[20:23], a[88:95], v1
    s_cbranch_scc0 B_vs8
    buffer_load_dwordx4 v[84:87], v108, s[4:7], s19 offen offset:3072 sc1
B_vs8:
    v_smfmac_f32_16x16x64_bf16 v[36:39], v[24:27], a[96:103], v1
    v_smfmac_f32_16x16x64_bf16 v[36:39], v[28:31], a[104:111], v1
    s_waitcnt lgkmcnt(0)
    v_smfmac_f32_16x16x64_bf16 v[104:107], v[8:11], v[96:103], v1
    ds_read_b128 v[88:91], v113 offset:4096
    ds_read_b128 v[92:95], v113 offset:5120
    v_smfmac_f32_16x16x64_bf16 v[40:43], v[4:7], a[112:119], v1
    v_add_f32 v32, v32, v34
    v_smfmac_f32_16x16x64_bf16 v[40:43], v[8:11], a[120:127], v1
    v_add_f32 v33, v33, v35
    v_smfmac_f32_16x16x64_bf16 v[40:43], v[12:15], a[128:135], v1
    v_cvt_pk_bf16_f32 v48, v32, v33
    v_smfmac_f32_16x16x64_bf16 v[40:43], v[16:19], a[136:143], v1
    v_mov_b32 v32, 0
    v_smfmac_f32_16x16x64_bf16 v[40:43], v[20:23], a[144:151], v1
    v_mov_b32 v33, 0
    v_smfmac_f32_16x16x64_bf16 v[40:43], v[24:27], a[152:159], v1
    v_mov_b32 v34, 0
    v_smfmac_f32_16x16x64_bf16 v[40:43], v[28:31], a[160:167], v1
    v_mov_b32 v35, 0
    s_waitcnt lgkmcnt(0)
    v_smfmac_f32_16x16x64_bf16 v[104:107], v[12:15], v[88:95], v1
    ds_read_b128 v[96:99], v113 offset:6144
    ds_read_b128 v[100:103], v113 offset:7168
    v_smfmac_f32_16x16x64_bf16 v[44:47], v[4:7], a[168:175], v1
    v_add_f32 v36, v36, v38
    v_smfmac_f32_16x16x64_bf16 v[44:47], v[8:11], a[176:183], v1
    v_add_f32 v37, v37, v39
    v_smfmac_f32_16x16x64_bf16 v[44:47], v[12:15], a[184:191], v1
    v_cvt_pk_bf16_f32 v49, v36, v37
    v_smfmac_f32_16x16x64_bf16 v[44:47], v[16:19], a[192:199], v1
    v_mov_b32 v36, 0
    v_smfmac_f32_16x16x64_bf16 v[44:47], v[20:23], a[200:207], v1
    v_mov_b32 v37, 0
    v_smfmac_f32_16x16x64_bf16 v[44:47], v[24:27], a[208:215], v1
    v_mov_b32 v38, 0
    v_smfmac_f32_16x16x64_bf16 v[44:47], v[28:31], a[216:223], v1
    v_mov_b32 v39, 0
    s_waitcnt lgkmcnt(0)
    v_smfmac_f32_16x16x64_bf16 v[104:107], v[16:19], v[96:103], v1
    ds_read_b128 v[88:91], v113 offset:8192
    ds_read_b128 v[92:95], v113 offset:9216
    v_smfmac_f32_16x16x64_bf16 v[32:35], v[4:7], a[224:231], v1
    v_add_f32 v40, v40, v42
    v_smfmac_f32_16x16x64_bf16 v[32:35], v[8:11], a[232:239], v1
    v_add_f32 v41, v41, v43
    v_smfmac_f32_16x16x64_bf16 v[32:35], v[12:15], a[240:247], v1
    v_cvt_pk_bf16_f32 v50, v40, v41
    v_smfmac_f32_16x16x64_bf16 v[32:35], v[16:19], a[248:255], v1
    v_mov_b32 v40, 0
    v_smfmac_f32_16x16x64_bf16 v[32:35], v[20:23], v[120:127], v1
    v_mov_b32 v41, 0
    v_smfmac_f32_16x16x64_bf16 v[32:35], v[24:27], v[128:135], v1
    v_mov_b32 v42, 0
    v_smfmac_f32_16x16x64_bf16 v[32:35], v[28:31], v[136:143], v1
    v_mov_b32 v43, 0
    s_waitcnt lgkmcnt(0)
    v_smfmac_f32_16x16x64_bf16 v[104:107], v[20:23], v[88:95], v1
    ds_read_b128 v[96:99], v113 offset:10240
    ds_read_b128 v[100:103], v113 offset:11264
    v_smfmac_f32_16x16x64_bf16 v[36:39], v[4:7], v[144:151], v1
    v_add_f32 v44, v44, v46
    v_smfmac_f32_16x16x64_bf16 v[36:39], v[8:11], v[152:159], v1
    v_add_f32 v45, v45, v47
    v_smfmac_f32_16x16x64_bf16 v[36:39], v[12:15], v[160:167], v1
    v_cvt_pk_bf16_f32 v51, v44, v45
    v_smfmac_f32_16x16x64_bf16 v[36:39], v[16:19], v[168:175], v1
    v_mov_b32 v44, 0
    v_smfmac_f32_16x16x64_bf16 v[36:39], v[20:23], v[176:183], v1
    v_mov_b32 v45, 0
    v_smfmac_f32_16x16x64_bf16 v[36:39], v[24:27], v[184:191], v1
    v_mov_b32 v46, 0
    v_smfmac_f32_16x16x64_bf16 v[36:39], v[28:31], v[192:199], v1
    v_mov_b32 v47, 0
    s_waitcnt lgkmcnt(0)
    v_smfmac_f32_16x16x64_bf16 v[104:107], v[24:27], v[96:103], v1
    ds_read_b128 v[88:91], v113 offset:12288
    ds_read_b128 v[92:95], v113 offset:13312
    v_smfmac_f32_16x16x64_bf16 v[40:43], v[4:7], v[200:207], v1
    v_add_f32 v32, v32, v34
    v_smfmac_f32_16x16x64_bf16 v[40:43], v[8:11], v[208:215], v1
    v_add_f32 v33, v33, v35
    v_smfmac_f32_16x16x64_bf16 v[40:43], v[12:15], v[216:223], v1
    v_cvt_pk_bf16_f32 v52, v32, v33
    v_smfmac_f32_16x16x64_bf16 v[40:43], v[16:19], v[224:231], v1
    v_mov_b32 v32, 0
    v_smfmac_f32_16x16x64_bf16 v[40:43], v[20:23], v[232:239], v1
    v_mov_b32 v33, 0
    v_smfmac_f32_16x16x64_bf16 v[40:43], v[24:27], v[240:247], v1
    v_mov_b32 v34, 0
    v_smfmac_f32_16x16x64_bf16 v[40:43], v[28:31], v[248:255], v1
    v_mov_b32 v35, 0
    s_waitcnt lgkmcnt(0)
    v_smfmac_f32_16x16x64_bf16 v[104:107], v[28:31], v[88:95], v1
    v_add_f32 v36, v36, v38
    v_add_f32 v37, v37, v39
    v_cvt_pk_bf16_f32 v53, v36, v37
    v_mov_b32 v36, 0
    v_mov_b32 v37, 0
    v_mov_b32 v38, 0
    v_mov_b32 v39, 0
    v_add_f32 v40, v40, v42
    v_add_f32 v41, v41, v43
    v_cvt_pk_bf16_f32 v54, v40, v41
    v_mov_b32 v40, 0
    v_mov_b32 v41, 0
    v_mov_b32 v42, 0
    v_mov_b32 v43, 0
    v_add_f32 v104, v104, v106
    v_add_f32 v105, v105, v107
    v_cvt_pk_bf16_f32 v55, v104, v105
    v_mov_b32 v104, 0
    v_mov_b32 v105, 0
    v_mov_b32 v106, 0
    v_mov_b32 v107, 0
    s_cmp_eq_u32 s34, 1
    s_cbranch_scc1 B_vook
    s_cmp_ge_u32 s15, 63
    s_cbranch_scc1 B_vook
    s_cmp_lt_u32 s15, 4
    s_cbranch_scc0 B_volate
    v_lshrrev_b32 v2, 1, v0
    v_min_u32 v2, 7, v2
    v_mul_u32_u24 v2, 28, v2
    v_and_b32 v88, 1, v0
    v_add_u32 v2, v2, v88
    s_lshl_b32 s18, s13, 1
    v_add_u32 v2, s18, v2
    v_lshlrev_b32 v2, 4, v2
    s_mov_b32 s18, 78619136
    s_mov_b32 s23, 1048576
B_epoll:
    buffer_load_dword v88, v2, s[4:7], s18 offen sc1
    s_mov_b32 s90, 16
    s_sub_u32 s23, s23, 1
    s_cmp_eq_u32 s23, 0
    s_cbranch_scc1 L_abort0
    s_waitcnt vmcnt(0)
    v_cmp_ne_u32 vcc, 1, v88
    s_cbranch_vccnz B_epoll
    s_max_u32 s24, s24, 4
    s_branch B_vogo
B_volate:
    s_add_u32 s18, s15, 1
    s_min_u32 s18, s18, 64
    s_cmp_ge_u32 s24, s18
    s_cbranch_scc1 B_wm_ok
    s_mov_b32 s23, 1048576
B_wm:
    buffer_load_dword v2, off, s[4:7], s25 sc1
    s_mov_b32 s90, 17
    s_sub_u32 s23, s23, 1
    s_cmp_eq_u32 s23, 0
    s_cbranch_scc1 L_abort0
    s_waitcnt vmcnt(0)
    v_readfirstlane_b32 s24, v2
    s_nop 0
    s_cmp_ge_u32 s24, s18
    s_cbranch_scc0 B_wm
B_wm_ok:
B_vogo:
    s_add_u32 s19, s27, 4096
    buffer_load_dwordx4 v[56:59], v108, s[4:7], s27 offen offset:0 sc1
    buffer_load_dwordx4 v[60:63], v108, s[4:7], s27 offen offset:1024 sc1
    buffer_load_dwordx4 v[64:67], v108, s[4:7], s27 offen offset:2048 sc1
    buffer_load_dwordx4 v[68:71], v108, s[4:7], s27 offen offset:3072 sc1
    buffer_load_dwordx4 v[72:75], v108, s[4:7], s19 offen offset:0 sc1
    buffer_load_dwordx4 v[76:79], v108, s[4:7], s19 offen offset:1024 sc1
    buffer_load_dwordx4 v[80:83], v108, s[4:7], s19 offen offset:2048 sc1
    buffer_load_dwordx4 v[84:87], v108, s[4:7], s19 offen offset:3072 sc1
B_vook:
    s_cmp_ge_u32 s15, 63
    s_cbranch_scc0 B_notlast
    s_waitcnt vmcnt(0)
    s_barrier
    s_cmp_eq_u32 s14, 0
    s_cbranch_scc0 B_d1
    s_mov_b64 exec, 1
    v_mov_b32 v2, 64
    buffer_store_dword v2, off, s[4:7], s39
    s_mov_b64 exec, -1
B_d1:
    s_add_u32 s28, s28, 114688
    buffer_store_dwordx4 v[48:51], v108, s[4:7], s28 offen sc1
    buffer_store_dwordx4 v[52:55], v108, s[4:7], s28 offen offset:1024 sc1
    s_waitcnt vmcnt(0)
    s_barrier
    s_cmp_eq_u32 s14, 0
    s_cbranch_scc0 B_d2
    s_mov_b64 exec, 1
    v_mov_b32 v2, 65
    buffer_store_dword v2, off, s[4:7], s39
    s_mov_b64 exec, -1
B_d2:
    s_add_u32 s65, s65, 1
    s_cmp_lt_u32 s65, 2
    s_cbranch_scc1 B_layer
    s_endpgm
B_notlast:
    s_sleep 6
    s_nop 3
    s_nop 3
    s_mov_b32 s23, 65536
    buffer_load_dword v12, v115, s[4:7], s17 offen sc1
    buffer_load_dword v13, v115, s[4:7], s17 offen offset:256 sc1
    buffer_load_dwordx4 v[4:7], v114, s[4:7], s17 offen sc1
    buffer_load_dwordx4 v[8:11], v114, s[4:7], s17 offen offset:1024 sc1
    s_sleep 2
    s_nop 3
    s_nop 3
B_ppoll:
    buffer_load_dword v22, v115, s[4:7], s17 offen sc1
    buffer_load_dword v23, v115, s[4:7], s17 offen offset:256 sc1
    buffer_load_dwordx4 v[14:17], v114, s[4:7], s17 offen sc1
    buffer_load_dwordx4 v[18:21], v114, s[4:7], s17 offen offset:1024 sc1
    s_waitcnt vmcnt(6)
    v_smfmac_f32_16x16x32_bf16 v[32:35], v[12:13], v[48:51], v1
    v_smfmac_f32_16x16x32_bf16 v[36:39], v[12:13], v[52:55], v1
    v_or_b32 v25, v12, v13
    s_waitcnt vmcnt(5)
    v_smfmac_f32_16x16x64_bf16 v[32:35], v[4:7], v[56:63], v1
    v_or3_b32 v24, v4, v5, v6
    v_smfmac_f32_16x16x64_bf16 v[36:39], v[4:7], v[64:71], v1
    v_or3_b32 v24, v24, v7, v25
    s_waitcnt vmcnt(4)
    v_smfmac_f32_16x16x64_bf16 v[32:35], v[8:11], v[72:79], v1
    v_or3_b32 v25, v8, v9, v10
    v_smfmac_f32_16x16x64_bf16 v[36:39], v[8:11], v[80:87], v1
    v_or3_b32 v24, v24, v25, v11
    v_and_b32 v24, 0x80008000, v24
    v_cmp_ne_u32 vcc, 0, v24
    s_cbranch_vccnz B_pretry
B_pok:
    s_add_u32 s27, s27, 458752
    s_nop 0
    v_add_f32 v32, v32, v34
    v_add_f32 v33, v33, v35
    ds_write_b32 v116, v32 offset:0
    ds_write_b32 v116, v33 offset:160
    v_add_f32 v36, v36, v38
    v_add_f32 v37, v37, v39
    ds_write_b32 v116, v36 offset:64
    ds_write_b32 v116, v37 offset:224
    s_waitcnt lgkmcnt(0)
    s_barrier
    s_cmp_eq_u32 s14, 0
    s_cbranch_scc0 B_nored
    ds_read_b128 v[88:91], v117 offset:0
    ds_read_b128 v[92:95], v117 offset:1280
    ds_read_b128 v[96:99], v117 offset:2560
    ds_read_b128 v[100:103], v117 offset:3840
    s_add_u32 s18, s16, 8192
    s_waitcnt lgkmcnt(2)
    v_pk_add_f32 v[88:89], v[88:89], v[92:93]
    v_pk_add_f32 v[90:91], v[90:91], v[94:95]
    s_waitcnt lgkmcnt(0)
    v_pk_add_f32 v[96:97], v[96:97], v[100:101]
    v_pk_add_f32 v[98:99], v[98:99], v[102:103]
    v_pk_add_f32 v[88:89], v[88:89], v[96:97]
    v_pk_add_f32 v[90:91], v[90:91], v[98:99]
    v_cvt_pk_bf16_f32 v110, v88, v89
    v_cvt_pk_bf16_f32 v111, v90, v91
    v_min_u32 v110, -2, v110
    v_min_u32 v111, -2, v111
    buffer_store_dwordx2 v[110:111], v119, s[4:7], s18 offen
B_nored:
    s_cmp_ge_u32 s24, 64
    s_cbranch_scc1 B_wmfresh
    buffer_load_dword v2, off, s[4:7], s25 sc1
    s_waitcnt vmcnt(0)
    v_readfirstlane_b32 s35, v2
    s_nop 0
    s_max_u32 s24, s24, s35
B_wmfresh:
    v_mov_b64 v[32:33], 0
    v_mov_b64 v[34:35], 0
    v_mov_b64 v[36:37], 0
    v_mov_b64 v[38:39], 0
    s_add_u32 s15, s15, 1
    s_add_u32 s16, s16, 8192
    s_add_u32 s17, s17, 10240
    s_add_u32 s28, s28, 114688
    s_add_u32 s29, s29, 7168
    s_cmp_eq_u32 s14, 0
    s_cbranch_scc1 B_sl0
    s_branch B_loop
B_sl0:
    s_sleep 1
    s_branch B_loop
B_pretry:
    s_nop 7
    v_mov_b64 v[32:33], 0
    v_mov_b64 v[34:35], 0
    v_mov_b64 v[36:37], 0
    v_mov_b64 v[38:39], 0
    s_nop 1
    buffer_load_dword v12, v115, s[4:7], s17 offen sc1
    buffer_load_dword v13, v115, s[4:7], s17 offen offset:256 sc1
    buffer_load_dwordx4 v[4:7], v114, s[4:7], s17 offen sc1
    buffer_load_dwordx4 v[8:11], v114, s[4:7], s17 offen offset:1024 sc1
    s_mov_b32 s90, 18
    s_sub_u32 s23, s23, 1
    s_cmp_eq_u32 s23, 0
    s_cbranch_scc1 L_abort0
    s_waitcnt vmcnt(6)
    v_smfmac_f32_16x16x32_bf16 v[32:35], v[22:23], v[48:51], v1
    v_smfmac_f32_16x16x32_bf16 v[36:39], v[22:23], v[52:55], v1
    v_or_b32 v25, v22, v23
    s_waitcnt vmcnt(5)
    v_smfmac_f32_16x16x64_bf16 v[32:35], v[14:17], v[56:63], v1
    v_or3_b32 v24, v14, v15, v16
    v_smfmac_f32_16x16x64_bf16 v[36:39], v[14:17], v[64:71], v1
    v_or3_b32 v24, v24, v17, v25
    s_waitcnt vmcnt(4)
    v_smfmac_f32_16x16x64_bf16 v[32:35], v[18:21], v[72:79], v1
    v_or3_b32 v25, v18, v19, v20
    v_smfmac_f32_16x16x64_bf16 v[36:39], v[18:21], v[80:87], v1
    v_or3_b32 v24, v24, v25, v21
    v_and_b32 v24, 0x80008000, v24
    v_cmp_ne_u32 vcc, 0, v24
    s_cbranch_vccnz B_pretry2
    s_branch B_pok
B_pretry2:
    s_nop 7
    v_mov_b64 v[32:33], 0
    v_mov_b64 v[34:35], 0
    v_mov_b64 v[36:37], 0
    v_mov_b64 v[38:39], 0
    s_nop 1
    s_branch B_ppoll
C_rolePF:
    s_cmp_eq_u32 s76, 0
    s_cbranch_scc0 PF_wfill_ok
    v_mbcnt_lo_u32_b32 v20, -1, 0
    v_mbcnt_hi_u32_b32 v20, -1, v20
    v_add_u32 v21, 0, v20
    v_min_u32 v21, 14, v21
    v_lshlrev_b32 v21, 4, v21
    s_mov_b32 s53, 78639104
    s_mov_b32 s54, 1048576
PF_wfill:
    buffer_load_dword v22, v21, s[4:7], s53 offen sc1
    s_mov_b32 s90, 19
    s_sub_u32 s54, s54, 1
    s_cmp_eq_u32 s54, 0
    s_cbranch_scc1 L_abort0
    s_waitcnt vmcnt(0)
    v_cmp_ne_u32 vcc, 1, v22
    s_cbranch_vccz PF_wfill_ok
    s_sleep 8
    s_branch PF_wfill
PF_wfill_ok:
    s_barrier
    v_accvgpr_read_b32 v0, a255
    v_and_b32 v0, 63, v0
    s_cmp_eq_u32 s13, 31
    s_cbranch_scc0 PF_main
    s_cmp_eq_u32 s14, 0
    s_cbranch_scc0 PF_main
WM_layer:
    s_mul_i32 s53, s65, 79691776
    s_add_u32 s53, s53, 30408704
    s_add_u32 s4, s68, s53
    s_addc_u32 s5, s69, 0
    s_and_b32 s5, s5, 0xffff
    s_mov_b32 s6, 79691776
    s_mov_b32 s7, 0x20000
    s_mov_b32 s37, 78483456
    s_mov_b32 s25, 78618624
    v_lshlrev_b32 v12, 4, v0
    v_add_u32 v12, 512, v12
    v_and_b32 v13, 31, v0
    v_lshlrev_b32 v13, 4, v13
    v_add_u32 v13, 3584, v13
    s_mov_b32 s15, 0
WM_loop:
    s_mov_b32 s23, 1048576
WM_poll:
    buffer_load_dword v5, v12, s[4:7], s37 offen offset:0 sc1
    buffer_load_dword v6, v12, s[4:7], s37 offen offset:1024 sc1
    buffer_load_dword v7, v12, s[4:7], s37 offen offset:2048 sc1
    buffer_load_dword v8, v13, s[4:7], s37 offen sc1
    s_mov_b32 s90, 20
    s_sub_u32 s23, s23, 1
    s_cmp_eq_u32 s23, 0
    s_cbranch_scc1 L_abort0
    s_waitcnt vmcnt(0)
    v_and_b32 v5, v5, v6
    v_and_b32 v7, v7, v8
    v_and_b32 v5, v5, v7
    v_cmp_ne_u32 vcc, 1, v5
    s_cbranch_vccz WM_ok
    s_sleep 2
    s_branch WM_poll
WM_ok:
    s_add_u32 s15, s15, 4
    s_add_u32 s37, s37, 4096
    v_mov_b32 v6, s15
    buffer_store_dword v6, off, s[4:7], s25
    buffer_store_dword v6, off, s[4:7], s25 offset:128 sc1
    s_cmp_lt_u32 s15, 64
    s_cbranch_scc1 WM_loop
    s_add_u32 s65, s65, 1
    s_cmp_lt_u32 s65, 2
    s_cbranch_scc1 WM_layer
    s_endpgm
PF_main:
    v_lshlrev_b32 v2, 7, v0
    s_lshl_b32 s18, s14, 13
    v_add_u32 v12, s18, v2
    v_lshlrev_b32 v7, 6, v0
    s_lshl_b32 s18, s14, 12
    v_add_u32 v7, s18, v7
    s_sub_u32 s18, s13, 30
    s_mul_i32 s18, s18, 3
    s_add_u32 s18, s18, s14
    s_lshl_b32 s18, s18, 16
    v_lshrrev_b32 v13, 5, v0
    v_lshlrev_b32 v13, 13, v13
    v_and_b32 v14, 31, v0
    v_lshl_add_u32 v13, v14, 7, v13
    s_add_u32 s18, s18, 4096
    v_add_u32 v13, s18, v13
PF_layer:
    s_mul_i32 s53, s65, 79691776
    s_add_u32 s53, s53, 30408704
    s_add_u32 s4, s68, s53
    s_addc_u32 s5, s69, 0
    s_and_b32 s5, s5, 0xffff
    s_mov_b32 s6, 79691776
    s_mov_b32 s7, 0x20000
    s_mov_b32 s22, 0
    s_mov_b32 s16, 2064384
    s_mov_b32 s17, 2621440
    s_mov_b32 s25, 78618624
    s_mov_b32 s24, 0
    s_mov_b32 s27, 11112448
    v_mov_b32 v3, 0
    v_min_u32 v15, 13, v0
    v_lshlrev_b32 v15, 9, v15
    s_mov_b32 s38, 78616576
    s_cmp_eq_u32 s13, 30
    s_cbranch_scc0 PF_o1
    buffer_load_dword v8, v7, s[4:7], s17 offen sc1
    s_add_u32 s17, s17, 10240
    buffer_load_dword v8, v7, s[4:7], s17 offen sc1
    s_add_u32 s17, s17, 10240
    s_add_u32 s19, s16, 8192
    buffer_load_dword v9, v7, s[4:7], s19 offen sc1
PF_o1:
    s_mov_b32 s18, 3
    s_min_u32 s18, s18, 64
    s_cmp_ge_u32 s24, s18
    s_cbranch_scc1 PF_wm0_ok
    s_mov_b32 s23, 1048576
PF_wm0:
    buffer_load_dword v5, off, s[4:7], s25 sc1
    s_mov_b32 s90, 21
    s_sub_u32 s23, s23, 1
    s_cmp_eq_u32 s23, 0
    s_cbranch_scc1 L_abort0
    s_waitcnt vmcnt(0)
    v_readfirstlane_b32 s24, v5
    s_nop 0
    s_cmp_ge_u32 s24, s18
    s_cbranch_scc0 PF_wm0
PF_wm0_ok:
    s_cmp_eq_u32 s13, 30
    s_cbranch_scc0 PF_o2
    buffer_load_dword v4, v12, s[4:7], s22 offen sc1
    s_add_u32 s22, s22, 28672
    buffer_load_dword v4, v12, s[4:7], s22 offen sc1
    s_add_u32 s22, s22, 28672
    buffer_load_dword v4, v12, s[4:7], s22 offen sc1
    s_add_u32 s22, s22, 28672
PF_o2:
    s_add_u32 s27, s27, 458752
    s_add_u32 s27, s27, 458752
    s_add_u32 s27, s27, 458752
    s_mov_b32 s15, 1
PF_loop:
    s_add_u32 s16, s16, 8192
    s_mov_b32 s23, 1048576
PF_poll:
    s_sleep 4
    buffer_load_dword v5, v15, s[4:7], s16 offen sc1
    s_mov_b32 s90, 22
    s_sub_u32 s23, s23, 1
    s_cmp_eq_u32 s23, 0
    s_cbranch_scc1 L_abort0
    s_waitcnt vmcnt(0)
    v_cmp_eq_u32 vcc, -1, v5
    s_cbranch_vccnz PF_poll
    s_cmp_eq_u32 s13, 30
    s_cbranch_scc0 PF_nopub
    s_cmp_eq_u32 s14, 0
    s_cbranch_scc0 PF_nopub
    s_mov_b64 exec, 1
    v_mov_b32 v6, s15
    buffer_store_dword v6, off, s[4:7], s38 sc1
    s_mov_b64 exec, -1
PF_nopub:
    s_cmp_eq_u32 s13, 30
    s_cbranch_scc0 PF_o3
    s_add_u32 s19, s16, 16384
    buffer_load_dword v9, v7, s[4:7], s19 offen sc1
    buffer_load_dword v8, v7, s[4:7], s17 offen sc1
    s_add_u32 s17, s17, 10240
    buffer_load_dword v4, v12, s[4:7], s22 offen sc1
    s_add_u32 s22, s22, 28672
PF_o3:
    s_add_u32 s18, s15, 3
    s_min_u32 s18, s18, 64
    s_cmp_ge_u32 s24, s18
    s_cbranch_scc1 PF_wm_ok
    s_mov_b32 s23, 1048576
PF_wm:
    buffer_load_dword v5, off, s[4:7], s25 sc1
    s_mov_b32 s90, 23
    s_sub_u32 s23, s23, 1
    s_cmp_eq_u32 s23, 0
    s_cbranch_scc1 L_abort0
    s_waitcnt vmcnt(0)
    v_readfirstlane_b32 s24, v5
    s_nop 0
    s_cmp_ge_u32 s24, s18
    s_cbranch_scc0 PF_wm
PF_wm_ok:
    s_add_u32 s27, s27, 458752
    s_add_u32 s15, s15, 1
    s_cmp_lt_u32 s15, 64
    s_cbranch_scc1 PF_loop
    s_cmp_eq_u32 s13, 30
    s_cbranch_scc0 PF_lend
    s_cmp_eq_u32 s14, 0
    s_cbranch_scc0 PF_lend
    v_min_u32 v16, 13, v0
    v_lshlrev_b32 v16, 7, v16
    s_mov_b32 s19, 78614528
    s_mov_b32 s23, 1048576
PF_end64:
    buffer_load_dword v5, v16, s[4:7], s19 offen sc1
    s_mov_b32 s90, 24
    s_sub_u32 s23, s23, 1
    s_cmp_eq_u32 s23, 0
    s_cbranch_scc1 L_abort0
    s_waitcnt vmcnt(0)
    v_cmp_gt_u32 vcc, 64, v5
    s_cbranch_vccnz PF_end64
    s_mov_b64 exec, 1
    v_mov_b32 v6, 64
    buffer_store_dword v6, off, s[4:7], s38 sc1
    s_mov_b64 exec, -1
    s_mov_b32 s23, 1048576
PF_end65:
    buffer_load_dword v5, v16, s[4:7], s19 offen sc1
    s_mov_b32 s90, 25
    s_sub_u32 s23, s23, 1
    s_cmp_eq_u32 s23, 0
    s_cbranch_scc1 L_abort0
    s_waitcnt vmcnt(0)
    v_cmp_gt_u32 vcc, 65, v5
    s_cbranch_vccnz PF_end65
    s_mov_b64 exec, 1
    v_mov_b32 v6, 65
    buffer_store_dword v6, off, s[4:7], s38 sc1
    s_mov_b64 exec, -1
PF_lend:
    s_waitcnt vmcnt(0)
    s_add_u32 s65, s65, 1
    s_cmp_lt_u32 s65, 2
    s_cbranch_scc1 PF_layer
    s_endpgm
L_abort0:
    s_mov_b32 s8, s70
    s_and_b32 s9, s71, 0xffff
    s_mov_b32 s10, 256
    s_mov_b32 s11, 0x20000
    s_lshl_b32 s91, s90, 24
    s_and_b32 s92, s67, 0xff
    s_lshl_b32 s92, s92, 16
    s_or_b32 s91, s91, s92
    s_cmp_eq_u32 s66, 0
    s_cselect_b32 s92, s15, s12
    s_and_b32 s92, s92, 0xff
    s_lshl_b32 s92, s92, 8
    s_or_b32 s91, s91, s92
    s_lshl_b32 s92, s65, 7
    s_or_b32 s91, s91, s92
    s_or_b32 s91, s91, s66
    s_mul_hi_u32 s92, s2, 0x924924a
    s_mul_i32 s92, s92, 28
    s_sub_u32 s92, s2, s92
    s_lshl_b32 s92, s92, 2
    s_add_u32 s92, s92, 144
    v_mov_b32 v1, s91
    v_mov_b32 v2, s92
    buffer_store_dword v1, v2, s[8:11], 0 offen
    s_waitcnt vmcnt(0)
    s_endpgm
K_bulk:
    s_sub_u32 s64, s66, 1
    s_lshl_b32 s64, s64, 5
    s_add_u32 s64, s64, s67
    s_cmp_lt_u32 s64, 128
    s_cbranch_scc1 K_noprep
    s_sub_u32 s51, s64, 128
    s_mov_b32 s33, 1431655766
    s_mul_hi_u32 s55, s51, s33
    s_mul_i32 s53, s55, 3
    s_sub_u32 s53, s51, s53
    s_mul_i32 s55, s55, 7
    s_add_u32 s55, s55, s53
    s_mov_b32 s77, 0
K_prep:
    s_cmp_ge_u32 s55, 112
    s_cbranch_scc1 P_matB
    s_load_dwordx4 s[44:47], s[0:1], 40
    s_waitcnt lgkmcnt(0)
    s_mov_b32 s8, s44
    s_and_b32 s9, s45, 0xffff
    s_mov_b32 s10, 3670016
    s_mov_b32 s11, 0x20000
    s_mov_b32 s12, s46
    s_and_b32 s13, s47, 0xffff
    s_mov_b32 s14, 3670016
    s_mov_b32 s15, 0x20000
    s_mov_b32 s52, s55
    s_branch P_bodyA
P_matB:
    s_load_dwordx4 s[44:47], s[0:1], 56
    s_waitcnt lgkmcnt(0)
    s_mov_b32 s8, s44
    s_and_b32 s9, s45, 0xffff
    s_mov_b32 s10, 3670016
    s_mov_b32 s11, 0x20000
    s_mov_b32 s12, s46
    s_and_b32 s13, s47, 0xffff
    s_mov_b32 s14, 3670016
    s_mov_b32 s15, 0x20000
    s_sub_u32 s52, s55, 112
    v_accvgpr_read_b32 v0, a255
    s_mov_b32 s28, s76
    v_and_b32 v0, 63, v0
    s_mov_b32 s33, 613566757
    s_mul_hi_u32 s31, s52, s33
    s_mul_i32 s32, s31, 7
    s_sub_u32 s32, s52, s32
    s_lshl_b32 s34, s31, 9
    v_lshrrev_b32 v2, 5, v0
    v_add_u32 v2, 0, v2
    v_lshrrev_b32 v3, 2, v2
    v_lshlrev_b32 v3, 3, v3
    v_and_b32 v4, 3, v2
    v_add_u32 v3, v3, v4
    v_lshlrev_b32 v3, 13, v3
    v_and_b32 v4, 7, v2
    v_lshlrev_b32 v4, 2, v4
    v_and_b32 v5, 31, v0
    v_xor_b32 v4, v4, v5
    v_lshl_add_u32 v3, v4, 4, v3
    s_lshl_b32 s35, s32, 6
    s_lshr_b32 s36, s28, 1
    s_lshl_b32 s36, s36, 5
    s_add_u32 s35, s35, s36
    s_and_b32 s36, s28, 1
    s_lshl_b32 s36, s36, 2
    s_add_u32 s35, s35, s36
    s_lshl_b32 s35, s35, 13
    s_add_u32 s35, s35, s34
    s_lshl_b32 s37, s28, 13
    s_add_u32 s37, s37, 65536
    s_add_u32 m0, s37, 0
    s_nop 0
    buffer_load_dwordx4 v3, s[8:11], s35 offen lds
    v_lshrrev_b32 v2, 5, v0
    v_add_u32 v2, 2, v2
    v_lshrrev_b32 v3, 2, v2
    v_lshlrev_b32 v3, 3, v3
    v_and_b32 v4, 3, v2
    v_add_u32 v3, v3, v4
    v_lshlrev_b32 v3, 13, v3
    v_and_b32 v4, 7, v2
    v_lshlrev_b32 v4, 2, v4
    v_and_b32 v5, 31, v0
    v_xor_b32 v4, v4, v5
    v_lshl_add_u32 v3, v4, 4, v3
    s_add_u32 m0, s37, 1024
    s_nop 0
    buffer_load_dwordx4 v3, s[8:11], s35 offen lds
    v_lshrrev_b32 v2, 5, v0
    v_add_u32 v2, 4, v2
    v_lshrrev_b32 v3, 2, v2
    v_lshlrev_b32 v3, 3, v3
    v_and_b32 v4, 3, v2
    v_add_u32 v3, v3, v4
    v_lshlrev_b32 v3, 13, v3
    v_and_b32 v4, 7, v2
    v_lshlrev_b32 v4, 2, v4
    v_and_b32 v5, 31, v0
    v_xor_b32 v4, v4, v5
    v_lshl_add_u32 v3, v4, 4, v3
    s_add_u32 m0, s37, 2048
    s_nop 0
    buffer_load_dwordx4 v3, s[8:11], s35 offen lds
    v_lshrrev_b32 v2, 5, v0
    v_add_u32 v2, 6, v2
    v_lshrrev_b32 v3, 2, v2
    v_lshlrev_b32 v3, 3, v3
    v_and_b32 v4, 3, v2
    v_add_u32 v3, v3, v4
    v_lshlrev_b32 v3, 13, v3
    v_and_b32 v4, 7, v2
    v_lshlrev_b32 v4, 2, v4
    v_and_b32 v5, 31, v0
    v_xor_b32 v4, v4, v5
    v_lshl_add_u32 v3, v4, 4, v3
    s_add_u32 m0, s37, 3072
    s_nop 0
    buffer_load_dwordx4 v3, s[8:11], s35 offen lds
    v_lshrrev_b32 v2, 5, v0
    v_add_u32 v2, 8, v2
    v_lshrrev_b32 v3, 2, v2
    v_lshlrev_b32 v3, 3, v3
    v_and_b32 v4, 3, v2
    v_add_u32 v3, v3, v4
    v_lshlrev_b32 v3, 13, v3
    v_and_b32 v4, 7, v2
    v_lshlrev_b32 v4, 2, v4
    v_and_b32 v5, 31, v0
    v_xor_b32 v4, v4, v5
    v_lshl_add_u32 v3, v4, 4, v3
    s_add_u32 m0, s37, 4096
    s_nop 0
    buffer_load_dwordx4 v3, s[8:11], s35 offen lds
    v_lshrrev_b32 v2, 5, v0
    v_add_u32 v2, 10, v2
    v_lshrrev_b32 v3, 2, v2
    v_lshlrev_b32 v3, 3, v3
    v_and_b32 v4, 3, v2
    v_add_u32 v3, v3, v4
    v_lshlrev_b32 v3, 13, v3
    v_and_b32 v4, 7, v2
    v_lshlrev_b32 v4, 2, v4
    v_and_b32 v5, 31, v0
    v_xor_b32 v4, v4, v5
    v_lshl_add_u32 v3, v4, 4, v3
    s_add_u32 m0, s37, 5120
    s_nop 0
    buffer_load_dwordx4 v3, s[8:11], s35 offen lds
    v_lshrrev_b32 v2, 5, v0
    v_add_u32 v2, 12, v2
    v_lshrrev_b32 v3, 2, v2
    v_lshlrev_b32 v3, 3, v3
    v_and_b32 v4, 3, v2
    v_add_u32 v3, v3, v4
    v_lshlrev_b32 v3, 13, v3
    v_and_b32 v4, 7, v2
    v_lshlrev_b32 v4, 2, v4
    v_and_b32 v5, 31, v0
    v_xor_b32 v4, v4, v5
    v_lshl_add_u32 v3, v4, 4, v3
    s_add_u32 m0, s37, 6144
    s_nop 0
    buffer_load_dwordx4 v3, s[8:11], s35 offen lds
    v_lshrrev_b32 v2, 5, v0
    v_add_u32 v2, 14, v2
    v_lshrrev_b32 v3, 2, v2
    v_lshlrev_b32 v3, 3, v3
    v_and_b32 v4, 3, v2
    v_add_u32 v3, v3, v4
    v_lshlrev_b32 v3, 13, v3
    v_and_b32 v4, 7, v2
    v_lshlrev_b32 v4, 2, v4
    v_and_b32 v5, 31, v0
    v_xor_b32 v4, v4, v5
    v_lshl_add_u32 v3, v4, 4, v3
    s_add_u32 m0, s37, 7168
    s_nop 0
    buffer_load_dwordx4 v3, s[8:11], s35 offen lds
    v_and_b32 v2, 15, v0
    v_lshlrev_b32 v3, 9, v2
    v_lshrrev_b32 v4, 4, v0
    v_lshl_add_u32 v3, v4, 4, v3
    v_and_b32 v2, 7, v2
    v_xor_b32 v4, 0, v2
    v_lshl_add_u32 v64, v4, 6, v3
    v_xor_b32 v4, 1, v2
    v_lshl_add_u32 v65, v4, 6, v3
    v_xor_b32 v4, 2, v2
    v_lshl_add_u32 v66, v4, 6, v3
    v_xor_b32 v4, 3, v2
    v_lshl_add_u32 v67, v4, 6, v3
    v_xor_b32 v4, 4, v2
    v_lshl_add_u32 v68, v4, 6, v3
    v_xor_b32 v4, 5, v2
    v_lshl_add_u32 v69, v4, 6, v3
    v_xor_b32 v4, 6, v2
    v_lshl_add_u32 v70, v4, 6, v3
    v_xor_b32 v4, 7, v2
    v_lshl_add_u32 v71, v4, 6, v3
    v_lshrrev_b32 v2, 3, v0
    v_mul_u32_u24 v72, 896, v2
    v_and_b32 v2, 7, v0
    v_lshl_add_u32 v72, v2, 4, v72
    s_mul_i32 s38, s31, 229376
    s_mul_i32 s36, s28, 57344
    s_add_u32 s38, s38, s36
    s_lshl_b32 s39, s28, 13
    v_lshrrev_b32 v2, 4, v0
    v_lshlrev_b32 v2, 3, v2
    v_bfe_u32 v3, v0, 2, 2
    v_add_u32 v2, v2, v3
    v_lshlrev_b32 v73, 7, v2
    v_and_b32 v3, 3, v0
    v_lshl_add_u32 v73, v3, 3, v73
    s_lshl_b32 s36, s28, 5
    v_add_u32 v73, s36, v73
    v_add_u32 v74, 65536, v73
    v_lshlrev_b32 v1, 4, v0
    v_lshrrev_b32 v3, 5, v0
    v_lshlrev_b32 v3, 10, v3
    v_bfe_u32 v7, v0, 4, 1
    v_lshl_add_u32 v3, v7, 9, v3
    v_and_b32 v7, 15, v0
    v_lshl_add_u32 v3, v7, 4, v3
    s_mov_b32 s36, 0x3f800000
    s_add_u32 m0, s39, 0
    s_add_u32 s35, s38, 0
    buffer_load_dwordx4 v72, s[12:15], s35 offen lds
    s_add_u32 m0, s39, 1024
    s_add_u32 s35, s38, 7168
    buffer_load_dwordx4 v72, s[12:15], s35 offen lds
    s_add_u32 m0, s39, 2048
    s_add_u32 s35, s38, 14336
    buffer_load_dwordx4 v72, s[12:15], s35 offen lds
    s_add_u32 m0, s39, 3072
    s_add_u32 s35, s38, 21504
    buffer_load_dwordx4 v72, s[12:15], s35 offen lds
    s_add_u32 m0, s39, 4096
    s_add_u32 s35, s38, 28672
    buffer_load_dwordx4 v72, s[12:15], s35 offen lds
    s_add_u32 m0, s39, 5120
    s_add_u32 s35, s38, 35840
    buffer_load_dwordx4 v72, s[12:15], s35 offen lds
    s_add_u32 m0, s39, 6144
    s_add_u32 s35, s38, 43008
    buffer_load_dwordx4 v72, s[12:15], s35 offen lds
    s_add_u32 m0, s39, 7168
    s_add_u32 s35, s38, 50176
    buffer_load_dwordx4 v72, s[12:15], s35 offen lds
    s_add_u32 m0, s39, 32768
    s_add_u32 s35, s38, 128
    buffer_load_dwordx4 v72, s[12:15], s35 offen lds
    s_add_u32 m0, s39, 33792
    s_add_u32 s35, s38, 7296
    buffer_load_dwordx4 v72, s[12:15], s35 offen lds
    s_add_u32 m0, s39, 34816
    s_add_u32 s35, s38, 14464
    buffer_load_dwordx4 v72, s[12:15], s35 offen lds
    s_add_u32 m0, s39, 35840
    s_add_u32 s35, s38, 21632
    buffer_load_dwordx4 v72, s[12:15], s35 offen lds
    s_add_u32 m0, s39, 36864
    s_add_u32 s35, s38, 28800
    buffer_load_dwordx4 v72, s[12:15], s35 offen lds
    s_add_u32 m0, s39, 37888
    s_add_u32 s35, s38, 35968
    buffer_load_dwordx4 v72, s[12:15], s35 offen lds
    s_add_u32 m0, s39, 38912
    s_add_u32 s35, s38, 43136
    buffer_load_dwordx4 v72, s[12:15], s35 offen lds
    s_add_u32 m0, s39, 39936
    s_add_u32 s35, s38, 50304
    buffer_load_dwordx4 v72, s[12:15], s35 offen lds
    s_waitcnt vmcnt(16)
    s_barrier
    v_add_u32 v80, 65536, v64
    ds_read_b128 v[128:131], v80
    v_add_u32 v80, 65536, v65
    ds_read_b128 v[132:135], v80
    v_add_u32 v80, 65536, v66
    ds_read_b128 v[136:139], v80
    v_add_u32 v80, 65536, v67
    ds_read_b128 v[140:143], v80
    v_add_u32 v80, 65536, v68
    ds_read_b128 v[144:147], v80
    v_add_u32 v80, 65536, v69
    ds_read_b128 v[148:151], v80
    v_add_u32 v80, 65536, v70
    ds_read_b128 v[152:155], v80
    v_add_u32 v80, 65536, v71
    ds_read_b128 v[156:159], v80
    s_waitcnt lgkmcnt(0)
    v_add_u32 v80, 73728, v64
    ds_read_b128 v[160:163], v80
    v_add_u32 v80, 73728, v65
    ds_read_b128 v[164:167], v80
    v_add_u32 v80, 73728, v66
    ds_read_b128 v[168:171], v80
    v_add_u32 v80, 73728, v67
    ds_read_b128 v[172:175], v80
    v_add_u32 v80, 73728, v68
    ds_read_b128 v[176:179], v80
    v_add_u32 v80, 73728, v69
    ds_read_b128 v[180:183], v80
    v_add_u32 v80, 73728, v70
    ds_read_b128 v[184:187], v80
    v_add_u32 v80, 73728, v71
    ds_read_b128 v[188:191], v80
    s_waitcnt lgkmcnt(0)
    v_add_u32 v80, 81920, v64
    ds_read_b128 v[192:195], v80
    v_add_u32 v80, 81920, v65
    ds_read_b128 v[196:199], v80
    v_add_u32 v80, 81920, v66
    ds_read_b128 v[200:203], v80
    v_add_u32 v80, 81920, v67
    ds_read_b128 v[204:207], v80
    v_add_u32 v80, 81920, v68
    ds_read_b128 v[208:211], v80
    v_add_u32 v80, 81920, v69
    ds_read_b128 v[212:215], v80
    v_add_u32 v80, 81920, v70
    ds_read_b128 v[216:219], v80
    v_add_u32 v80, 81920, v71
    ds_read_b128 v[220:223], v80
    s_waitcnt lgkmcnt(0)
    v_add_u32 v80, 90112, v64
    ds_read_b128 v[224:227], v80
    v_add_u32 v80, 90112, v65
    ds_read_b128 v[228:231], v80
    v_add_u32 v80, 90112, v66
    ds_read_b128 v[232:235], v80
    v_add_u32 v80, 90112, v67
    ds_read_b128 v[236:239], v80
    v_add_u32 v80, 90112, v68
    ds_read_b128 v[240:243], v80
    v_add_u32 v80, 90112, v69
    ds_read_b128 v[244:247], v80
    v_add_u32 v80, 90112, v70
    ds_read_b128 v[248:251], v80
    v_add_u32 v80, 90112, v71
    ds_read_b128 v[252:255], v80
    s_waitcnt lgkmcnt(0)
    s_barrier
    s_waitcnt vmcnt(8)
    s_barrier
    s_add_u32 m0, s39, 65536
    s_add_u32 s35, s38, 256
    buffer_load_dwordx4 v72, s[12:15], s35 offen lds
    s_add_u32 m0, s39, 66560
    s_add_u32 s35, s38, 7424
    buffer_load_dwordx4 v72, s[12:15], s35 offen lds
    s_add_u32 m0, s39, 67584
    s_add_u32 s35, s38, 14592
    buffer_load_dwordx4 v72, s[12:15], s35 offen lds
    s_add_u32 m0, s39, 68608
    s_add_u32 s35, s38, 21760
    buffer_load_dwordx4 v72, s[12:15], s35 offen lds
    s_add_u32 m0, s39, 69632
    s_add_u32 s35, s38, 28928
    buffer_load_dwordx4 v72, s[12:15], s35 offen lds
    s_add_u32 m0, s39, 70656
    s_add_u32 s35, s38, 36096
    buffer_load_dwordx4 v72, s[12:15], s35 offen lds
    s_add_u32 m0, s39, 71680
    s_add_u32 s35, s38, 43264
    buffer_load_dwordx4 v72, s[12:15], s35 offen lds
    s_add_u32 m0, s39, 72704
    s_add_u32 s35, s38, 50432
    buffer_load_dwordx4 v72, s[12:15], s35 offen lds
    ds_read_b64_tr_b16 v[32:33], v73 offset:0
    ds_read_b64_tr_b16 v[34:35], v73 offset:512
    ds_read_b64_tr_b16 v[36:37], v73 offset:4096
    ds_read_b64_tr_b16 v[38:39], v73 offset:4608
    ds_read_b64_tr_b16 v[40:41], v73 offset:8192
    ds_read_b64_tr_b16 v[42:43], v73 offset:8704
    ds_read_b64_tr_b16 v[44:45], v73 offset:12288
    ds_read_b64_tr_b16 v[46:47], v73 offset:12800
    ds_read_b64_tr_b16 v[48:49], v73 offset:16384
    ds_read_b64_tr_b16 v[50:51], v73 offset:16896
    ds_read_b64_tr_b16 v[52:53], v73 offset:20480
    ds_read_b64_tr_b16 v[54:55], v73 offset:20992
    ds_read_b64_tr_b16 v[56:57], v73 offset:24576
    ds_read_b64_tr_b16 v[58:59], v73 offset:25088
    s_waitcnt lgkmcnt(8)
    ds_read_b64_tr_b16 v[60:61], v73 offset:28672
    ds_read_b64_tr_b16 v[62:63], v73 offset:29184
    s_waitcnt lgkmcnt(0)
    v_mfma_f32_16x16x32_bf16 v[8:11], v[128:131], v[32:35], 0
    v_mfma_f32_16x16x32_bf16 v[12:15], v[160:163], v[32:35], 0
    v_mfma_f32_16x16x32_bf16 v[16:19], v[192:195], v[32:35], 0
    v_mfma_f32_16x16x32_bf16 v[20:23], v[224:227], v[32:35], 0
    v_mfma_f32_16x16x32_bf16 v[8:11], v[132:135], v[36:39], v[8:11]
    v_mfma_f32_16x16x32_bf16 v[12:15], v[164:167], v[36:39], v[12:15]
    v_mfma_f32_16x16x32_bf16 v[16:19], v[196:199], v[36:39], v[16:19]
    v_mfma_f32_16x16x32_bf16 v[20:23], v[228:231], v[36:39], v[20:23]
    v_mfma_f32_16x16x32_bf16 v[8:11], v[136:139], v[40:43], v[8:11]
    v_mfma_f32_16x16x32_bf16 v[12:15], v[168:171], v[40:43], v[12:15]
    v_mfma_f32_16x16x32_bf16 v[16:19], v[200:203], v[40:43], v[16:19]
    v_mfma_f32_16x16x32_bf16 v[20:23], v[232:235], v[40:43], v[20:23]
    v_mfma_f32_16x16x32_bf16 v[8:11], v[140:143], v[44:47], v[8:11]
    v_mfma_f32_16x16x32_bf16 v[12:15], v[172:175], v[44:47], v[12:15]
    v_mfma_f32_16x16x32_bf16 v[16:19], v[204:207], v[44:47], v[16:19]
    v_mfma_f32_16x16x32_bf16 v[20:23], v[236:239], v[44:47], v[20:23]
    v_mfma_f32_16x16x32_bf16 v[8:11], v[144:147], v[48:51], v[8:11]
    v_mfma_f32_16x16x32_bf16 v[12:15], v[176:179], v[48:51], v[12:15]
    v_mfma_f32_16x16x32_bf16 v[16:19], v[208:211], v[48:51], v[16:19]
    v_mfma_f32_16x16x32_bf16 v[20:23], v[240:243], v[48:51], v[20:23]
    v_mfma_f32_16x16x32_bf16 v[8:11], v[148:151], v[52:55], v[8:11]
    v_mfma_f32_16x16x32_bf16 v[12:15], v[180:183], v[52:55], v[12:15]
    v_mfma_f32_16x16x32_bf16 v[16:19], v[212:215], v[52:55], v[16:19]
    v_mfma_f32_16x16x32_bf16 v[20:23], v[244:247], v[52:55], v[20:23]
    v_mfma_f32_16x16x32_bf16 v[8:11], v[152:155], v[56:59], v[8:11]
    v_mfma_f32_16x16x32_bf16 v[12:15], v[184:187], v[56:59], v[12:15]
    v_mfma_f32_16x16x32_bf16 v[16:19], v[216:219], v[56:59], v[16:19]
    v_mfma_f32_16x16x32_bf16 v[20:23], v[248:251], v[56:59], v[20:23]
    v_mfma_f32_16x16x32_bf16 v[8:11], v[156:159], v[60:63], v[8:11]
    v_mfma_f32_16x16x32_bf16 v[12:15], v[188:191], v[60:63], v[12:15]
    v_mfma_f32_16x16x32_bf16 v[16:19], v[220:223], v[60:63], v[16:19]
    v_mfma_f32_16x16x32_bf16 v[20:23], v[252:255], v[60:63], v[20:23]
    s_waitcnt vmcnt(8)
    s_barrier
    s_add_u32 m0, s39, 0
    s_add_u32 s35, s38, 384
    buffer_load_dwordx4 v72, s[12:15], s35 offen lds
    s_add_u32 m0, s39, 1024
    s_add_u32 s35, s38, 7552
    buffer_load_dwordx4 v72, s[12:15], s35 offen lds
    s_add_u32 m0, s39, 2048
    s_add_u32 s35, s38, 14720
    buffer_load_dwordx4 v72, s[12:15], s35 offen lds
    s_add_u32 m0, s39, 3072
    s_add_u32 s35, s38, 21888
    buffer_load_dwordx4 v72, s[12:15], s35 offen lds
    s_add_u32 m0, s39, 4096
    s_add_u32 s35, s38, 29056
    buffer_load_dwordx4 v72, s[12:15], s35 offen lds
    s_add_u32 m0, s39, 5120
    s_add_u32 s35, s38, 36224
    buffer_load_dwordx4 v72, s[12:15], s35 offen lds
    s_add_u32 m0, s39, 6144
    s_add_u32 s35, s38, 43392
    buffer_load_dwordx4 v72, s[12:15], s35 offen lds
    s_add_u32 m0, s39, 7168
    s_add_u32 s35, s38, 50560
    buffer_load_dwordx4 v72, s[12:15], s35 offen lds
    ds_read_b64_tr_b16 v[32:33], v73 offset:32768
    ds_read_b64_tr_b16 v[34:35], v73 offset:33280
    ds_read_b64_tr_b16 v[36:37], v73 offset:36864
    ds_read_b64_tr_b16 v[38:39], v73 offset:37376
    ds_read_b64_tr_b16 v[40:41], v73 offset:40960
    ds_read_b64_tr_b16 v[42:43], v73 offset:41472
    ds_read_b64_tr_b16 v[44:45], v73 offset:45056
    ds_read_b64_tr_b16 v[46:47], v73 offset:45568
    ds_read_b64_tr_b16 v[48:49], v73 offset:49152
    ds_read_b64_tr_b16 v[50:51], v73 offset:49664
    ds_read_b64_tr_b16 v[52:53], v73 offset:53248
    ds_read_b64_tr_b16 v[54:55], v73 offset:53760
    ds_read_b64_tr_b16 v[56:57], v73 offset:57344
    ds_read_b64_tr_b16 v[58:59], v73 offset:57856
    s_waitcnt lgkmcnt(8)
    ds_read_b64_tr_b16 v[60:61], v73 offset:61440
    ds_read_b64_tr_b16 v[62:63], v73 offset:61952
    s_waitcnt lgkmcnt(0)
    v_mfma_f32_16x16x32_bf16 v[84:87], v[128:131], v[32:35], 0
    s_add_u32 s43, s28, 0
    s_lshr_b32 s40, s31, 1
    s_mul_i32 s40, s40, 28
    s_add_u32 s40, s40, s43
    s_lshl_b32 s40, s40, 1
    s_and_b32 s42, s31, 1
    s_add_u32 s40, s40, s42
    s_mul_i32 s40, s40, 14336
    s_add_u32 s40, s40, 19267584
    v_mfma_f32_16x16x32_bf16 v[88:91], v[160:163], v[32:35], 0
    s_lshr_b32 s41, s43, 1
    s_lshl_b32 s41, s41, 2
    s_lshr_b32 s42, s31, 2
    s_add_u32 s41, s41, s42
    s_mul_i32 s41, s41, 56
    s_and_b32 s42, s43, 1
    s_lshl_b32 s42, s42, 2
    s_and_b32 s44, s31, 3
    s_add_u32 s42, s42, s44
    v_mfma_f32_16x16x32_bf16 v[92:95], v[192:195], v[32:35], 0
    s_mul_i32 s42, s42, 7
    s_add_u32 s41, s41, s42
    s_add_u32 s41, s41, s32
    s_lshl_b32 s41, s41, 11
    s_add_u32 s41, s41, 6422528
    s_lshl_b32 s42, s32, 11
    s_add_u32 s40, s40, s42
    v_mfma_f32_16x16x32_bf16 v[96:99], v[224:227], v[32:35], 0
    v_cvt_pk_bf16_f32 v24, v8, v9
    v_cvt_pk_bf16_f32 v25, v10, v11
    v_cvt_pk_bf16_f32 v26, v12, v13
    v_mfma_f32_16x16x32_bf16 v[84:87], v[132:135], v[36:39], v[84:87]
    v_cvt_pk_bf16_f32 v27, v14, v15
    buffer_store_dwordx4 v[24:27], v1, s[56:59], s40 offen offset:0 sc1
    v_cvt_pk_bf16_f32 v28, v16, v17
    v_mfma_f32_16x16x32_bf16 v[88:91], v[164:167], v[36:39], v[88:91]
    v_cvt_pk_bf16_f32 v29, v18, v19
    v_cvt_pk_bf16_f32 v30, v20, v21
    v_cvt_pk_bf16_f32 v31, v22, v23
    v_mfma_f32_16x16x32_bf16 v[92:95], v[196:199], v[36:39], v[92:95]
    buffer_store_dwordx4 v[28:31], v1, s[56:59], s40 offen offset:1024 sc1
    v_mov_b32 v100, v24
    v_mov_b32 v101, v28
    v_mfma_f32_16x16x32_bf16 v[96:99], v[228:231], v[36:39], v[96:99]
    v_mov_b32 v102, v25
    v_mov_b32 v103, v29
    buffer_store_dwordx4 v[100:103], v3, s[56:59], s41 offen offset:0 sc1
    v_mfma_f32_16x16x32_bf16 v[84:87], v[136:139], v[40:43], v[84:87]
    v_mov_b32 v104, v26
    v_mov_b32 v105, v30
    v_mov_b32 v106, v27
    v_mfma_f32_16x16x32_bf16 v[88:91], v[168:171], v[40:43], v[88:91]
    v_mov_b32 v107, v31
    buffer_store_dwordx4 v[104:107], v3, s[56:59], s41 offen offset:256 sc1
    v_mfma_f32_16x16x32_bf16 v[92:95], v[200:203], v[40:43], v[92:95]
    v_mfma_f32_16x16x32_bf16 v[96:99], v[232:235], v[40:43], v[96:99]
    v_mfma_f32_16x16x32_bf16 v[84:87], v[140:143], v[44:47], v[84:87]
    v_mfma_f32_16x16x32_bf16 v[88:91], v[172:175], v[44:47], v[88:91]
    v_mfma_f32_16x16x32_bf16 v[92:95], v[204:207], v[44:47], v[92:95]
    v_mfma_f32_16x16x32_bf16 v[96:99], v[236:239], v[44:47], v[96:99]
    v_mfma_f32_16x16x32_bf16 v[84:87], v[144:147], v[48:51], v[84:87]
    v_mfma_f32_16x16x32_bf16 v[88:91], v[176:179], v[48:51], v[88:91]
    v_mfma_f32_16x16x32_bf16 v[92:95], v[208:211], v[48:51], v[92:95]
    v_mfma_f32_16x16x32_bf16 v[96:99], v[240:243], v[48:51], v[96:99]
    v_mfma_f32_16x16x32_bf16 v[84:87], v[148:151], v[52:55], v[84:87]
    v_mfma_f32_16x16x32_bf16 v[88:91], v[180:183], v[52:55], v[88:91]
    v_mfma_f32_16x16x32_bf16 v[92:95], v[212:215], v[52:55], v[92:95]
    v_mfma_f32_16x16x32_bf16 v[96:99], v[244:247], v[52:55], v[96:99]
    v_mfma_f32_16x16x32_bf16 v[84:87], v[152:155], v[56:59], v[84:87]
    v_mfma_f32_16x16x32_bf16 v[88:91], v[184:187], v[56:59], v[88:91]
    v_mfma_f32_16x16x32_bf16 v[92:95], v[216:219], v[56:59], v[92:95]
    v_mfma_f32_16x16x32_bf16 v[96:99], v[248:251], v[56:59], v[96:99]
    v_mfma_f32_16x16x32_bf16 v[84:87], v[156:159], v[60:63], v[84:87]
    v_mfma_f32_16x16x32_bf16 v[88:91], v[188:191], v[60:63], v[88:91]
    v_mfma_f32_16x16x32_bf16 v[92:95], v[220:223], v[60:63], v[92:95]
    v_mfma_f32_16x16x32_bf16 v[96:99], v[252:255], v[60:63], v[96:99]
    s_waitcnt vmcnt(12)
    s_barrier
    s_add_u32 m0, s39, 32768
    s_add_u32 s35, s38, 512
    buffer_load_dwordx4 v72, s[12:15], s35 offen lds
    s_add_u32 m0, s39, 33792
    s_add_u32 s35, s38, 7680
    buffer_load_dwordx4 v72, s[12:15], s35 offen lds
    s_add_u32 m0, s39, 34816
    s_add_u32 s35, s38, 14848
    buffer_load_dwordx4 v72, s[12:15], s35 offen lds
    s_add_u32 m0, s39, 35840
    s_add_u32 s35, s38, 22016
    buffer_load_dwordx4 v72, s[12:15], s35 offen lds
    s_add_u32 m0, s39, 36864
    s_add_u32 s35, s38, 29184
    buffer_load_dwordx4 v72, s[12:15], s35 offen lds
    s_add_u32 m0, s39, 37888
    s_add_u32 s35, s38, 36352
    buffer_load_dwordx4 v72, s[12:15], s35 offen lds
    s_add_u32 m0, s39, 38912
    s_add_u32 s35, s38, 43520
    buffer_load_dwordx4 v72, s[12:15], s35 offen lds
    s_add_u32 m0, s39, 39936
    s_add_u32 s35, s38, 50688
    buffer_load_dwordx4 v72, s[12:15], s35 offen lds
    ds_read_b64_tr_b16 v[32:33], v74 offset:0
    ds_read_b64_tr_b16 v[34:35], v74 offset:512
    ds_read_b64_tr_b16 v[36:37], v74 offset:4096
    ds_read_b64_tr_b16 v[38:39], v74 offset:4608
    ds_read_b64_tr_b16 v[40:41], v74 offset:8192
    ds_read_b64_tr_b16 v[42:43], v74 offset:8704
    ds_read_b64_tr_b16 v[44:45], v74 offset:12288
    ds_read_b64_tr_b16 v[46:47], v74 offset:12800
    ds_read_b64_tr_b16 v[48:49], v74 offset:16384
    ds_read_b64_tr_b16 v[50:51], v74 offset:16896
    ds_read_b64_tr_b16 v[52:53], v74 offset:20480
    ds_read_b64_tr_b16 v[54:55], v74 offset:20992
    ds_read_b64_tr_b16 v[56:57], v74 offset:24576
    ds_read_b64_tr_b16 v[58:59], v74 offset:25088
    s_waitcnt lgkmcnt(8)
    ds_read_b64_tr_b16 v[60:61], v74 offset:28672
    ds_read_b64_tr_b16 v[62:63], v74 offset:29184
    s_waitcnt lgkmcnt(0)
    v_mfma_f32_16x16x32_bf16 v[8:11], v[128:131], v[32:35], 0
    s_add_u32 s43, s28, 4
    s_lshr_b32 s40, s31, 1
    s_mul_i32 s40, s40, 28
    s_add_u32 s40, s40, s43
    s_lshl_b32 s40, s40, 1
    s_and_b32 s42, s31, 1
    s_add_u32 s40, s40, s42
    s_mul_i32 s40, s40, 14336
    s_add_u32 s40, s40, 19267584
    v_mfma_f32_16x16x32_bf16 v[12:15], v[160:163], v[32:35], 0
    s_lshr_b32 s41, s43, 1
    s_lshl_b32 s41, s41, 2
    s_lshr_b32 s42, s31, 2
    s_add_u32 s41, s41, s42
    s_mul_i32 s41, s41, 56
    s_and_b32 s42, s43, 1
    s_lshl_b32 s42, s42, 2
    s_and_b32 s44, s31, 3
    s_add_u32 s42, s42, s44
    v_mfma_f32_16x16x32_bf16 v[16:19], v[192:195], v[32:35], 0
    s_mul_i32 s42, s42, 7
    s_add_u32 s41, s41, s42
    s_add_u32 s41, s41, s32
    s_lshl_b32 s41, s41, 11
    s_add_u32 s41, s41, 6422528
    s_lshl_b32 s42, s32, 11
    s_add_u32 s40, s40, s42
    v_mfma_f32_16x16x32_bf16 v[20:23], v[224:227], v[32:35], 0
    v_cvt_pk_bf16_f32 v24, v84, v85
    v_cvt_pk_bf16_f32 v25, v86, v87
    v_cvt_pk_bf16_f32 v26, v88, v89
    v_mfma_f32_16x16x32_bf16 v[8:11], v[132:135], v[36:39], v[8:11]
    v_cvt_pk_bf16_f32 v27, v90, v91
    buffer_store_dwordx4 v[24:27], v1, s[56:59], s40 offen offset:0 sc1
    v_cvt_pk_bf16_f32 v28, v92, v93
    v_mfma_f32_16x16x32_bf16 v[12:15], v[164:167], v[36:39], v[12:15]
    v_cvt_pk_bf16_f32 v29, v94, v95
    v_cvt_pk_bf16_f32 v30, v96, v97
    v_cvt_pk_bf16_f32 v31, v98, v99
    v_mfma_f32_16x16x32_bf16 v[16:19], v[196:199], v[36:39], v[16:19]
    buffer_store_dwordx4 v[28:31], v1, s[56:59], s40 offen offset:1024 sc1
    v_mov_b32 v100, v24
    v_mov_b32 v101, v28
    v_mfma_f32_16x16x32_bf16 v[20:23], v[228:231], v[36:39], v[20:23]
    v_mov_b32 v102, v25
    v_mov_b32 v103, v29
    buffer_store_dwordx4 v[100:103], v3, s[56:59], s41 offen offset:0 sc1
    v_mfma_f32_16x16x32_bf16 v[8:11], v[136:139], v[40:43], v[8:11]
    v_mov_b32 v104, v26
    v_mov_b32 v105, v30
    v_mov_b32 v106, v27
    v_mfma_f32_16x16x32_bf16 v[12:15], v[168:171], v[40:43], v[12:15]
    v_mov_b32 v107, v31
    buffer_store_dwordx4 v[104:107], v3, s[56:59], s41 offen offset:256 sc1
    v_mfma_f32_16x16x32_bf16 v[16:19], v[200:203], v[40:43], v[16:19]
    v_mfma_f32_16x16x32_bf16 v[20:23], v[232:235], v[40:43], v[20:23]
    v_mfma_f32_16x16x32_bf16 v[8:11], v[140:143], v[44:47], v[8:11]
    v_mfma_f32_16x16x32_bf16 v[12:15], v[172:175], v[44:47], v[12:15]
    v_mfma_f32_16x16x32_bf16 v[16:19], v[204:207], v[44:47], v[16:19]
    v_mfma_f32_16x16x32_bf16 v[20:23], v[236:239], v[44:47], v[20:23]
    v_mfma_f32_16x16x32_bf16 v[8:11], v[144:147], v[48:51], v[8:11]
    v_mfma_f32_16x16x32_bf16 v[12:15], v[176:179], v[48:51], v[12:15]
    v_mfma_f32_16x16x32_bf16 v[16:19], v[208:211], v[48:51], v[16:19]
    v_mfma_f32_16x16x32_bf16 v[20:23], v[240:243], v[48:51], v[20:23]
    v_mfma_f32_16x16x32_bf16 v[8:11], v[148:151], v[52:55], v[8:11]
    v_mfma_f32_16x16x32_bf16 v[12:15], v[180:183], v[52:55], v[12:15]
    v_mfma_f32_16x16x32_bf16 v[16:19], v[212:215], v[52:55], v[16:19]
    v_mfma_f32_16x16x32_bf16 v[20:23], v[244:247], v[52:55], v[20:23]
    v_mfma_f32_16x16x32_bf16 v[8:11], v[152:155], v[56:59], v[8:11]
    v_mfma_f32_16x16x32_bf16 v[12:15], v[184:187], v[56:59], v[12:15]
    v_mfma_f32_16x16x32_bf16 v[16:19], v[216:219], v[56:59], v[16:19]
    v_mfma_f32_16x16x32_bf16 v[20:23], v[248:251], v[56:59], v[20:23]
    v_mfma_f32_16x16x32_bf16 v[8:11], v[156:159], v[60:63], v[8:11]
    v_mfma_f32_16x16x32_bf16 v[12:15], v[188:191], v[60:63], v[12:15]
    v_mfma_f32_16x16x32_bf16 v[16:19], v[220:223], v[60:63], v[16:19]
    v_mfma_f32_16x16x32_bf16 v[20:23], v[252:255], v[60:63], v[20:23]
    s_waitcnt vmcnt(12)
    s_barrier
    s_add_u32 m0, s39, 65536
    s_add_u32 s35, s38, 640
    buffer_load_dwordx4 v72, s[12:15], s35 offen lds
    s_add_u32 m0, s39, 66560
    s_add_u32 s35, s38, 7808
    buffer_load_dwordx4 v72, s[12:15], s35 offen lds
    s_add_u32 m0, s39, 67584
    s_add_u32 s35, s38, 14976
    buffer_load_dwordx4 v72, s[12:15], s35 offen lds
    s_add_u32 m0, s39, 68608
    s_add_u32 s35, s38, 22144
    buffer_load_dwordx4 v72, s[12:15], s35 offen lds
    s_add_u32 m0, s39, 69632
    s_add_u32 s35, s38, 29312
    buffer_load_dwordx4 v72, s[12:15], s35 offen lds
    s_add_u32 m0, s39, 70656
    s_add_u32 s35, s38, 36480
    buffer_load_dwordx4 v72, s[12:15], s35 offen lds
    s_add_u32 m0, s39, 71680
    s_add_u32 s35, s38, 43648
    buffer_load_dwordx4 v72, s[12:15], s35 offen lds
    s_add_u32 m0, s39, 72704
    s_add_u32 s35, s38, 50816
    buffer_load_dwordx4 v72, s[12:15], s35 offen lds
    ds_read_b64_tr_b16 v[32:33], v73 offset:0
    ds_read_b64_tr_b16 v[34:35], v73 offset:512
    ds_read_b64_tr_b16 v[36:37], v73 offset:4096
    ds_read_b64_tr_b16 v[38:39], v73 offset:4608
    ds_read_b64_tr_b16 v[40:41], v73 offset:8192
    ds_read_b64_tr_b16 v[42:43], v73 offset:8704
    ds_read_b64_tr_b16 v[44:45], v73 offset:12288
    ds_read_b64_tr_b16 v[46:47], v73 offset:12800
    ds_read_b64_tr_b16 v[48:49], v73 offset:16384
    ds_read_b64_tr_b16 v[50:51], v73 offset:16896
    ds_read_b64_tr_b16 v[52:53], v73 offset:20480
    ds_read_b64_tr_b16 v[54:55], v73 offset:20992
    ds_read_b64_tr_b16 v[56:57], v73 offset:24576
    ds_read_b64_tr_b16 v[58:59], v73 offset:25088
    s_waitcnt lgkmcnt(8)
    ds_read_b64_tr_b16 v[60:61], v73 offset:28672
    ds_read_b64_tr_b16 v[62:63], v73 offset:29184
    s_waitcnt lgkmcnt(0)
    v_mfma_f32_16x16x32_bf16 v[84:87], v[128:131], v[32:35], 0
    s_add_u32 s43, s28, 8
    s_lshr_b32 s40, s31, 1
    s_mul_i32 s40, s40, 28
    s_add_u32 s40, s40, s43
    s_lshl_b32 s40, s40, 1
    s_and_b32 s42, s31, 1
    s_add_u32 s40, s40, s42
    s_mul_i32 s40, s40, 14336
    s_add_u32 s40, s40, 19267584
    v_mfma_f32_16x16x32_bf16 v[88:91], v[160:163], v[32:35], 0
    s_lshr_b32 s41, s43, 1
    s_lshl_b32 s41, s41, 2
    s_lshr_b32 s42, s31, 2
    s_add_u32 s41, s41, s42
    s_mul_i32 s41, s41, 56
    s_and_b32 s42, s43, 1
    s_lshl_b32 s42, s42, 2
    s_and_b32 s44, s31, 3
    s_add_u32 s42, s42, s44
    v_mfma_f32_16x16x32_bf16 v[92:95], v[192:195], v[32:35], 0
    s_mul_i32 s42, s42, 7
    s_add_u32 s41, s41, s42
    s_add_u32 s41, s41, s32
    s_lshl_b32 s41, s41, 11
    s_add_u32 s41, s41, 6422528
    s_lshl_b32 s42, s32, 11
    s_add_u32 s40, s40, s42
    v_mfma_f32_16x16x32_bf16 v[96:99], v[224:227], v[32:35], 0
    v_cvt_pk_bf16_f32 v24, v8, v9
    v_cvt_pk_bf16_f32 v25, v10, v11
    v_cvt_pk_bf16_f32 v26, v12, v13
    v_mfma_f32_16x16x32_bf16 v[84:87], v[132:135], v[36:39], v[84:87]
    v_cvt_pk_bf16_f32 v27, v14, v15
    buffer_store_dwordx4 v[24:27], v1, s[56:59], s40 offen offset:0 sc1
    v_cvt_pk_bf16_f32 v28, v16, v17
    v_mfma_f32_16x16x32_bf16 v[88:91], v[164:167], v[36:39], v[88:91]
    v_cvt_pk_bf16_f32 v29, v18, v19
    v_cvt_pk_bf16_f32 v30, v20, v21
    v_cvt_pk_bf16_f32 v31, v22, v23
    v_mfma_f32_16x16x32_bf16 v[92:95], v[196:199], v[36:39], v[92:95]
    buffer_store_dwordx4 v[28:31], v1, s[56:59], s40 offen offset:1024 sc1
    v_mov_b32 v100, v24
    v_mov_b32 v101, v28
    v_mfma_f32_16x16x32_bf16 v[96:99], v[228:231], v[36:39], v[96:99]
    v_mov_b32 v102, v25
    v_mov_b32 v103, v29
    buffer_store_dwordx4 v[100:103], v3, s[56:59], s41 offen offset:0 sc1
    v_mfma_f32_16x16x32_bf16 v[84:87], v[136:139], v[40:43], v[84:87]
    v_mov_b32 v104, v26
    v_mov_b32 v105, v30
    v_mov_b32 v106, v27
    v_mfma_f32_16x16x32_bf16 v[88:91], v[168:171], v[40:43], v[88:91]
    v_mov_b32 v107, v31
    buffer_store_dwordx4 v[104:107], v3, s[56:59], s41 offen offset:256 sc1
    v_mfma_f32_16x16x32_bf16 v[92:95], v[200:203], v[40:43], v[92:95]
    v_mfma_f32_16x16x32_bf16 v[96:99], v[232:235], v[40:43], v[96:99]
    v_mfma_f32_16x16x32_bf16 v[84:87], v[140:143], v[44:47], v[84:87]
    v_mfma_f32_16x16x32_bf16 v[88:91], v[172:175], v[44:47], v[88:91]
    v_mfma_f32_16x16x32_bf16 v[92:95], v[204:207], v[44:47], v[92:95]
    v_mfma_f32_16x16x32_bf16 v[96:99], v[236:239], v[44:47], v[96:99]
    v_mfma_f32_16x16x32_bf16 v[84:87], v[144:147], v[48:51], v[84:87]
    v_mfma_f32_16x16x32_bf16 v[88:91], v[176:179], v[48:51], v[88:91]
    v_mfma_f32_16x16x32_bf16 v[92:95], v[208:211], v[48:51], v[92:95]
    v_mfma_f32_16x16x32_bf16 v[96:99], v[240:243], v[48:51], v[96:99]
    v_mfma_f32_16x16x32_bf16 v[84:87], v[148:151], v[52:55], v[84:87]
    v_mfma_f32_16x16x32_bf16 v[88:91], v[180:183], v[52:55], v[88:91]
    v_mfma_f32_16x16x32_bf16 v[92:95], v[212:215], v[52:55], v[92:95]
    v_mfma_f32_16x16x32_bf16 v[96:99], v[244:247], v[52:55], v[96:99]
    v_mfma_f32_16x16x32_bf16 v[84:87], v[152:155], v[56:59], v[84:87]
    v_mfma_f32_16x16x32_bf16 v[88:91], v[184:187], v[56:59], v[88:91]
    v_mfma_f32_16x16x32_bf16 v[92:95], v[216:219], v[56:59], v[92:95]
    v_mfma_f32_16x16x32_bf16 v[96:99], v[248:251], v[56:59], v[96:99]
    v_mfma_f32_16x16x32_bf16 v[84:87], v[156:159], v[60:63], v[84:87]
    v_mfma_f32_16x16x32_bf16 v[88:91], v[188:191], v[60:63], v[88:91]
    v_mfma_f32_16x16x32_bf16 v[92:95], v[220:223], v[60:63], v[92:95]
    v_mfma_f32_16x16x32_bf16 v[96:99], v[252:255], v[60:63], v[96:99]
    s_waitcnt vmcnt(12)
    s_barrier
    s_add_u32 m0, s39, 0
    s_add_u32 s35, s38, 768
    buffer_load_dwordx4 v72, s[12:15], s35 offen lds
    s_add_u32 m0, s39, 1024
    s_add_u32 s35, s38, 7936
    buffer_load_dwordx4 v72, s[12:15], s35 offen lds
    s_add_u32 m0, s39, 2048
    s_add_u32 s35, s38, 15104
    buffer_load_dwordx4 v72, s[12:15], s35 offen lds
    s_add_u32 m0, s39, 3072
    s_add_u32 s35, s38, 22272
    buffer_load_dwordx4 v72, s[12:15], s35 offen lds
    s_add_u32 m0, s39, 4096
    s_add_u32 s35, s38, 29440
    buffer_load_dwordx4 v72, s[12:15], s35 offen lds
    s_add_u32 m0, s39, 5120
    s_add_u32 s35, s38, 36608
    buffer_load_dwordx4 v72, s[12:15], s35 offen lds
    s_add_u32 m0, s39, 6144
    s_add_u32 s35, s38, 43776
    buffer_load_dwordx4 v72, s[12:15], s35 offen lds
    s_add_u32 m0, s39, 7168
    s_add_u32 s35, s38, 50944
    buffer_load_dwordx4 v72, s[12:15], s35 offen lds
    ds_read_b64_tr_b16 v[32:33], v73 offset:32768
    ds_read_b64_tr_b16 v[34:35], v73 offset:33280
    ds_read_b64_tr_b16 v[36:37], v73 offset:36864
    ds_read_b64_tr_b16 v[38:39], v73 offset:37376
    ds_read_b64_tr_b16 v[40:41], v73 offset:40960
    ds_read_b64_tr_b16 v[42:43], v73 offset:41472
    ds_read_b64_tr_b16 v[44:45], v73 offset:45056
    ds_read_b64_tr_b16 v[46:47], v73 offset:45568
    ds_read_b64_tr_b16 v[48:49], v73 offset:49152
    ds_read_b64_tr_b16 v[50:51], v73 offset:49664
    ds_read_b64_tr_b16 v[52:53], v73 offset:53248
    ds_read_b64_tr_b16 v[54:55], v73 offset:53760
    ds_read_b64_tr_b16 v[56:57], v73 offset:57344
    ds_read_b64_tr_b16 v[58:59], v73 offset:57856
    s_waitcnt lgkmcnt(8)
    ds_read_b64_tr_b16 v[60:61], v73 offset:61440
    ds_read_b64_tr_b16 v[62:63], v73 offset:61952
    s_waitcnt lgkmcnt(0)
    v_mfma_f32_16x16x32_bf16 v[8:11], v[128:131], v[32:35], 0
    s_add_u32 s43, s28, 12
    s_lshr_b32 s40, s31, 1
    s_mul_i32 s40, s40, 28
    s_add_u32 s40, s40, s43
    s_lshl_b32 s40, s40, 1
    s_and_b32 s42, s31, 1
    s_add_u32 s40, s40, s42
    s_mul_i32 s40, s40, 14336
    s_add_u32 s40, s40, 19267584
    v_mfma_f32_16x16x32_bf16 v[12:15], v[160:163], v[32:35], 0
    s_lshr_b32 s41, s43, 1
    s_lshl_b32 s41, s41, 2
    s_lshr_b32 s42, s31, 2
    s_add_u32 s41, s41, s42
    s_mul_i32 s41, s41, 56
    s_and_b32 s42, s43, 1
    s_lshl_b32 s42, s42, 2
    s_and_b32 s44, s31, 3
    s_add_u32 s42, s42, s44
    v_mfma_f32_16x16x32_bf16 v[16:19], v[192:195], v[32:35], 0
    s_mul_i32 s42, s42, 7
    s_add_u32 s41, s41, s42
    s_add_u32 s41, s41, s32
    s_lshl_b32 s41, s41, 11
    s_add_u32 s41, s41, 6422528
    s_lshl_b32 s42, s32, 11
    s_add_u32 s40, s40, s42
    v_mfma_f32_16x16x32_bf16 v[20:23], v[224:227], v[32:35], 0
    v_cvt_pk_bf16_f32 v24, v84, v85
    v_cvt_pk_bf16_f32 v25, v86, v87
    v_cvt_pk_bf16_f32 v26, v88, v89
    v_mfma_f32_16x16x32_bf16 v[8:11], v[132:135], v[36:39], v[8:11]
    v_cvt_pk_bf16_f32 v27, v90, v91
    buffer_store_dwordx4 v[24:27], v1, s[56:59], s40 offen offset:0 sc1
    v_cvt_pk_bf16_f32 v28, v92, v93
    v_mfma_f32_16x16x32_bf16 v[12:15], v[164:167], v[36:39], v[12:15]
    v_cvt_pk_bf16_f32 v29, v94, v95
    v_cvt_pk_bf16_f32 v30, v96, v97
    v_cvt_pk_bf16_f32 v31, v98, v99
    v_mfma_f32_16x16x32_bf16 v[16:19], v[196:199], v[36:39], v[16:19]
    buffer_store_dwordx4 v[28:31], v1, s[56:59], s40 offen offset:1024 sc1
    v_mov_b32 v100, v24
    v_mov_b32 v101, v28
    v_mfma_f32_16x16x32_bf16 v[20:23], v[228:231], v[36:39], v[20:23]
    v_mov_b32 v102, v25
    v_mov_b32 v103, v29
    buffer_store_dwordx4 v[100:103], v3, s[56:59], s41 offen offset:0 sc1
    v_mfma_f32_16x16x32_bf16 v[8:11], v[136:139], v[40:43], v[8:11]
    v_mov_b32 v104, v26
    v_mov_b32 v105, v30
    v_mov_b32 v106, v27
    v_mfma_f32_16x16x32_bf16 v[12:15], v[168:171], v[40:43], v[12:15]
    v_mov_b32 v107, v31
    buffer_store_dwordx4 v[104:107], v3, s[56:59], s41 offen offset:256 sc1
    v_mfma_f32_16x16x32_bf16 v[16:19], v[200:203], v[40:43], v[16:19]
    v_mfma_f32_16x16x32_bf16 v[20:23], v[232:235], v[40:43], v[20:23]
    v_mfma_f32_16x16x32_bf16 v[8:11], v[140:143], v[44:47], v[8:11]
    v_mfma_f32_16x16x32_bf16 v[12:15], v[172:175], v[44:47], v[12:15]
    v_mfma_f32_16x16x32_bf16 v[16:19], v[204:207], v[44:47], v[16:19]
    v_mfma_f32_16x16x32_bf16 v[20:23], v[236:239], v[44:47], v[20:23]
    v_mfma_f32_16x16x32_bf16 v[8:11], v[144:147], v[48:51], v[8:11]
    v_mfma_f32_16x16x32_bf16 v[12:15], v[176:179], v[48:51], v[12:15]
    v_mfma_f32_16x16x32_bf16 v[16:19], v[208:211], v[48:51], v[16:19]
    v_mfma_f32_16x16x32_bf16 v[20:23], v[240:243], v[48:51], v[20:23]
    v_mfma_f32_16x16x32_bf16 v[8:11], v[148:151], v[52:55], v[8:11]
    v_mfma_f32_16x16x32_bf16 v[12:15], v[180:183], v[52:55], v[12:15]
    v_mfma_f32_16x16x32_bf16 v[16:19], v[212:215], v[52:55], v[16:19]
    v_mfma_f32_16x16x32_bf16 v[20:23], v[244:247], v[52:55], v[20:23]
    v_mfma_f32_16x16x32_bf16 v[8:11], v[152:155], v[56:59], v[8:11]
    v_mfma_f32_16x16x32_bf16 v[12:15], v[184:187], v[56:59], v[12:15]
    v_mfma_f32_16x16x32_bf16 v[16:19], v[216:219], v[56:59], v[16:19]
    v_mfma_f32_16x16x32_bf16 v[20:23], v[248:251], v[56:59], v[20:23]
    v_mfma_f32_16x16x32_bf16 v[8:11], v[156:159], v[60:63], v[8:11]
    v_mfma_f32_16x16x32_bf16 v[12:15], v[188:191], v[60:63], v[12:15]
    v_mfma_f32_16x16x32_bf16 v[16:19], v[220:223], v[60:63], v[16:19]
    v_mfma_f32_16x16x32_bf16 v[20:23], v[252:255], v[60:63], v[20:23]
    s_waitcnt vmcnt(12)
    s_barrier
    ds_read_b64_tr_b16 v[32:33], v74 offset:0
    ds_read_b64_tr_b16 v[34:35], v74 offset:512
    ds_read_b64_tr_b16 v[36:37], v74 offset:4096
    ds_read_b64_tr_b16 v[38:39], v74 offset:4608
    ds_read_b64_tr_b16 v[40:41], v74 offset:8192
    ds_read_b64_tr_b16 v[42:43], v74 offset:8704
    ds_read_b64_tr_b16 v[44:45], v74 offset:12288
    ds_read_b64_tr_b16 v[46:47], v74 offset:12800
    ds_read_b64_tr_b16 v[48:49], v74 offset:16384
    ds_read_b64_tr_b16 v[50:51], v74 offset:16896
    ds_read_b64_tr_b16 v[52:53], v74 offset:20480
    ds_read_b64_tr_b16 v[54:55], v74 offset:20992
    ds_read_b64_tr_b16 v[56:57], v74 offset:24576
    ds_read_b64_tr_b16 v[58:59], v74 offset:25088
    s_waitcnt lgkmcnt(8)
    ds_read_b64_tr_b16 v[60:61], v74 offset:28672
    ds_read_b64_tr_b16 v[62:63], v74 offset:29184
    s_waitcnt lgkmcnt(0)
    v_mfma_f32_16x16x32_bf16 v[84:87], v[128:131], v[32:35], 0
    s_add_u32 s43, s28, 16
    s_lshr_b32 s40, s31, 1
    s_mul_i32 s40, s40, 28
    s_add_u32 s40, s40, s43
    s_lshl_b32 s40, s40, 1
    s_and_b32 s42, s31, 1
    s_add_u32 s40, s40, s42
    s_mul_i32 s40, s40, 14336
    s_add_u32 s40, s40, 19267584
    v_mfma_f32_16x16x32_bf16 v[88:91], v[160:163], v[32:35], 0
    s_lshr_b32 s41, s43, 1
    s_lshl_b32 s41, s41, 2
    s_lshr_b32 s42, s31, 2
    s_add_u32 s41, s41, s42
    s_mul_i32 s41, s41, 56
    s_and_b32 s42, s43, 1
    s_lshl_b32 s42, s42, 2
    s_and_b32 s44, s31, 3
    s_add_u32 s42, s42, s44
    v_mfma_f32_16x16x32_bf16 v[92:95], v[192:195], v[32:35], 0
    s_mul_i32 s42, s42, 7
    s_add_u32 s41, s41, s42
    s_add_u32 s41, s41, s32
    s_lshl_b32 s41, s41, 11
    s_add_u32 s41, s41, 6422528
    s_lshl_b32 s42, s32, 11
    s_add_u32 s40, s40, s42
    v_mfma_f32_16x16x32_bf16 v[96:99], v[224:227], v[32:35], 0
    v_cvt_pk_bf16_f32 v24, v8, v9
    v_cvt_pk_bf16_f32 v25, v10, v11
    v_cvt_pk_bf16_f32 v26, v12, v13
    v_mfma_f32_16x16x32_bf16 v[84:87], v[132:135], v[36:39], v[84:87]
    v_cvt_pk_bf16_f32 v27, v14, v15
    buffer_store_dwordx4 v[24:27], v1, s[56:59], s40 offen offset:0 sc1
    v_cvt_pk_bf16_f32 v28, v16, v17
    v_mfma_f32_16x16x32_bf16 v[88:91], v[164:167], v[36:39], v[88:91]
    v_cvt_pk_bf16_f32 v29, v18, v19
    v_cvt_pk_bf16_f32 v30, v20, v21
    v_cvt_pk_bf16_f32 v31, v22, v23
    v_mfma_f32_16x16x32_bf16 v[92:95], v[196:199], v[36:39], v[92:95]
    buffer_store_dwordx4 v[28:31], v1, s[56:59], s40 offen offset:1024 sc1
    v_mov_b32 v100, v24
    v_mov_b32 v101, v28
    v_mfma_f32_16x16x32_bf16 v[96:99], v[228:231], v[36:39], v[96:99]
    v_mov_b32 v102, v25
    v_mov_b32 v103, v29
    buffer_store_dwordx4 v[100:103], v3, s[56:59], s41 offen offset:0 sc1
    v_mfma_f32_16x16x32_bf16 v[84:87], v[136:139], v[40:43], v[84:87]
    v_mov_b32 v104, v26
    v_mov_b32 v105, v30
    v_mov_b32 v106, v27
    v_mfma_f32_16x16x32_bf16 v[88:91], v[168:171], v[40:43], v[88:91]
    v_mov_b32 v107, v31
    buffer_store_dwordx4 v[104:107], v3, s[56:59], s41 offen offset:256 sc1
    v_mfma_f32_16x16x32_bf16 v[92:95], v[200:203], v[40:43], v[92:95]
    v_mfma_f32_16x16x32_bf16 v[96:99], v[232:235], v[40:43], v[96:99]
    v_mfma_f32_16x16x32_bf16 v[84:87], v[140:143], v[44:47], v[84:87]
    v_mfma_f32_16x16x32_bf16 v[88:91], v[172:175], v[44:47], v[88:91]
    v_mfma_f32_16x16x32_bf16 v[92:95], v[204:207], v[44:47], v[92:95]
    v_mfma_f32_16x16x32_bf16 v[96:99], v[236:239], v[44:47], v[96:99]
    v_mfma_f32_16x16x32_bf16 v[84:87], v[144:147], v[48:51], v[84:87]
    v_mfma_f32_16x16x32_bf16 v[88:91], v[176:179], v[48:51], v[88:91]
    v_mfma_f32_16x16x32_bf16 v[92:95], v[208:211], v[48:51], v[92:95]
    v_mfma_f32_16x16x32_bf16 v[96:99], v[240:243], v[48:51], v[96:99]
    v_mfma_f32_16x16x32_bf16 v[84:87], v[148:151], v[52:55], v[84:87]
    v_mfma_f32_16x16x32_bf16 v[88:91], v[180:183], v[52:55], v[88:91]
    v_mfma_f32_16x16x32_bf16 v[92:95], v[212:215], v[52:55], v[92:95]
    v_mfma_f32_16x16x32_bf16 v[96:99], v[244:247], v[52:55], v[96:99]
    v_mfma_f32_16x16x32_bf16 v[84:87], v[152:155], v[56:59], v[84:87]
    v_mfma_f32_16x16x32_bf16 v[88:91], v[184:187], v[56:59], v[88:91]
    v_mfma_f32_16x16x32_bf16 v[92:95], v[216:219], v[56:59], v[92:95]
    v_mfma_f32_16x16x32_bf16 v[96:99], v[248:251], v[56:59], v[96:99]
    v_mfma_f32_16x16x32_bf16 v[84:87], v[156:159], v[60:63], v[84:87]
    v_mfma_f32_16x16x32_bf16 v[88:91], v[188:191], v[60:63], v[88:91]
    v_mfma_f32_16x16x32_bf16 v[92:95], v[220:223], v[60:63], v[92:95]
    v_mfma_f32_16x16x32_bf16 v[96:99], v[252:255], v[60:63], v[96:99]
    s_waitcnt vmcnt(4)
    s_barrier
    ds_read_b64_tr_b16 v[32:33], v73 offset:0
    ds_read_b64_tr_b16 v[34:35], v73 offset:512
    ds_read_b64_tr_b16 v[36:37], v73 offset:4096
    ds_read_b64_tr_b16 v[38:39], v73 offset:4608
    ds_read_b64_tr_b16 v[40:41], v73 offset:8192
    ds_read_b64_tr_b16 v[42:43], v73 offset:8704
    ds_read_b64_tr_b16 v[44:45], v73 offset:12288
    ds_read_b64_tr_b16 v[46:47], v73 offset:12800
    ds_read_b64_tr_b16 v[48:49], v73 offset:16384
    ds_read_b64_tr_b16 v[50:51], v73 offset:16896
    ds_read_b64_tr_b16 v[52:53], v73 offset:20480
    ds_read_b64_tr_b16 v[54:55], v73 offset:20992
    ds_read_b64_tr_b16 v[56:57], v73 offset:24576
    ds_read_b64_tr_b16 v[58:59], v73 offset:25088
    s_waitcnt lgkmcnt(8)
    ds_read_b64_tr_b16 v[60:61], v73 offset:28672
    ds_read_b64_tr_b16 v[62:63], v73 offset:29184
    s_waitcnt lgkmcnt(0)
    v_mfma_f32_16x16x32_bf16 v[8:11], v[128:131], v[32:35], 0
    s_add_u32 s43, s28, 20
    s_lshr_b32 s40, s31, 1
    s_mul_i32 s40, s40, 28
    s_add_u32 s40, s40, s43
    s_lshl_b32 s40, s40, 1
    s_and_b32 s42, s31, 1
    s_add_u32 s40, s40, s42
    s_mul_i32 s40, s40, 14336
    s_add_u32 s40, s40, 19267584
    v_mfma_f32_16x16x32_bf16 v[12:15], v[160:163], v[32:35], 0
    s_lshr_b32 s41, s43, 1
    s_lshl_b32 s41, s41, 2
    s_lshr_b32 s42, s31, 2
    s_add_u32 s41, s41, s42
    s_mul_i32 s41, s41, 56
    s_and_b32 s42, s43, 1
    s_lshl_b32 s42, s42, 2
    s_and_b32 s44, s31, 3
    s_add_u32 s42, s42, s44
    v_mfma_f32_16x16x32_bf16 v[16:19], v[192:195], v[32:35], 0
    s_mul_i32 s42, s42, 7
    s_add_u32 s41, s41, s42
    s_add_u32 s41, s41, s32
    s_lshl_b32 s41, s41, 11
    s_add_u32 s41, s41, 6422528
    s_lshl_b32 s42, s32, 11
    s_add_u32 s40, s40, s42
    v_mfma_f32_16x16x32_bf16 v[20:23], v[224:227], v[32:35], 0
    v_cvt_pk_bf16_f32 v24, v84, v85
    v_cvt_pk_bf16_f32 v25, v86, v87
    v_cvt_pk_bf16_f32 v26, v88, v89
    v_mfma_f32_16x16x32_bf16 v[8:11], v[132:135], v[36:39], v[8:11]
    v_cvt_pk_bf16_f32 v27, v90, v91
    buffer_store_dwordx4 v[24:27], v1, s[56:59], s40 offen offset:0 sc1
    v_cvt_pk_bf16_f32 v28, v92, v93
    v_mfma_f32_16x16x32_bf16 v[12:15], v[164:167], v[36:39], v[12:15]
    v_cvt_pk_bf16_f32 v29, v94, v95
    v_cvt_pk_bf16_f32 v30, v96, v97
    v_cvt_pk_bf16_f32 v31, v98, v99
    v_mfma_f32_16x16x32_bf16 v[16:19], v[196:199], v[36:39], v[16:19]
    buffer_store_dwordx4 v[28:31], v1, s[56:59], s40 offen offset:1024 sc1
    v_mov_b32 v100, v24
    v_mov_b32 v101, v28
    v_mfma_f32_16x16x32_bf16 v[20:23], v[228:231], v[36:39], v[20:23]
    v_mov_b32 v102, v25
    v_mov_b32 v103, v29
    buffer_store_dwordx4 v[100:103], v3, s[56:59], s41 offen offset:0 sc1
    v_mfma_f32_16x16x32_bf16 v[8:11], v[136:139], v[40:43], v[8:11]
    v_mov_b32 v104, v26
    v_mov_b32 v105, v30
    v_mov_b32 v106, v27
    v_mfma_f32_16x16x32_bf16 v[12:15], v[168:171], v[40:43], v[12:15]
    v_mov_b32 v107, v31
    buffer_store_dwordx4 v[104:107], v3, s[56:59], s41 offen offset:256 sc1
    v_mfma_f32_16x16x32_bf16 v[16:19], v[200:203], v[40:43], v[16:19]
    v_mfma_f32_16x16x32_bf16 v[20:23], v[232:235], v[40:43], v[20:23]
    v_mfma_f32_16x16x32_bf16 v[8:11], v[140:143], v[44:47], v[8:11]
    v_mfma_f32_16x16x32_bf16 v[12:15], v[172:175], v[44:47], v[12:15]
    v_mfma_f32_16x16x32_bf16 v[16:19], v[204:207], v[44:47], v[16:19]
    v_mfma_f32_16x16x32_bf16 v[20:23], v[236:239], v[44:47], v[20:23]
    v_mfma_f32_16x16x32_bf16 v[8:11], v[144:147], v[48:51], v[8:11]
    v_mfma_f32_16x16x32_bf16 v[12:15], v[176:179], v[48:51], v[12:15]
    v_mfma_f32_16x16x32_bf16 v[16:19], v[208:211], v[48:51], v[16:19]
    v_mfma_f32_16x16x32_bf16 v[20:23], v[240:243], v[48:51], v[20:23]
    v_mfma_f32_16x16x32_bf16 v[8:11], v[148:151], v[52:55], v[8:11]
    v_mfma_f32_16x16x32_bf16 v[12:15], v[180:183], v[52:55], v[12:15]
    v_mfma_f32_16x16x32_bf16 v[16:19], v[212:215], v[52:55], v[16:19]
    v_mfma_f32_16x16x32_bf16 v[20:23], v[244:247], v[52:55], v[20:23]
    v_mfma_f32_16x16x32_bf16 v[8:11], v[152:155], v[56:59], v[8:11]
    v_mfma_f32_16x16x32_bf16 v[12:15], v[184:187], v[56:59], v[12:15]
    v_mfma_f32_16x16x32_bf16 v[16:19], v[216:219], v[56:59], v[16:19]
    v_mfma_f32_16x16x32_bf16 v[20:23], v[248:251], v[56:59], v[20:23]
    v_mfma_f32_16x16x32_bf16 v[8:11], v[156:159], v[60:63], v[8:11]
    v_mfma_f32_16x16x32_bf16 v[12:15], v[188:191], v[60:63], v[12:15]
    v_mfma_f32_16x16x32_bf16 v[16:19], v[220:223], v[60:63], v[16:19]
    v_mfma_f32_16x16x32_bf16 v[20:23], v[252:255], v[60:63], v[20:23]
    s_add_u32 s43, s28, 24
    s_lshr_b32 s40, s31, 1
    s_mul_i32 s40, s40, 28
    s_add_u32 s40, s40, s43
    s_lshl_b32 s40, s40, 1
    s_and_b32 s42, s31, 1
    s_add_u32 s40, s40, s42
    s_mul_i32 s40, s40, 14336
    s_add_u32 s40, s40, 19267584
    s_lshr_b32 s41, s43, 1
    s_lshl_b32 s41, s41, 2
    s_lshr_b32 s42, s31, 2
    s_add_u32 s41, s41, s42
    s_mul_i32 s41, s41, 56
    s_and_b32 s42, s43, 1
    s_lshl_b32 s42, s42, 2
    s_and_b32 s44, s31, 3
    s_add_u32 s42, s42, s44
    s_mul_i32 s42, s42, 7
    s_add_u32 s41, s41, s42
    s_add_u32 s41, s41, s32
    s_lshl_b32 s41, s41, 11
    s_add_u32 s41, s41, 6422528
    s_lshl_b32 s42, s32, 11
    s_add_u32 s40, s40, s42
    v_cvt_pk_bf16_f32 v24, v8, v9
    v_cvt_pk_bf16_f32 v25, v10, v11
    v_cvt_pk_bf16_f32 v26, v12, v13
    v_cvt_pk_bf16_f32 v27, v14, v15
    buffer_store_dwordx4 v[24:27], v1, s[56:59], s40 offen offset:0 sc1
    v_cvt_pk_bf16_f32 v28, v16, v17
    v_cvt_pk_bf16_f32 v29, v18, v19
    v_cvt_pk_bf16_f32 v30, v20, v21
    v_cvt_pk_bf16_f32 v31, v22, v23
    buffer_store_dwordx4 v[28:31], v1, s[56:59], s40 offen offset:1024 sc1
    v_mov_b32 v100, v24
    v_mov_b32 v101, v28
    v_mov_b32 v102, v25
    v_mov_b32 v103, v29
    buffer_store_dwordx4 v[100:103], v3, s[56:59], s41 offen offset:0 sc1
    v_mov_b32 v104, v26
    v_mov_b32 v105, v30
    v_mov_b32 v106, v27
    v_mov_b32 v107, v31
    buffer_store_dwordx4 v[104:107], v3, s[56:59], s41 offen offset:256 sc1
    s_branch P_done
P_bodyA:
    v_accvgpr_read_b32 v0, a255
    s_mov_b32 s28, s76
    v_and_b32 v0, 63, v0
    s_mov_b32 s33, 613566757
    s_mul_hi_u32 s31, s52, s33
    s_mul_i32 s32, s31, 7
    s_sub_u32 s32, s52, s32
    s_lshl_b32 s34, s31, 9
    v_lshrrev_b32 v2, 5, v0
    v_add_u32 v2, 0, v2
    v_lshrrev_b32 v3, 2, v2
    v_lshlrev_b32 v3, 3, v3
    v_and_b32 v4, 3, v2
    v_add_u32 v3, v3, v4
    v_lshlrev_b32 v3, 13, v3
    v_and_b32 v4, 7, v2
    v_lshlrev_b32 v4, 2, v4
    v_and_b32 v5, 31, v0
    v_xor_b32 v4, v4, v5
    v_lshl_add_u32 v3, v4, 4, v3
    s_lshl_b32 s35, s32, 6
    s_lshr_b32 s36, s28, 1
    s_lshl_b32 s36, s36, 5
    s_add_u32 s35, s35, s36
    s_and_b32 s36, s28, 1
    s_lshl_b32 s36, s36, 2
    s_add_u32 s35, s35, s36
    s_lshl_b32 s35, s35, 13
    s_add_u32 s35, s35, s34
    s_lshl_b32 s37, s28, 13
    s_add_u32 s37, s37, 65536
    s_add_u32 m0, s37, 0
    s_nop 0
    buffer_load_dwordx4 v3, s[8:11], s35 offen lds
    v_lshrrev_b32 v2, 5, v0
    v_add_u32 v2, 2, v2
    v_lshrrev_b32 v3, 2, v2
    v_lshlrev_b32 v3, 3, v3
    v_and_b32 v4, 3, v2
    v_add_u32 v3, v3, v4
    v_lshlrev_b32 v3, 13, v3
    v_and_b32 v4, 7, v2
    v_lshlrev_b32 v4, 2, v4
    v_and_b32 v5, 31, v0
    v_xor_b32 v4, v4, v5
    v_lshl_add_u32 v3, v4, 4, v3
    s_add_u32 m0, s37, 1024
    s_nop 0
    buffer_load_dwordx4 v3, s[8:11], s35 offen lds
    v_lshrrev_b32 v2, 5, v0
    v_add_u32 v2, 4, v2
    v_lshrrev_b32 v3, 2, v2
    v_lshlrev_b32 v3, 3, v3
    v_and_b32 v4, 3, v2
    v_add_u32 v3, v3, v4
    v_lshlrev_b32 v3, 13, v3
    v_and_b32 v4, 7, v2
    v_lshlrev_b32 v4, 2, v4
    v_and_b32 v5, 31, v0
    v_xor_b32 v4, v4, v5
    v_lshl_add_u32 v3, v4, 4, v3
    s_add_u32 m0, s37, 2048
    s_nop 0
    buffer_load_dwordx4 v3, s[8:11], s35 offen lds
    v_lshrrev_b32 v2, 5, v0
    v_add_u32 v2, 6, v2
    v_lshrrev_b32 v3, 2, v2
    v_lshlrev_b32 v3, 3, v3
    v_and_b32 v4, 3, v2
    v_add_u32 v3, v3, v4
    v_lshlrev_b32 v3, 13, v3
    v_and_b32 v4, 7, v2
    v_lshlrev_b32 v4, 2, v4
    v_and_b32 v5, 31, v0
    v_xor_b32 v4, v4, v5
    v_lshl_add_u32 v3, v4, 4, v3
    s_add_u32 m0, s37, 3072
    s_nop 0
    buffer_load_dwordx4 v3, s[8:11], s35 offen lds
    v_lshrrev_b32 v2, 5, v0
    v_add_u32 v2, 8, v2
    v_lshrrev_b32 v3, 2, v2
    v_lshlrev_b32 v3, 3, v3
    v_and_b32 v4, 3, v2
    v_add_u32 v3, v3, v4
    v_lshlrev_b32 v3, 13, v3
    v_and_b32 v4, 7, v2
    v_lshlrev_b32 v4, 2, v4
    v_and_b32 v5, 31, v0
    v_xor_b32 v4, v4, v5
    v_lshl_add_u32 v3, v4, 4, v3
    s_add_u32 m0, s37, 4096
    s_nop 0
    buffer_load_dwordx4 v3, s[8:11], s35 offen lds
    v_lshrrev_b32 v2, 5, v0
    v_add_u32 v2, 10, v2
    v_lshrrev_b32 v3, 2, v2
    v_lshlrev_b32 v3, 3, v3
    v_and_b32 v4, 3, v2
    v_add_u32 v3, v3, v4
    v_lshlrev_b32 v3, 13, v3
    v_and_b32 v4, 7, v2
    v_lshlrev_b32 v4, 2, v4
    v_and_b32 v5, 31, v0
    v_xor_b32 v4, v4, v5
    v_lshl_add_u32 v3, v4, 4, v3
    s_add_u32 m0, s37, 5120
    s_nop 0
    buffer_load_dwordx4 v3, s[8:11], s35 offen lds
    v_lshrrev_b32 v2, 5, v0
    v_add_u32 v2, 12, v2
    v_lshrrev_b32 v3, 2, v2
    v_lshlrev_b32 v3, 3, v3
    v_and_b32 v4, 3, v2
    v_add_u32 v3, v3, v4
    v_lshlrev_b32 v3, 13, v3
    v_and_b32 v4, 7, v2
    v_lshlrev_b32 v4, 2, v4
    v_and_b32 v5, 31, v0
    v_xor_b32 v4, v4, v5
    v_lshl_add_u32 v3, v4, 4, v3
    s_add_u32 m0, s37, 6144
    s_nop 0
    buffer_load_dwordx4 v3, s[8:11], s35 offen lds
    v_lshrrev_b32 v2, 5, v0
    v_add_u32 v2, 14, v2
    v_lshrrev_b32 v3, 2, v2
    v_lshlrev_b32 v3, 3, v3
    v_and_b32 v4, 3, v2
    v_add_u32 v3, v3, v4
    v_lshlrev_b32 v3, 13, v3
    v_and_b32 v4, 7, v2
    v_lshlrev_b32 v4, 2, v4
    v_and_b32 v5, 31, v0
    v_xor_b32 v4, v4, v5
    v_lshl_add_u32 v3, v4, 4, v3
    s_add_u32 m0, s37, 7168
    s_nop 0
    buffer_load_dwordx4 v3, s[8:11], s35 offen lds
    v_and_b32 v2, 15, v0
    v_lshlrev_b32 v3, 9, v2
    v_lshrrev_b32 v4, 4, v0
    v_lshl_add_u32 v3, v4, 4, v3
    v_and_b32 v2, 7, v2
    v_xor_b32 v4, 0, v2
    v_lshl_add_u32 v64, v4, 6, v3
    v_xor_b32 v4, 1, v2
    v_lshl_add_u32 v65, v4, 6, v3
    v_xor_b32 v4, 2, v2
    v_lshl_add_u32 v66, v4, 6, v3
    v_xor_b32 v4, 3, v2
    v_lshl_add_u32 v67, v4, 6, v3
    v_xor_b32 v4, 4, v2
    v_lshl_add_u32 v68, v4, 6, v3
    v_xor_b32 v4, 5, v2
    v_lshl_add_u32 v69, v4, 6, v3
    v_xor_b32 v4, 6, v2
    v_lshl_add_u32 v70, v4, 6, v3
    v_xor_b32 v4, 7, v2
    v_lshl_add_u32 v71, v4, 6, v3
    v_lshrrev_b32 v2, 5, v0
    v_and_b32 v5, 31, v0
    s_lshl_b32 s38, s28, 17
    s_add_u32 s38, s38, s34
    s_lshl_b32 s39, s28, 13
    v_add_u32 v3, 0, v2
    v_and_b32 v4, 7, v3
    v_lshlrev_b32 v4, 2, v4
    v_xor_b32 v4, v4, v5
    v_lshlrev_b32 v72, 13, v3
    v_lshl_add_u32 v72, v4, 4, v72
    v_add_u32 v3, 2, v2
    v_and_b32 v4, 7, v3
    v_lshlrev_b32 v4, 2, v4
    v_xor_b32 v4, v4, v5
    v_lshlrev_b32 v73, 13, v3
    v_lshl_add_u32 v73, v4, 4, v73
    v_add_u32 v3, 4, v2
    v_and_b32 v4, 7, v3
    v_lshlrev_b32 v4, 2, v4
    v_xor_b32 v4, v4, v5
    v_lshlrev_b32 v74, 13, v3
    v_lshl_add_u32 v74, v4, 4, v74
    v_add_u32 v3, 6, v2
    v_and_b32 v4, 7, v3
    v_lshlrev_b32 v4, 2, v4
    v_xor_b32 v4, v4, v5
    v_lshlrev_b32 v75, 13, v3
    v_lshl_add_u32 v75, v4, 4, v75
    v_add_u32 v3, 8, v2
    v_and_b32 v4, 7, v3
    v_lshlrev_b32 v4, 2, v4
    v_xor_b32 v4, v4, v5
    v_lshlrev_b32 v76, 13, v3
    v_lshl_add_u32 v76, v4, 4, v76
    v_add_u32 v3, 10, v2
    v_and_b32 v4, 7, v3
    v_lshlrev_b32 v4, 2, v4
    v_xor_b32 v4, v4, v5
    v_lshlrev_b32 v77, 13, v3
    v_lshl_add_u32 v77, v4, 4, v77
    v_add_u32 v3, 12, v2
    v_and_b32 v4, 7, v3
    v_lshlrev_b32 v4, 2, v4
    v_xor_b32 v4, v4, v5
    v_lshlrev_b32 v78, 13, v3
    v_lshl_add_u32 v78, v4, 4, v78
    v_add_u32 v3, 14, v2
    v_and_b32 v4, 7, v3
    v_lshlrev_b32 v4, 2, v4
    v_xor_b32 v4, v4, v5
    v_lshlrev_b32 v79, 13, v3
    v_lshl_add_u32 v79, v4, 4, v79
    v_bfe_u32 v2, v0, 2, 1
    v_mul_u32_u24 v1, 14336, v2
    v_lshrrev_b32 v2, 4, v0
    v_lshl_add_u32 v1, v2, 8, v1
    v_bfe_u32 v2, v0, 3, 1
    v_lshl_add_u32 v1, v2, 6, v1
    v_and_b32 v2, 3, v0
    v_lshl_add_u32 v1, v2, 4, v1
    v_lshrrev_b32 v3, 5, v0
    v_lshlrev_b32 v3, 10, v3
    v_bfe_u32 v7, v0, 4, 1
    v_lshl_add_u32 v3, v7, 9, v3
    v_and_b32 v7, 15, v0
    v_lshl_add_u32 v3, v7, 4, v3
    s_mov_b32 s36, 0x3db8aa3b
    s_add_u32 s35, s38, 0
    s_add_u32 m0, s39, 0
    s_nop 0
    buffer_load_dwordx4 v72, s[12:15], s35 offen lds
    s_add_u32 m0, s39, 1024
    s_nop 0
    buffer_load_dwordx4 v73, s[12:15], s35 offen lds
    s_add_u32 m0, s39, 2048
    s_nop 0
    buffer_load_dwordx4 v74, s[12:15], s35 offen lds
    s_add_u32 m0, s39, 3072
    s_nop 0
    buffer_load_dwordx4 v75, s[12:15], s35 offen lds
    s_add_u32 m0, s39, 4096
    s_nop 0
    buffer_load_dwordx4 v76, s[12:15], s35 offen lds
    s_add_u32 m0, s39, 5120
    s_nop 0
    buffer_load_dwordx4 v77, s[12:15], s35 offen lds
    s_add_u32 m0, s39, 6144
    s_nop 0
    buffer_load_dwordx4 v78, s[12:15], s35 offen lds
    s_add_u32 m0, s39, 7168
    s_nop 0
    buffer_load_dwordx4 v79, s[12:15], s35 offen lds
    s_add_u32 s35, s38, 524288
    s_add_u32 m0, s39, 32768
    s_nop 0
    buffer_load_dwordx4 v72, s[12:15], s35 offen lds
    s_add_u32 m0, s39, 33792
    s_nop 0
    buffer_load_dwordx4 v73, s[12:15], s35 offen lds
    s_add_u32 m0, s39, 34816
    s_nop 0
    buffer_load_dwordx4 v74, s[12:15], s35 offen lds
    s_add_u32 m0, s39, 35840
    s_nop 0
    buffer_load_dwordx4 v75, s[12:15], s35 offen lds
    s_add_u32 m0, s39, 36864
    s_nop 0
    buffer_load_dwordx4 v76, s[12:15], s35 offen lds
    s_add_u32 m0, s39, 37888
    s_nop 0
    buffer_load_dwordx4 v77, s[12:15], s35 offen lds
    s_add_u32 m0, s39, 38912
    s_nop 0
    buffer_load_dwordx4 v78, s[12:15], s35 offen lds
    s_add_u32 m0, s39, 39936
    s_nop 0
    buffer_load_dwordx4 v79, s[12:15], s35 offen lds
    s_waitcnt vmcnt(16)
    s_barrier
    v_add_u32 v80, 65536, v64
    ds_read_b128 v[128:131], v80
    v_add_u32 v80, 65536, v65
    ds_read_b128 v[132:135], v80
    v_add_u32 v80, 65536, v66
    ds_read_b128 v[136:139], v80
    v_add_u32 v80, 65536, v67
    ds_read_b128 v[140:143], v80
    v_add_u32 v80, 65536, v68
    ds_read_b128 v[144:147], v80
    v_add_u32 v80, 65536, v69
    ds_read_b128 v[148:151], v80
    v_add_u32 v80, 65536, v70
    ds_read_b128 v[152:155], v80
    v_add_u32 v80, 65536, v71
    ds_read_b128 v[156:159], v80
    s_waitcnt lgkmcnt(0)
    v_add_u32 v80, 73728, v64
    ds_read_b128 v[160:163], v80
    v_add_u32 v80, 73728, v65
    ds_read_b128 v[164:167], v80
    v_add_u32 v80, 73728, v66
    ds_read_b128 v[168:171], v80
    v_add_u32 v80, 73728, v67
    ds_read_b128 v[172:175], v80
    v_add_u32 v80, 73728, v68
    ds_read_b128 v[176:179], v80
    v_add_u32 v80, 73728, v69
    ds_read_b128 v[180:183], v80
    v_add_u32 v80, 73728, v70
    ds_read_b128 v[184:187], v80
    v_add_u32 v80, 73728, v71
    ds_read_b128 v[188:191], v80
    s_waitcnt lgkmcnt(0)
    v_add_u32 v80, 81920, v64
    ds_read_b128 v[192:195], v80
    v_add_u32 v80, 81920, v65
    ds_read_b128 v[196:199], v80
    v_add_u32 v80, 81920, v66
    ds_read_b128 v[200:203], v80
    v_add_u32 v80, 81920, v67
    ds_read_b128 v[204:207], v80
    v_add_u32 v80, 81920, v68
    ds_read_b128 v[208:211], v80
    v_add_u32 v80, 81920, v69
    ds_read_b128 v[212:215], v80
    v_add_u32 v80, 81920, v70
    ds_read_b128 v[216:219], v80
    v_add_u32 v80, 81920, v71
    ds_read_b128 v[220:223], v80
    s_waitcnt lgkmcnt(0)
    v_add_u32 v80, 90112, v64
    ds_read_b128 v[224:227], v80
    v_add_u32 v80, 90112, v65
    ds_read_b128 v[228:231], v80
    v_add_u32 v80, 90112, v66
    ds_read_b128 v[232:235], v80
    v_add_u32 v80, 90112, v67
    ds_read_b128 v[236:239], v80
    v_add_u32 v80, 90112, v68
    ds_read_b128 v[240:243], v80
    v_add_u32 v80, 90112, v69
    ds_read_b128 v[244:247], v80
    v_add_u32 v80, 90112, v70
    ds_read_b128 v[248:251], v80
    v_add_u32 v80, 90112, v71
    ds_read_b128 v[252:255], v80
    s_waitcnt lgkmcnt(0)
    s_barrier
    s_waitcnt vmcnt(8)
    s_add_u32 s35, s38, 1048576
    s_add_u32 m0, s39, 65536
    s_nop 0
    buffer_load_dwordx4 v72, s[12:15], s35 offen lds
    s_add_u32 m0, s39, 66560
    s_nop 0
    buffer_load_dwordx4 v73, s[12:15], s35 offen lds
    s_add_u32 m0, s39, 67584
    s_nop 0
    buffer_load_dwordx4 v74, s[12:15], s35 offen lds
    s_add_u32 m0, s39, 68608
    s_nop 0
    buffer_load_dwordx4 v75, s[12:15], s35 offen lds
    s_add_u32 m0, s39, 69632
    s_nop 0
    buffer_load_dwordx4 v76, s[12:15], s35 offen lds
    s_add_u32 m0, s39, 70656
    s_nop 0
    buffer_load_dwordx4 v77, s[12:15], s35 offen lds
    s_add_u32 m0, s39, 71680
    s_nop 0
    buffer_load_dwordx4 v78, s[12:15], s35 offen lds
    s_add_u32 m0, s39, 72704
    s_nop 0
    buffer_load_dwordx4 v79, s[12:15], s35 offen lds
    s_add_u32 s43, s39, 0
    v_add_u32 v80, s43, v64
    ds_read_b128 v[32:35], v80
    v_add_u32 v80, s43, v65
    ds_read_b128 v[36:39], v80
    v_add_u32 v80, s43, v66
    ds_read_b128 v[40:43], v80
    v_add_u32 v80, s43, v67
    ds_read_b128 v[44:47], v80
    v_add_u32 v80, s43, v68
    ds_read_b128 v[48:51], v80
    v_add_u32 v80, s43, v69
    ds_read_b128 v[52:55], v80
    v_add_u32 v80, s43, v70
    ds_read_b128 v[56:59], v80
    v_add_u32 v80, s43, v71
    ds_read_b128 v[60:63], v80
    s_waitcnt lgkmcnt(0)
    v_mfma_f32_16x16x32_bf16 v[8:11], v[128:131], v[32:35], 0
    v_mfma_f32_16x16x32_bf16 v[12:15], v[160:163], v[32:35], 0
    v_mfma_f32_16x16x32_bf16 v[16:19], v[192:195], v[32:35], 0
    v_mfma_f32_16x16x32_bf16 v[20:23], v[224:227], v[32:35], 0
    v_mfma_f32_16x16x32_bf16 v[8:11], v[132:135], v[36:39], v[8:11]
    v_mfma_f32_16x16x32_bf16 v[12:15], v[164:167], v[36:39], v[12:15]
    v_mfma_f32_16x16x32_bf16 v[16:19], v[196:199], v[36:39], v[16:19]
    v_mfma_f32_16x16x32_bf16 v[20:23], v[228:231], v[36:39], v[20:23]
    v_mfma_f32_16x16x32_bf16 v[8:11], v[136:139], v[40:43], v[8:11]
    v_mfma_f32_16x16x32_bf16 v[12:15], v[168:171], v[40:43], v[12:15]
    v_mfma_f32_16x16x32_bf16 v[16:19], v[200:203], v[40:43], v[16:19]
    v_mfma_f32_16x16x32_bf16 v[20:23], v[232:235], v[40:43], v[20:23]
    v_mfma_f32_16x16x32_bf16 v[8:11], v[140:143], v[44:47], v[8:11]
    v_mfma_f32_16x16x32_bf16 v[12:15], v[172:175], v[44:47], v[12:15]
    v_mfma_f32_16x16x32_bf16 v[16:19], v[204:207], v[44:47], v[16:19]
    v_mfma_f32_16x16x32_bf16 v[20:23], v[236:239], v[44:47], v[20:23]
    v_mfma_f32_16x16x32_bf16 v[8:11], v[144:147], v[48:51], v[8:11]
    v_mfma_f32_16x16x32_bf16 v[12:15], v[176:179], v[48:51], v[12:15]
    v_mfma_f32_16x16x32_bf16 v[16:19], v[208:211], v[48:51], v[16:19]
    v_mfma_f32_16x16x32_bf16 v[20:23], v[240:243], v[48:51], v[20:23]
    v_mfma_f32_16x16x32_bf16 v[8:11], v[148:151], v[52:55], v[8:11]
    v_mfma_f32_16x16x32_bf16 v[12:15], v[180:183], v[52:55], v[12:15]
    v_mfma_f32_16x16x32_bf16 v[16:19], v[212:215], v[52:55], v[16:19]
    v_mfma_f32_16x16x32_bf16 v[20:23], v[244:247], v[52:55], v[20:23]
    v_mfma_f32_16x16x32_bf16 v[8:11], v[152:155], v[56:59], v[8:11]
    v_mfma_f32_16x16x32_bf16 v[12:15], v[184:187], v[56:59], v[12:15]
    v_mfma_f32_16x16x32_bf16 v[16:19], v[216:219], v[56:59], v[16:19]
    v_mfma_f32_16x16x32_bf16 v[20:23], v[248:251], v[56:59], v[20:23]
    v_mfma_f32_16x16x32_bf16 v[8:11], v[156:159], v[60:63], v[8:11]
    v_mfma_f32_16x16x32_bf16 v[12:15], v[188:191], v[60:63], v[12:15]
    v_mfma_f32_16x16x32_bf16 v[16:19], v[220:223], v[60:63], v[16:19]
    v_mfma_f32_16x16x32_bf16 v[20:23], v[252:255], v[60:63], v[20:23]
    s_waitcnt vmcnt(8)
    s_add_u32 s35, s38, 1572864
    s_add_u32 m0, s39, 0
    s_nop 0
    buffer_load_dwordx4 v72, s[12:15], s35 offen lds
    s_add_u32 m0, s39, 1024
    s_nop 0
    buffer_load_dwordx4 v73, s[12:15], s35 offen lds
    s_add_u32 m0, s39, 2048
    s_nop 0
    buffer_load_dwordx4 v74, s[12:15], s35 offen lds
    s_add_u32 m0, s39, 3072
    s_nop 0
    buffer_load_dwordx4 v75, s[12:15], s35 offen lds
    s_add_u32 m0, s39, 4096
    s_nop 0
    buffer_load_dwordx4 v76, s[12:15], s35 offen lds
    s_add_u32 m0, s39, 5120
    s_nop 0
    buffer_load_dwordx4 v77, s[12:15], s35 offen lds
    s_add_u32 m0, s39, 6144
    s_nop 0
    buffer_load_dwordx4 v78, s[12:15], s35 offen lds
    s_add_u32 m0, s39, 7168
    s_nop 0
    buffer_load_dwordx4 v79, s[12:15], s35 offen lds
    s_add_u32 s43, s39, 32768
    v_add_u32 v80, s43, v64
    ds_read_b128 v[32:35], v80
    v_add_u32 v80, s43, v65
    ds_read_b128 v[36:39], v80
    v_add_u32 v80, s43, v66
    ds_read_b128 v[40:43], v80
    v_add_u32 v80, s43, v67
    ds_read_b128 v[44:47], v80
    v_add_u32 v80, s43, v68
    ds_read_b128 v[48:51], v80
    v_add_u32 v80, s43, v69
    ds_read_b128 v[52:55], v80
    v_add_u32 v80, s43, v70
    ds_read_b128 v[56:59], v80
    v_add_u32 v80, s43, v71
    ds_read_b128 v[60:63], v80
    s_waitcnt lgkmcnt(0)
    v_mfma_f32_16x16x32_bf16 v[84:87], v[128:131], v[32:35], 0
    s_add_u32 s43, s28, 0
    s_mul_i32 s40, s31, 14
    s_lshr_b32 s41, s43, 1
    s_add_u32 s40, s40, s41
    s_mul_i32 s40, s40, 28672
    s_and_b32 s41, s43, 1
    s_lshl_b32 s41, s41, 7
    s_add_u32 s40, s40, s41
    s_add_u32 s40, s40, 12845056
    v_mfma_f32_16x16x32_bf16 v[88:91], v[160:163], v[32:35], 0
    s_lshl_b32 s41, s31, 2
    s_add_u32 s41, s41, s28
    s_mul_i32 s41, s41, 49
    s_add_u32 s41, s41, 0
    s_add_u32 s41, s41, s32
    s_lshl_b32 s41, s41, 11
    s_add_u32 s41, s41, 0
    s_lshl_b32 s42, s32, 11
    s_add_u32 s40, s40, s42
    v_mfma_f32_16x16x32_bf16 v[92:95], v[192:195], v[32:35], 0
    v_mfma_f32_16x16x32_bf16 v[96:99], v[224:227], v[32:35], 0
    v_mul_f32 v8, s36, v8
    v_mul_f32 v9, s36, v9
    v_mul_f32 v10, s36, v10
    v_mfma_f32_16x16x32_bf16 v[84:87], v[132:135], v[36:39], v[84:87]
    v_mul_f32 v11, s36, v11
    v_mul_f32 v12, s36, v12
    v_mul_f32 v13, s36, v13
    v_mfma_f32_16x16x32_bf16 v[88:91], v[164:167], v[36:39], v[88:91]
    v_mul_f32 v14, s36, v14
    v_mul_f32 v15, s36, v15
    v_mul_f32 v16, s36, v16
    v_mfma_f32_16x16x32_bf16 v[92:95], v[196:199], v[36:39], v[92:95]
    v_mul_f32 v17, s36, v17
    v_mul_f32 v18, s36, v18
    v_mul_f32 v19, s36, v19
    v_mfma_f32_16x16x32_bf16 v[96:99], v[228:231], v[36:39], v[96:99]
    v_mul_f32 v20, s36, v20
    v_mul_f32 v21, s36, v21
    v_mul_f32 v22, s36, v22
    v_mfma_f32_16x16x32_bf16 v[84:87], v[136:139], v[40:43], v[84:87]
    v_mul_f32 v23, s36, v23
    v_cvt_pk_bf16_f32 v24, v8, v9
    v_cvt_pk_bf16_f32 v25, v10, v11
    v_mfma_f32_16x16x32_bf16 v[88:91], v[168:171], v[40:43], v[88:91]
    v_cvt_pk_bf16_f32 v26, v12, v13
    v_cvt_pk_bf16_f32 v27, v14, v15
    buffer_store_dwordx4 v[24:27], v1, s[56:59], s40 offen offset:0 sc1
    v_mfma_f32_16x16x32_bf16 v[92:95], v[200:203], v[40:43], v[92:95]
    v_cvt_pk_bf16_f32 v28, v16, v17
    v_cvt_pk_bf16_f32 v29, v18, v19
    v_cvt_pk_bf16_f32 v30, v20, v21
    v_mfma_f32_16x16x32_bf16 v[96:99], v[232:235], v[40:43], v[96:99]
    v_cvt_pk_bf16_f32 v31, v22, v23
    buffer_store_dwordx4 v[28:31], v1, s[56:59], s40 offen offset:1024 sc1
    v_mov_b32 v100, v24
    v_mfma_f32_16x16x32_bf16 v[84:87], v[140:143], v[44:47], v[84:87]
    v_mov_b32 v101, v28
    v_mov_b32 v102, v25
    v_mov_b32 v103, v29
    v_mfma_f32_16x16x32_bf16 v[88:91], v[172:175], v[44:47], v[88:91]
    buffer_store_dwordx4 v[100:103], v3, s[56:59], s41 offen offset:0 sc1
    v_mov_b32 v104, v26
    v_mov_b32 v105, v30
    v_mfma_f32_16x16x32_bf16 v[92:95], v[204:207], v[44:47], v[92:95]
    v_mov_b32 v106, v27
    v_mov_b32 v107, v31
    buffer_store_dwordx4 v[104:107], v3, s[56:59], s41 offen offset:256 sc1
    v_mfma_f32_16x16x32_bf16 v[96:99], v[236:239], v[44:47], v[96:99]
    v_mfma_f32_16x16x32_bf16 v[84:87], v[144:147], v[48:51], v[84:87]
    v_mfma_f32_16x16x32_bf16 v[88:91], v[176:179], v[48:51], v[88:91]
    v_mfma_f32_16x16x32_bf16 v[92:95], v[208:211], v[48:51], v[92:95]
    v_mfma_f32_16x16x32_bf16 v[96:99], v[240:243], v[48:51], v[96:99]
    v_mfma_f32_16x16x32_bf16 v[84:87], v[148:151], v[52:55], v[84:87]
    v_mfma_f32_16x16x32_bf16 v[88:91], v[180:183], v[52:55], v[88:91]
    v_mfma_f32_16x16x32_bf16 v[92:95], v[212:215], v[52:55], v[92:95]
    v_mfma_f32_16x16x32_bf16 v[96:99], v[244:247], v[52:55], v[96:99]
    v_mfma_f32_16x16x32_bf16 v[84:87], v[152:155], v[56:59], v[84:87]
    v_mfma_f32_16x16x32_bf16 v[88:91], v[184:187], v[56:59], v[88:91]
    v_mfma_f32_16x16x32_bf16 v[92:95], v[216:219], v[56:59], v[92:95]
    v_mfma_f32_16x16x32_bf16 v[96:99], v[248:251], v[56:59], v[96:99]
    v_mfma_f32_16x16x32_bf16 v[84:87], v[156:159], v[60:63], v[84:87]
    v_mfma_f32_16x16x32_bf16 v[88:91], v[188:191], v[60:63], v[88:91]
    v_mfma_f32_16x16x32_bf16 v[92:95], v[220:223], v[60:63], v[92:95]
    v_mfma_f32_16x16x32_bf16 v[96:99], v[252:255], v[60:63], v[96:99]
    s_waitcnt vmcnt(12)
    s_add_u32 s35, s38, 2097152
    s_add_u32 m0, s39, 32768
    s_nop 0
    buffer_load_dwordx4 v72, s[12:15], s35 offen lds
    s_add_u32 m0, s39, 33792
    s_nop 0
    buffer_load_dwordx4 v73, s[12:15], s35 offen lds
    s_add_u32 m0, s39, 34816
    s_nop 0
    buffer_load_dwordx4 v74, s[12:15], s35 offen lds
    s_add_u32 m0, s39, 35840
    s_nop 0
    buffer_load_dwordx4 v75, s[12:15], s35 offen lds
    s_add_u32 m0, s39, 36864
    s_nop 0
    buffer_load_dwordx4 v76, s[12:15], s35 offen lds
    s_add_u32 m0, s39, 37888
    s_nop 0
    buffer_load_dwordx4 v77, s[12:15], s35 offen lds
    s_add_u32 m0, s39, 38912
    s_nop 0
    buffer_load_dwordx4 v78, s[12:15], s35 offen lds
    s_add_u32 m0, s39, 39936
    s_nop 0
    buffer_load_dwordx4 v79, s[12:15], s35 offen lds
    s_add_u32 s43, s39, 65536
    v_add_u32 v80, s43, v64
    ds_read_b128 v[32:35], v80
    v_add_u32 v80, s43, v65
    ds_read_b128 v[36:39], v80
    v_add_u32 v80, s43, v66
    ds_read_b128 v[40:43], v80
    v_add_u32 v80, s43, v67
    ds_read_b128 v[44:47], v80
    v_add_u32 v80, s43, v68
    ds_read_b128 v[48:51], v80
    v_add_u32 v80, s43, v69
    ds_read_b128 v[52:55], v80
    v_add_u32 v80, s43, v70
    ds_read_b128 v[56:59], v80
    v_add_u32 v80, s43, v71
    ds_read_b128 v[60:63], v80
    s_waitcnt lgkmcnt(0)
    v_mfma_f32_16x16x32_bf16 v[8:11], v[128:131], v[32:35], 0
    s_add_u32 s43, s28, 4
    s_mul_i32 s40, s31, 14
    s_lshr_b32 s41, s43, 1
    s_add_u32 s40, s40, s41
    s_mul_i32 s40, s40, 28672
    s_and_b32 s41, s43, 1
    s_lshl_b32 s41, s41, 7
    s_add_u32 s40, s40, s41
    s_add_u32 s40, s40, 12845056
    v_mfma_f32_16x16x32_bf16 v[12:15], v[160:163], v[32:35], 0
    s_lshl_b32 s41, s31, 2
    s_add_u32 s41, s41, s28
    s_mul_i32 s41, s41, 49
    s_add_u32 s41, s41, 7
    s_add_u32 s41, s41, s32
    s_lshl_b32 s41, s41, 11
    s_add_u32 s41, s41, 0
    s_lshl_b32 s42, s32, 11
    s_add_u32 s40, s40, s42
    v_mfma_f32_16x16x32_bf16 v[16:19], v[192:195], v[32:35], 0
    v_mfma_f32_16x16x32_bf16 v[20:23], v[224:227], v[32:35], 0
    v_mul_f32 v84, s36, v84
    v_mul_f32 v85, s36, v85
    v_mul_f32 v86, s36, v86
    v_mfma_f32_16x16x32_bf16 v[8:11], v[132:135], v[36:39], v[8:11]
    v_mul_f32 v87, s36, v87
    v_mul_f32 v88, s36, v88
    v_mul_f32 v89, s36, v89
    v_mfma_f32_16x16x32_bf16 v[12:15], v[164:167], v[36:39], v[12:15]
    v_mul_f32 v90, s36, v90
    v_mul_f32 v91, s36, v91
    v_mul_f32 v92, s36, v92
    v_mfma_f32_16x16x32_bf16 v[16:19], v[196:199], v[36:39], v[16:19]
    v_mul_f32 v93, s36, v93
    v_mul_f32 v94, s36, v94
    v_mul_f32 v95, s36, v95
    v_mfma_f32_16x16x32_bf16 v[20:23], v[228:231], v[36:39], v[20:23]
    v_mul_f32 v96, s36, v96
    v_mul_f32 v97, s36, v97
    v_mul_f32 v98, s36, v98
    v_mfma_f32_16x16x32_bf16 v[8:11], v[136:139], v[40:43], v[8:11]
    v_mul_f32 v99, s36, v99
    v_cvt_pk_bf16_f32 v24, v84, v85
    v_cvt_pk_bf16_f32 v25, v86, v87
    v_mfma_f32_16x16x32_bf16 v[12:15], v[168:171], v[40:43], v[12:15]
    v_cvt_pk_bf16_f32 v26, v88, v89
    v_cvt_pk_bf16_f32 v27, v90, v91
    buffer_store_dwordx4 v[24:27], v1, s[56:59], s40 offen offset:0 sc1
    v_mfma_f32_16x16x32_bf16 v[16:19], v[200:203], v[40:43], v[16:19]
    v_cvt_pk_bf16_f32 v28, v92, v93
    v_cvt_pk_bf16_f32 v29, v94, v95
    v_cvt_pk_bf16_f32 v30, v96, v97
    v_mfma_f32_16x16x32_bf16 v[20:23], v[232:235], v[40:43], v[20:23]
    v_cvt_pk_bf16_f32 v31, v98, v99
    buffer_store_dwordx4 v[28:31], v1, s[56:59], s40 offen offset:1024 sc1
    v_mov_b32 v100, v24
    v_mfma_f32_16x16x32_bf16 v[8:11], v[140:143], v[44:47], v[8:11]
    v_mov_b32 v101, v28
    v_mov_b32 v102, v25
    v_mov_b32 v103, v29
    v_mfma_f32_16x16x32_bf16 v[12:15], v[172:175], v[44:47], v[12:15]
    buffer_store_dwordx4 v[100:103], v3, s[56:59], s41 offen offset:0 sc1
    v_mov_b32 v104, v26
    v_mov_b32 v105, v30
    v_mfma_f32_16x16x32_bf16 v[16:19], v[204:207], v[44:47], v[16:19]
    v_mov_b32 v106, v27
    v_mov_b32 v107, v31
    buffer_store_dwordx4 v[104:107], v3, s[56:59], s41 offen offset:256 sc1
    v_mfma_f32_16x16x32_bf16 v[20:23], v[236:239], v[44:47], v[20:23]
    v_mfma_f32_16x16x32_bf16 v[8:11], v[144:147], v[48:51], v[8:11]
    v_mfma_f32_16x16x32_bf16 v[12:15], v[176:179], v[48:51], v[12:15]
    v_mfma_f32_16x16x32_bf16 v[16:19], v[208:211], v[48:51], v[16:19]
    v_mfma_f32_16x16x32_bf16 v[20:23], v[240:243], v[48:51], v[20:23]
    v_mfma_f32_16x16x32_bf16 v[8:11], v[148:151], v[52:55], v[8:11]
    v_mfma_f32_16x16x32_bf16 v[12:15], v[180:183], v[52:55], v[12:15]
    v_mfma_f32_16x16x32_bf16 v[16:19], v[212:215], v[52:55], v[16:19]
    v_mfma_f32_16x16x32_bf16 v[20:23], v[244:247], v[52:55], v[20:23]
    v_mfma_f32_16x16x32_bf16 v[8:11], v[152:155], v[56:59], v[8:11]
    v_mfma_f32_16x16x32_bf16 v[12:15], v[184:187], v[56:59], v[12:15]
    v_mfma_f32_16x16x32_bf16 v[16:19], v[216:219], v[56:59], v[16:19]
    v_mfma_f32_16x16x32_bf16 v[20:23], v[248:251], v[56:59], v[20:23]
    v_mfma_f32_16x16x32_bf16 v[8:11], v[156:159], v[60:63], v[8:11]
    v_mfma_f32_16x16x32_bf16 v[12:15], v[188:191], v[60:63], v[12:15]
    v_mfma_f32_16x16x32_bf16 v[16:19], v[220:223], v[60:63], v[16:19]
    v_mfma_f32_16x16x32_bf16 v[20:23], v[252:255], v[60:63], v[20:23]
    s_waitcnt vmcnt(12)
    s_add_u32 s35, s38, 2621440
    s_add_u32 m0, s39, 65536
    s_nop 0
    buffer_load_dwordx4 v72, s[12:15], s35 offen lds
    s_add_u32 m0, s39, 66560
    s_nop 0
    buffer_load_dwordx4 v73, s[12:15], s35 offen lds
    s_add_u32 m0, s39, 67584
    s_nop 0
    buffer_load_dwordx4 v74, s[12:15], s35 offen lds
    s_add_u32 m0, s39, 68608
    s_nop 0
    buffer_load_dwordx4 v75, s[12:15], s35 offen lds
    s_add_u32 m0, s39, 69632
    s_nop 0
    buffer_load_dwordx4 v76, s[12:15], s35 offen lds
    s_add_u32 m0, s39, 70656
    s_nop 0
    buffer_load_dwordx4 v77, s[12:15], s35 offen lds
    s_add_u32 m0, s39, 71680
    s_nop 0
    buffer_load_dwordx4 v78, s[12:15], s35 offen lds
    s_add_u32 m0, s39, 72704
    s_nop 0
    buffer_load_dwordx4 v79, s[12:15], s35 offen lds
    s_add_u32 s43, s39, 0
    v_add_u32 v80, s43, v64
    ds_read_b128 v[32:35], v80
    v_add_u32 v80, s43, v65
    ds_read_b128 v[36:39], v80
    v_add_u32 v80, s43, v66
    ds_read_b128 v[40:43], v80
    v_add_u32 v80, s43, v67
    ds_read_b128 v[44:47], v80
    v_add_u32 v80, s43, v68
    ds_read_b128 v[48:51], v80
    v_add_u32 v80, s43, v69
    ds_read_b128 v[52:55], v80
    v_add_u32 v80, s43, v70
    ds_read_b128 v[56:59], v80
    v_add_u32 v80, s43, v71
    ds_read_b128 v[60:63], v80
    s_waitcnt lgkmcnt(0)
    v_mfma_f32_16x16x32_bf16 v[84:87], v[128:131], v[32:35], 0
    s_add_u32 s43, s28, 8
    s_mul_i32 s40, s31, 14
    s_lshr_b32 s41, s43, 1
    s_add_u32 s40, s40, s41
    s_mul_i32 s40, s40, 28672
    s_and_b32 s41, s43, 1
    s_lshl_b32 s41, s41, 7
    s_add_u32 s40, s40, s41
    s_add_u32 s40, s40, 12845056
    v_mfma_f32_16x16x32_bf16 v[88:91], v[160:163], v[32:35], 0
    s_lshl_b32 s41, s31, 2
    s_add_u32 s41, s41, s28
    s_mul_i32 s41, s41, 49
    s_add_u32 s41, s41, 14
    s_add_u32 s41, s41, s32
    s_lshl_b32 s41, s41, 11
    s_add_u32 s41, s41, 0
    s_lshl_b32 s42, s32, 11
    s_add_u32 s40, s40, s42
    v_mfma_f32_16x16x32_bf16 v[92:95], v[192:195], v[32:35], 0
    v_mfma_f32_16x16x32_bf16 v[96:99], v[224:227], v[32:35], 0
    v_mul_f32 v8, s36, v8
    v_mul_f32 v9, s36, v9
    v_mul_f32 v10, s36, v10
    v_mfma_f32_16x16x32_bf16 v[84:87], v[132:135], v[36:39], v[84:87]
    v_mul_f32 v11, s36, v11
    v_mul_f32 v12, s36, v12
    v_mul_f32 v13, s36, v13
    v_mfma_f32_16x16x32_bf16 v[88:91], v[164:167], v[36:39], v[88:91]
    v_mul_f32 v14, s36, v14
    v_mul_f32 v15, s36, v15
    v_mul_f32 v16, s36, v16
    v_mfma_f32_16x16x32_bf16 v[92:95], v[196:199], v[36:39], v[92:95]
    v_mul_f32 v17, s36, v17
    v_mul_f32 v18, s36, v18
    v_mul_f32 v19, s36, v19
    v_mfma_f32_16x16x32_bf16 v[96:99], v[228:231], v[36:39], v[96:99]
    v_mul_f32 v20, s36, v20
    v_mul_f32 v21, s36, v21
    v_mul_f32 v22, s36, v22
    v_mfma_f32_16x16x32_bf16 v[84:87], v[136:139], v[40:43], v[84:87]
    v_mul_f32 v23, s36, v23
    v_cvt_pk_bf16_f32 v24, v8, v9
    v_cvt_pk_bf16_f32 v25, v10, v11
    v_mfma_f32_16x16x32_bf16 v[88:91], v[168:171], v[40:43], v[88:91]
    v_cvt_pk_bf16_f32 v26, v12, v13
    v_cvt_pk_bf16_f32 v27, v14, v15
    buffer_store_dwordx4 v[24:27], v1, s[56:59], s40 offen offset:0 sc1
    v_mfma_f32_16x16x32_bf16 v[92:95], v[200:203], v[40:43], v[92:95]
    v_cvt_pk_bf16_f32 v28, v16, v17
    v_cvt_pk_bf16_f32 v29, v18, v19
    v_cvt_pk_bf16_f32 v30, v20, v21
    v_mfma_f32_16x16x32_bf16 v[96:99], v[232:235], v[40:43], v[96:99]
    v_cvt_pk_bf16_f32 v31, v22, v23
    buffer_store_dwordx4 v[28:31], v1, s[56:59], s40 offen offset:1024 sc1
    v_mov_b32 v100, v24
    v_mfma_f32_16x16x32_bf16 v[84:87], v[140:143], v[44:47], v[84:87]
    v_mov_b32 v101, v28
    v_mov_b32 v102, v25
    v_mov_b32 v103, v29
    v_mfma_f32_16x16x32_bf16 v[88:91], v[172:175], v[44:47], v[88:91]
    buffer_store_dwordx4 v[100:103], v3, s[56:59], s41 offen offset:0 sc1
    v_mov_b32 v104, v26
    v_mov_b32 v105, v30
    v_mfma_f32_16x16x32_bf16 v[92:95], v[204:207], v[44:47], v[92:95]
    v_mov_b32 v106, v27
    v_mov_b32 v107, v31
    buffer_store_dwordx4 v[104:107], v3, s[56:59], s41 offen offset:256 sc1
    v_mfma_f32_16x16x32_bf16 v[96:99], v[236:239], v[44:47], v[96:99]
    v_mfma_f32_16x16x32_bf16 v[84:87], v[144:147], v[48:51], v[84:87]
    v_mfma_f32_16x16x32_bf16 v[88:91], v[176:179], v[48:51], v[88:91]
    v_mfma_f32_16x16x32_bf16 v[92:95], v[208:211], v[48:51], v[92:95]
    v_mfma_f32_16x16x32_bf16 v[96:99], v[240:243], v[48:51], v[96:99]
    v_mfma_f32_16x16x32_bf16 v[84:87], v[148:151], v[52:55], v[84:87]
    v_mfma_f32_16x16x32_bf16 v[88:91], v[180:183], v[52:55], v[88:91]
    v_mfma_f32_16x16x32_bf16 v[92:95], v[212:215], v[52:55], v[92:95]
    v_mfma_f32_16x16x32_bf16 v[96:99], v[244:247], v[52:55], v[96:99]
    v_mfma_f32_16x16x32_bf16 v[84:87], v[152:155], v[56:59], v[84:87]
    v_mfma_f32_16x16x32_bf16 v[88:91], v[184:187], v[56:59], v[88:91]
    v_mfma_f32_16x16x32_bf16 v[92:95], v[216:219], v[56:59], v[92:95]
    v_mfma_f32_16x16x32_bf16 v[96:99], v[248:251], v[56:59], v[96:99]
    v_mfma_f32_16x16x32_bf16 v[84:87], v[156:159], v[60:63], v[84:87]
    v_mfma_f32_16x16x32_bf16 v[88:91], v[188:191], v[60:63], v[88:91]
    v_mfma_f32_16x16x32_bf16 v[92:95], v[220:223], v[60:63], v[92:95]
    v_mfma_f32_16x16x32_bf16 v[96:99], v[252:255], v[60:63], v[96:99]
    s_waitcnt vmcnt(12)
    s_add_u32 s35, s38, 3145728
    s_add_u32 m0, s39, 0
    s_nop 0
    buffer_load_dwordx4 v72, s[12:15], s35 offen lds
    s_add_u32 m0, s39, 1024
    s_nop 0
    buffer_load_dwordx4 v73, s[12:15], s35 offen lds
    s_add_u32 m0, s39, 2048
    s_nop 0
    buffer_load_dwordx4 v74, s[12:15], s35 offen lds
    s_add_u32 m0, s39, 3072
    s_nop 0
    buffer_load_dwordx4 v75, s[12:15], s35 offen lds
    s_add_u32 m0, s39, 4096
    s_nop 0
    buffer_load_dwordx4 v76, s[12:15], s35 offen lds
    s_add_u32 m0, s39, 5120
    s_nop 0
    buffer_load_dwordx4 v77, s[12:15], s35 offen lds
    s_add_u32 m0, s39, 6144
    s_nop 0
    buffer_load_dwordx4 v78, s[12:15], s35 offen lds
    s_add_u32 m0, s39, 7168
    s_nop 0
    buffer_load_dwordx4 v79, s[12:15], s35 offen lds
    s_add_u32 s43, s39, 32768
    v_add_u32 v80, s43, v64
    ds_read_b128 v[32:35], v80
    v_add_u32 v80, s43, v65
    ds_read_b128 v[36:39], v80
    v_add_u32 v80, s43, v66
    ds_read_b128 v[40:43], v80
    v_add_u32 v80, s43, v67
    ds_read_b128 v[44:47], v80
    v_add_u32 v80, s43, v68
    ds_read_b128 v[48:51], v80
    v_add_u32 v80, s43, v69
    ds_read_b128 v[52:55], v80
    v_add_u32 v80, s43, v70
    ds_read_b128 v[56:59], v80
    v_add_u32 v80, s43, v71
    ds_read_b128 v[60:63], v80
    s_waitcnt lgkmcnt(0)
    v_mfma_f32_16x16x32_bf16 v[8:11], v[128:131], v[32:35], 0
    s_add_u32 s43, s28, 12
    s_mul_i32 s40, s31, 14
    s_lshr_b32 s41, s43, 1
    s_add_u32 s40, s40, s41
    s_mul_i32 s40, s40, 28672
    s_and_b32 s41, s43, 1
    s_lshl_b32 s41, s41, 7
    s_add_u32 s40, s40, s41
    s_add_u32 s40, s40, 12845056
    v_mfma_f32_16x16x32_bf16 v[12:15], v[160:163], v[32:35], 0
    s_lshl_b32 s41, s31, 2
    s_add_u32 s41, s41, s28
    s_mul_i32 s41, s41, 49
    s_add_u32 s41, s41, 21
    s_add_u32 s41, s41, s32
    s_lshl_b32 s41, s41, 11
    s_add_u32 s41, s41, 0
    s_lshl_b32 s42, s32, 11
    s_add_u32 s40, s40, s42
    v_mfma_f32_16x16x32_bf16 v[16:19], v[192:195], v[32:35], 0
    v_mfma_f32_16x16x32_bf16 v[20:23], v[224:227], v[32:35], 0
    v_mul_f32 v84, s36, v84
    v_mul_f32 v85, s36, v85
    v_mul_f32 v86, s36, v86
    v_mfma_f32_16x16x32_bf16 v[8:11], v[132:135], v[36:39], v[8:11]
    v_mul_f32 v87, s36, v87
    v_mul_f32 v88, s36, v88
    v_mul_f32 v89, s36, v89
    v_mfma_f32_16x16x32_bf16 v[12:15], v[164:167], v[36:39], v[12:15]
    v_mul_f32 v90, s36, v90
    v_mul_f32 v91, s36, v91
    v_mul_f32 v92, s36, v92
    v_mfma_f32_16x16x32_bf16 v[16:19], v[196:199], v[36:39], v[16:19]
    v_mul_f32 v93, s36, v93
    v_mul_f32 v94, s36, v94
    v_mul_f32 v95, s36, v95
    v_mfma_f32_16x16x32_bf16 v[20:23], v[228:231], v[36:39], v[20:23]
    v_mul_f32 v96, s36, v96
    v_mul_f32 v97, s36, v97
    v_mul_f32 v98, s36, v98
    v_mfma_f32_16x16x32_bf16 v[8:11], v[136:139], v[40:43], v[8:11]
    v_mul_f32 v99, s36, v99
    v_cvt_pk_bf16_f32 v24, v84, v85
    v_cvt_pk_bf16_f32 v25, v86, v87
    v_mfma_f32_16x16x32_bf16 v[12:15], v[168:171], v[40:43], v[12:15]
    v_cvt_pk_bf16_f32 v26, v88, v89
    v_cvt_pk_bf16_f32 v27, v90, v91
    buffer_store_dwordx4 v[24:27], v1, s[56:59], s40 offen offset:0 sc1
    v_mfma_f32_16x16x32_bf16 v[16:19], v[200:203], v[40:43], v[16:19]
    v_cvt_pk_bf16_f32 v28, v92, v93
    v_cvt_pk_bf16_f32 v29, v94, v95
    v_cvt_pk_bf16_f32 v30, v96, v97
    v_mfma_f32_16x16x32_bf16 v[20:23], v[232:235], v[40:43], v[20:23]
    v_cvt_pk_bf16_f32 v31, v98, v99
    buffer_store_dwordx4 v[28:31], v1, s[56:59], s40 offen offset:1024 sc1
    v_mov_b32 v100, v24
    v_mfma_f32_16x16x32_bf16 v[8:11], v[140:143], v[44:47], v[8:11]
    v_mov_b32 v101, v28
    v_mov_b32 v102, v25
    v_mov_b32 v103, v29
    v_mfma_f32_16x16x32_bf16 v[12:15], v[172:175], v[44:47], v[12:15]
    buffer_store_dwordx4 v[100:103], v3, s[56:59], s41 offen offset:0 sc1
    v_mov_b32 v104, v26
    v_mov_b32 v105, v30
    v_mfma_f32_16x16x32_bf16 v[16:19], v[204:207], v[44:47], v[16:19]
    v_mov_b32 v106, v27
    v_mov_b32 v107, v31
    buffer_store_dwordx4 v[104:107], v3, s[56:59], s41 offen offset:256 sc1
    v_mfma_f32_16x16x32_bf16 v[20:23], v[236:239], v[44:47], v[20:23]
    v_mfma_f32_16x16x32_bf16 v[8:11], v[144:147], v[48:51], v[8:11]
    v_mfma_f32_16x16x32_bf16 v[12:15], v[176:179], v[48:51], v[12:15]
    v_mfma_f32_16x16x32_bf16 v[16:19], v[208:211], v[48:51], v[16:19]
    v_mfma_f32_16x16x32_bf16 v[20:23], v[240:243], v[48:51], v[20:23]
    v_mfma_f32_16x16x32_bf16 v[8:11], v[148:151], v[52:55], v[8:11]
    v_mfma_f32_16x16x32_bf16 v[12:15], v[180:183], v[52:55], v[12:15]
    v_mfma_f32_16x16x32_bf16 v[16:19], v[212:215], v[52:55], v[16:19]
    v_mfma_f32_16x16x32_bf16 v[20:23], v[244:247], v[52:55], v[20:23]
    v_mfma_f32_16x16x32_bf16 v[8:11], v[152:155], v[56:59], v[8:11]
    v_mfma_f32_16x16x32_bf16 v[12:15], v[184:187], v[56:59], v[12:15]
    v_mfma_f32_16x16x32_bf16 v[16:19], v[216:219], v[56:59], v[16:19]
    v_mfma_f32_16x16x32_bf16 v[20:23], v[248:251], v[56:59], v[20:23]
    v_mfma_f32_16x16x32_bf16 v[8:11], v[156:159], v[60:63], v[8:11]
    v_mfma_f32_16x16x32_bf16 v[12:15], v[188:191], v[60:63], v[12:15]
    v_mfma_f32_16x16x32_bf16 v[16:19], v[220:223], v[60:63], v[16:19]
    v_mfma_f32_16x16x32_bf16 v[20:23], v[252:255], v[60:63], v[20:23]
    s_waitcnt vmcnt(12)
    s_add_u32 s43, s39, 65536
    v_add_u32 v80, s43, v64
    ds_read_b128 v[32:35], v80
    v_add_u32 v80, s43, v65
    ds_read_b128 v[36:39], v80
    v_add_u32 v80, s43, v66
    ds_read_b128 v[40:43], v80
    v_add_u32 v80, s43, v67
    ds_read_b128 v[44:47], v80
    v_add_u32 v80, s43, v68
    ds_read_b128 v[48:51], v80
    v_add_u32 v80, s43, v69
    ds_read_b128 v[52:55], v80
    v_add_u32 v80, s43, v70
    ds_read_b128 v[56:59], v80
    v_add_u32 v80, s43, v71
    ds_read_b128 v[60:63], v80
    s_waitcnt lgkmcnt(0)
    v_mfma_f32_16x16x32_bf16 v[84:87], v[128:131], v[32:35], 0
    s_add_u32 s43, s28, 16
    s_mul_i32 s40, s31, 14
    s_lshr_b32 s41, s43, 1
    s_add_u32 s40, s40, s41
    s_mul_i32 s40, s40, 28672
    s_and_b32 s41, s43, 1
    s_lshl_b32 s41, s41, 7
    s_add_u32 s40, s40, s41
    s_add_u32 s40, s40, 12845056
    v_mfma_f32_16x16x32_bf16 v[88:91], v[160:163], v[32:35], 0
    s_lshl_b32 s41, s31, 2
    s_add_u32 s41, s41, s28
    s_mul_i32 s41, s41, 49
    s_add_u32 s41, s41, 28
    s_add_u32 s41, s41, s32
    s_lshl_b32 s41, s41, 11
    s_add_u32 s41, s41, 0
    s_lshl_b32 s42, s32, 11
    s_add_u32 s40, s40, s42
    v_mfma_f32_16x16x32_bf16 v[92:95], v[192:195], v[32:35], 0
    v_mfma_f32_16x16x32_bf16 v[96:99], v[224:227], v[32:35], 0
    v_mul_f32 v8, s36, v8
    v_mul_f32 v9, s36, v9
    v_mul_f32 v10, s36, v10
    v_mfma_f32_16x16x32_bf16 v[84:87], v[132:135], v[36:39], v[84:87]
    v_mul_f32 v11, s36, v11
    v_mul_f32 v12, s36, v12
    v_mul_f32 v13, s36, v13
    v_mfma_f32_16x16x32_bf16 v[88:91], v[164:167], v[36:39], v[88:91]
    v_mul_f32 v14, s36, v14
    v_mul_f32 v15, s36, v15
    v_mul_f32 v16, s36, v16
    v_mfma_f32_16x16x32_bf16 v[92:95], v[196:199], v[36:39], v[92:95]
    v_mul_f32 v17, s36, v17
    v_mul_f32 v18, s36, v18
    v_mul_f32 v19, s36, v19
    v_mfma_f32_16x16x32_bf16 v[96:99], v[228:231], v[36:39], v[96:99]
    v_mul_f32 v20, s36, v20
    v_mul_f32 v21, s36, v21
    v_mul_f32 v22, s36, v22
    v_mfma_f32_16x16x32_bf16 v[84:87], v[136:139], v[40:43], v[84:87]
    v_mul_f32 v23, s36, v23
    v_cvt_pk_bf16_f32 v24, v8, v9
    v_cvt_pk_bf16_f32 v25, v10, v11
    v_mfma_f32_16x16x32_bf16 v[88:91], v[168:171], v[40:43], v[88:91]
    v_cvt_pk_bf16_f32 v26, v12, v13
    v_cvt_pk_bf16_f32 v27, v14, v15
    buffer_store_dwordx4 v[24:27], v1, s[56:59], s40 offen offset:0 sc1
    v_mfma_f32_16x16x32_bf16 v[92:95], v[200:203], v[40:43], v[92:95]
    v_cvt_pk_bf16_f32 v28, v16, v17
    v_cvt_pk_bf16_f32 v29, v18, v19
    v_cvt_pk_bf16_f32 v30, v20, v21
    v_mfma_f32_16x16x32_bf16 v[96:99], v[232:235], v[40:43], v[96:99]
    v_cvt_pk_bf16_f32 v31, v22, v23
    buffer_store_dwordx4 v[28:31], v1, s[56:59], s40 offen offset:1024 sc1
    v_mov_b32 v100, v24
    v_mfma_f32_16x16x32_bf16 v[84:87], v[140:143], v[44:47], v[84:87]
    v_mov_b32 v101, v28
    v_mov_b32 v102, v25
    v_mov_b32 v103, v29
    v_mfma_f32_16x16x32_bf16 v[88:91], v[172:175], v[44:47], v[88:91]
    buffer_store_dwordx4 v[100:103], v3, s[56:59], s41 offen offset:0 sc1
    v_mov_b32 v104, v26
    v_mov_b32 v105, v30
    v_mfma_f32_16x16x32_bf16 v[92:95], v[204:207], v[44:47], v[92:95]
    v_mov_b32 v106, v27
    v_mov_b32 v107, v31
    buffer_store_dwordx4 v[104:107], v3, s[56:59], s41 offen offset:256 sc1
    v_mfma_f32_16x16x32_bf16 v[96:99], v[236:239], v[44:47], v[96:99]
    v_mfma_f32_16x16x32_bf16 v[84:87], v[144:147], v[48:51], v[84:87]
    v_mfma_f32_16x16x32_bf16 v[88:91], v[176:179], v[48:51], v[88:91]
    v_mfma_f32_16x16x32_bf16 v[92:95], v[208:211], v[48:51], v[92:95]
    v_mfma_f32_16x16x32_bf16 v[96:99], v[240:243], v[48:51], v[96:99]
    v_mfma_f32_16x16x32_bf16 v[84:87], v[148:151], v[52:55], v[84:87]
    v_mfma_f32_16x16x32_bf16 v[88:91], v[180:183], v[52:55], v[88:91]
    v_mfma_f32_16x16x32_bf16 v[92:95], v[212:215], v[52:55], v[92:95]
    v_mfma_f32_16x16x32_bf16 v[96:99], v[244:247], v[52:55], v[96:99]
    v_mfma_f32_16x16x32_bf16 v[84:87], v[152:155], v[56:59], v[84:87]
    v_mfma_f32_16x16x32_bf16 v[88:91], v[184:187], v[56:59], v[88:91]
    v_mfma_f32_16x16x32_bf16 v[92:95], v[216:219], v[56:59], v[92:95]
    v_mfma_f32_16x16x32_bf16 v[96:99], v[248:251], v[56:59], v[96:99]
    v_mfma_f32_16x16x32_bf16 v[84:87], v[156:159], v[60:63], v[84:87]
    v_mfma_f32_16x16x32_bf16 v[88:91], v[188:191], v[60:63], v[88:91]
    v_mfma_f32_16x16x32_bf16 v[92:95], v[220:223], v[60:63], v[92:95]
    v_mfma_f32_16x16x32_bf16 v[96:99], v[252:255], v[60:63], v[96:99]
    s_waitcnt vmcnt(4)
    s_add_u32 s43, s39, 0
    v_add_u32 v80, s43, v64
    ds_read_b128 v[32:35], v80
    v_add_u32 v80, s43, v65
    ds_read_b128 v[36:39], v80
    v_add_u32 v80, s43, v66
    ds_read_b128 v[40:43], v80
    v_add_u32 v80, s43, v67
    ds_read_b128 v[44:47], v80
    v_add_u32 v80, s43, v68
    ds_read_b128 v[48:51], v80
    v_add_u32 v80, s43, v69
    ds_read_b128 v[52:55], v80
    v_add_u32 v80, s43, v70
    ds_read_b128 v[56:59], v80
    v_add_u32 v80, s43, v71
    ds_read_b128 v[60:63], v80
    s_waitcnt lgkmcnt(0)
    v_mfma_f32_16x16x32_bf16 v[8:11], v[128:131], v[32:35], 0
    s_add_u32 s43, s28, 20
    s_mul_i32 s40, s31, 14
    s_lshr_b32 s41, s43, 1
    s_add_u32 s40, s40, s41
    s_mul_i32 s40, s40, 28672
    s_and_b32 s41, s43, 1
    s_lshl_b32 s41, s41, 7
    s_add_u32 s40, s40, s41
    s_add_u32 s40, s40, 12845056
    v_mfma_f32_16x16x32_bf16 v[12:15], v[160:163], v[32:35], 0
    s_lshl_b32 s41, s31, 2
    s_add_u32 s41, s41, s28
    s_mul_i32 s41, s41, 49
    s_add_u32 s41, s41, 35
    s_add_u32 s41, s41, s32
    s_lshl_b32 s41, s41, 11
    s_add_u32 s41, s41, 0
    s_lshl_b32 s42, s32, 11
    s_add_u32 s40, s40, s42
    v_mfma_f32_16x16x32_bf16 v[16:19], v[192:195], v[32:35], 0
    v_mfma_f32_16x16x32_bf16 v[20:23], v[224:227], v[32:35], 0
    v_mul_f32 v84, s36, v84
    v_mul_f32 v85, s36, v85
    v_mul_f32 v86, s36, v86
    v_mfma_f32_16x16x32_bf16 v[8:11], v[132:135], v[36:39], v[8:11]
    v_mul_f32 v87, s36, v87
    v_mul_f32 v88, s36, v88
    v_mul_f32 v89, s36, v89
    v_mfma_f32_16x16x32_bf16 v[12:15], v[164:167], v[36:39], v[12:15]
    v_mul_f32 v90, s36, v90
    v_mul_f32 v91, s36, v91
    v_mul_f32 v92, s36, v92
    v_mfma_f32_16x16x32_bf16 v[16:19], v[196:199], v[36:39], v[16:19]
    v_mul_f32 v93, s36, v93
    v_mul_f32 v94, s36, v94
    v_mul_f32 v95, s36, v95
    v_mfma_f32_16x16x32_bf16 v[20:23], v[228:231], v[36:39], v[20:23]
    v_mul_f32 v96, s36, v96
    v_mul_f32 v97, s36, v97
    v_mul_f32 v98, s36, v98
    v_mfma_f32_16x16x32_bf16 v[8:11], v[136:139], v[40:43], v[8:11]
    v_mul_f32 v99, s36, v99
    v_cvt_pk_bf16_f32 v24, v84, v85
    v_cvt_pk_bf16_f32 v25, v86, v87
    v_mfma_f32_16x16x32_bf16 v[12:15], v[168:171], v[40:43], v[12:15]
    v_cvt_pk_bf16_f32 v26, v88, v89
    v_cvt_pk_bf16_f32 v27, v90, v91
    buffer_store_dwordx4 v[24:27], v1, s[56:59], s40 offen offset:0 sc1
    v_mfma_f32_16x16x32_bf16 v[16:19], v[200:203], v[40:43], v[16:19]
    v_cvt_pk_bf16_f32 v28, v92, v93
    v_cvt_pk_bf16_f32 v29, v94, v95
    v_cvt_pk_bf16_f32 v30, v96, v97
    v_mfma_f32_16x16x32_bf16 v[20:23], v[232:235], v[40:43], v[20:23]
    v_cvt_pk_bf16_f32 v31, v98, v99
    buffer_store_dwordx4 v[28:31], v1, s[56:59], s40 offen offset:1024 sc1
    v_mov_b32 v100, v24
    v_mfma_f32_16x16x32_bf16 v[8:11], v[140:143], v[44:47], v[8:11]
    v_mov_b32 v101, v28
    v_mov_b32 v102, v25
    v_mov_b32 v103, v29
    v_mfma_f32_16x16x32_bf16 v[12:15], v[172:175], v[44:47], v[12:15]
    buffer_store_dwordx4 v[100:103], v3, s[56:59], s41 offen offset:0 sc1
    v_mov_b32 v104, v26
    v_mov_b32 v105, v30
    v_mfma_f32_16x16x32_bf16 v[16:19], v[204:207], v[44:47], v[16:19]
    v_mov_b32 v106, v27
    v_mov_b32 v107, v31
    buffer_store_dwordx4 v[104:107], v3, s[56:59], s41 offen offset:256 sc1
    v_mfma_f32_16x16x32_bf16 v[20:23], v[236:239], v[44:47], v[20:23]
    v_mfma_f32_16x16x32_bf16 v[8:11], v[144:147], v[48:51], v[8:11]
    v_mfma_f32_16x16x32_bf16 v[12:15], v[176:179], v[48:51], v[12:15]
    v_mfma_f32_16x16x32_bf16 v[16:19], v[208:211], v[48:51], v[16:19]
    v_mfma_f32_16x16x32_bf16 v[20:23], v[240:243], v[48:51], v[20:23]
    v_mfma_f32_16x16x32_bf16 v[8:11], v[148:151], v[52:55], v[8:11]
    v_mfma_f32_16x16x32_bf16 v[12:15], v[180:183], v[52:55], v[12:15]
    v_mfma_f32_16x16x32_bf16 v[16:19], v[212:215], v[52:55], v[16:19]
    v_mfma_f32_16x16x32_bf16 v[20:23], v[244:247], v[52:55], v[20:23]
    v_mfma_f32_16x16x32_bf16 v[8:11], v[152:155], v[56:59], v[8:11]
    v_mfma_f32_16x16x32_bf16 v[12:15], v[184:187], v[56:59], v[12:15]
    v_mfma_f32_16x16x32_bf16 v[16:19], v[216:219], v[56:59], v[16:19]
    v_mfma_f32_16x16x32_bf16 v[20:23], v[248:251], v[56:59], v[20:23]
    v_mfma_f32_16x16x32_bf16 v[8:11], v[156:159], v[60:63], v[8:11]
    v_mfma_f32_16x16x32_bf16 v[12:15], v[188:191], v[60:63], v[12:15]
    v_mfma_f32_16x16x32_bf16 v[16:19], v[220:223], v[60:63], v[16:19]
    v_mfma_f32_16x16x32_bf16 v[20:23], v[252:255], v[60:63], v[20:23]
    s_add_u32 s43, s28, 24
    s_mul_i32 s40, s31, 14
    s_lshr_b32 s41, s43, 1
    s_add_u32 s40, s40, s41
    s_mul_i32 s40, s40, 28672
    s_and_b32 s41, s43, 1
    s_lshl_b32 s41, s41, 7
    s_add_u32 s40, s40, s41
    s_add_u32 s40, s40, 12845056
    s_lshl_b32 s41, s31, 2
    s_add_u32 s41, s41, s28
    s_mul_i32 s41, s41, 49
    s_add_u32 s41, s41, 42
    s_add_u32 s41, s41, s32
    s_lshl_b32 s41, s41, 11
    s_add_u32 s41, s41, 0
    s_lshl_b32 s42, s32, 11
    s_add_u32 s40, s40, s42
    v_mul_f32 v8, s36, v8
    v_mul_f32 v9, s36, v9
    v_mul_f32 v10, s36, v10
    v_mul_f32 v11, s36, v11
    v_mul_f32 v12, s36, v12
    v_mul_f32 v13, s36, v13
    v_mul_f32 v14, s36, v14
    v_mul_f32 v15, s36, v15
    v_mul_f32 v16, s36, v16
    v_mul_f32 v17, s36, v17
    v_mul_f32 v18, s36, v18
    v_mul_f32 v19, s36, v19
    v_mul_f32 v20, s36, v20
    v_mul_f32 v21, s36, v21
    v_mul_f32 v22, s36, v22
    v_mul_f32 v23, s36, v23
    v_cvt_pk_bf16_f32 v24, v8, v9
    v_cvt_pk_bf16_f32 v25, v10, v11
    v_cvt_pk_bf16_f32 v26, v12, v13
    v_cvt_pk_bf16_f32 v27, v14, v15
    buffer_store_dwordx4 v[24:27], v1, s[56:59], s40 offen offset:0 sc1
    v_cvt_pk_bf16_f32 v28, v16, v17
    v_cvt_pk_bf16_f32 v29, v18, v19
    v_cvt_pk_bf16_f32 v30, v20, v21
    v_cvt_pk_bf16_f32 v31, v22, v23
    buffer_store_dwordx4 v[28:31], v1, s[56:59], s40 offen offset:1024 sc1
    v_mov_b32 v100, v24
    v_mov_b32 v101, v28
    v_mov_b32 v102, v25
    v_mov_b32 v103, v29
    buffer_store_dwordx4 v[100:103], v3, s[56:59], s41 offen offset:0 sc1
    v_mov_b32 v104, v26
    v_mov_b32 v105, v30
    v_mov_b32 v106, v27
    v_mov_b32 v107, v31
    buffer_store_dwordx4 v[104:107], v3, s[56:59], s41 offen offset:256 sc1
P_done:
    s_waitcnt vmcnt(0)
    s_mov_b32 s8, s70
    s_and_b32 s9, s71, 0xffff
    s_mov_b32 s10, 256
    s_mov_b32 s11, 0x20000
    s_cmp_eq_u32 s76, 0
    s_cbranch_scc0 K_init_ok
    s_mov_b32 s54, 1048576
K_init:
    buffer_load_dword v2, off, s[8:11], 0 offset:64 sc1
    s_mov_b32 s90, 26
    s_sub_u32 s54, s54, 1
    s_cmp_eq_u32 s54, 0
    s_cbranch_scc1 L_abort1
    s_waitcnt vmcnt(0)
    v_readfirstlane_b32 s53, v2
    s_nop 0
    s_cmp_ge_u32 s53, 32
    s_cbranch_scc1 K_init_ok
    s_sleep 2
    s_branch K_init
K_init_ok:
    s_barrier
    s_cmp_eq_u32 s77, 2
    s_cbranch_scc1 K_prep2d
    s_waitcnt vmcnt(0)
    s_barrier
    s_cmp_eq_u32 s76, 0
    s_cbranch_scc0 K_fprep
    s_lshl_b32 s53, s51, 4
    s_add_u32 s53, s53, 78622720
    s_mov_b64 exec, 1
    v_mov_b32 v2, 1
    buffer_store_dword v2, off, s[4:7], s53 sc1
    s_mov_b64 exec, -1
K_fprep:
    s_cmp_eq_u32 s77, 1
    s_cbranch_scc1 X0_back
    s_add_u32 s55, s55, 4
    s_mov_b32 s77, 2
    s_branch K_prep
K_prep2d:
    s_waitcnt vmcnt(0)
    s_barrier
    s_cmp_eq_u32 s76, 0
    s_cbranch_scc0 K_fprep2
    s_lshl_b32 s53, s51, 4
    s_add_u32 s53, s53, 78647296
    s_mov_b64 exec, 1
    v_mov_b32 v2, 1
    buffer_store_dword v2, off, s[4:7], s53 sc1
    s_mov_b64 exec, -1
K_fprep2:
    s_branch K_layer
K_noprep:
    s_cmp_lt_u32 s64, 32
    s_cbranch_scc0 K_tab
    s_load_dwordx4 s[44:47], s[0:1], 8
    s_waitcnt lgkmcnt(0)
    s_mov_b32 s12, s44
    s_and_b32 s13, s45, 0xffff
    s_mov_b32 s14, 921600
    s_mov_b32 s15, 0x20000
    s_mov_b32 s16, s46
    s_and_b32 s17, s47, 0xffff
    s_mov_b32 s18, 921600
    s_mov_b32 s19, 0x20000
    v_accvgpr_read_b32 v0, a255
    s_mul_i32 s28, s64, 28800
    v_lshlrev_b32 v1, 4, v0
    v_add_u32 v2, 0, v1
    buffer_load_dwordx4 v[8:11], v2, s[12:15], s28 offen
    buffer_load_dwordx4 v[12:15], v2, s[16:19], s28 offen
    v_add_u32 v2, 4096, v1
    buffer_load_dwordx4 v[16:19], v2, s[12:15], s28 offen
    buffer_load_dwordx4 v[20:23], v2, s[16:19], s28 offen
    v_add_u32 v2, 8192, v1
    buffer_load_dwordx4 v[24:27], v2, s[12:15], s28 offen
    buffer_load_dwordx4 v[28:31], v2, s[16:19], s28 offen
    v_add_u32 v2, 12288, v1
    buffer_load_dwordx4 v[32:35], v2, s[12:15], s28 offen
    buffer_load_dwordx4 v[36:39], v2, s[16:19], s28 offen
    v_add_u32 v2, 16384, v1
    buffer_load_dwordx4 v[40:43], v2, s[12:15], s28 offen
    buffer_load_dwordx4 v[44:47], v2, s[16:19], s28 offen
    v_add_u32 v2, 20480, v1
    buffer_load_dwordx4 v[48:51], v2, s[12:15], s28 offen
    buffer_load_dwordx4 v[52:55], v2, s[16:19], s28 offen
    v_add_u32 v2, 24576, v1
    buffer_load_dwordx4 v[56:59], v2, s[12:15], s28 offen
    buffer_load_dwordx4 v[60:63], v2, s[16:19], s28 offen
    v_add_u32 v2, 28672, v1
    buffer_load_dwordx4 v[64:67], v2, s[12:15], s28 offen
    buffer_load_dwordx4 v[68:71], v2, s[16:19], s28 offen
    s_barrier
    s_waitcnt vmcnt(14)
    v_add_u32 v2, 0, v1
    ds_write_b128 v2, v[8:11]
    ds_write_b128 v2, v[12:15] offset:28800
    s_waitcnt vmcnt(12)
    v_add_u32 v2, 4096, v1
    ds_write_b128 v2, v[16:19]
    ds_write_b128 v2, v[20:23] offset:28800
    s_waitcnt vmcnt(10)
    v_add_u32 v2, 8192, v1
    ds_write_b128 v2, v[24:27]
    ds_write_b128 v2, v[28:31] offset:28800
    s_waitcnt vmcnt(8)
    v_add_u32 v2, 12288, v1
    ds_write_b128 v2, v[32:35]
    ds_write_b128 v2, v[36:39] offset:28800
    s_waitcnt vmcnt(6)
    v_add_u32 v2, 16384, v1
    ds_write_b128 v2, v[40:43]
    ds_write_b128 v2, v[44:47] offset:28800
    s_waitcnt vmcnt(4)
    v_add_u32 v2, 20480, v1
    ds_write_b128 v2, v[48:51]
    ds_write_b128 v2, v[52:55] offset:28800
    s_waitcnt vmcnt(2)
    v_add_u32 v2, 24576, v1
    ds_write_b128 v2, v[56:59]
    ds_write_b128 v2, v[60:63] offset:28800
    s_waitcnt vmcnt(0)
    v_add_u32 v2, 28672, v1
    v_mov_b32 v4, 28800
    v_cmp_gt_u32 vcc, v4, v2
    v_mov_b32 v4, 57600
    s_nop 0
    v_cndmask_b32 v2, v4, v2, vcc
    ds_write_b128 v2, v[64:67]
    v_add_u32 v3, 28800, v2
    v_mov_b32 v4, 57616
    v_cndmask_b32 v3, v4, v3, vcc
    ds_write_b128 v3, v[68:71]
    s_waitcnt lgkmcnt(0)
    s_barrier
    v_and_b32 v1, 63, v0
    v_lshrrev_b32 v2, 6, v0
    v_mul_u32_u24 v3, 450, v1
    v_lshl_add_u32 v3, v2, 1, v3
    s_lshl_b32 s29, s64, 8
    s_add_u32 s29, s29, 26460160
    v_lshlrev_b32 v4, 2, v1
    v_lshl_add_u32 v4, v2, 13, v4
    s_mov_b32 s3, 0
T_wt_loop:
    ds_read_u16 v8, v3 offset:0
    ds_read_u16 v16, v3 offset:28800
    ds_read_u16 v9, v3 offset:8
    ds_read_u16 v17, v3 offset:28808
    ds_read_u16 v10, v3 offset:16
    ds_read_u16 v18, v3 offset:28816
    ds_read_u16 v11, v3 offset:24
    ds_read_u16 v19, v3 offset:28824
    ds_read_u16 v12, v3 offset:32
    ds_read_u16 v20, v3 offset:28832
    ds_read_u16 v13, v3 offset:40
    ds_read_u16 v21, v3 offset:28840
    ds_read_u16 v14, v3 offset:48
    ds_read_u16 v22, v3 offset:28848
    s_waitcnt lgkmcnt(8)
    ds_read_u16 v15, v3 offset:56
    ds_read_u16 v23, v3 offset:28856
    s_waitcnt lgkmcnt(0)
    v_lshl_or_b32 v8, v16, 16, v8
    s_add_u32 s30, s29, 0
    buffer_store_dword v8, v4, s[56:59], s30 offen sc1
    v_lshl_or_b32 v9, v17, 16, v9
    s_add_u32 s30, s29, 32768
    buffer_store_dword v9, v4, s[56:59], s30 offen sc1
    v_lshl_or_b32 v10, v18, 16, v10
    s_add_u32 s30, s29, 65536
    buffer_store_dword v10, v4, s[56:59], s30 offen sc1
    v_lshl_or_b32 v11, v19, 16, v11
    s_add_u32 s30, s29, 98304
    buffer_store_dword v11, v4, s[56:59], s30 offen sc1
    v_lshl_or_b32 v12, v20, 16, v12
    s_add_u32 s30, s29, 131072
    buffer_store_dword v12, v4, s[56:59], s30 offen sc1
    v_lshl_or_b32 v13, v21, 16, v13
    s_add_u32 s30, s29, 163840
    buffer_store_dword v13, v4, s[56:59], s30 offen sc1
    v_lshl_or_b32 v14, v22, 16, v14
    s_add_u32 s30, s29, 196608
    buffer_store_dword v14, v4, s[56:59], s30 offen sc1
    v_lshl_or_b32 v15, v23, 16, v15
    s_add_u32 s30, s29, 229376
    buffer_store_dword v15, v4, s[56:59], s30 offen sc1
    v_add_u32 v3, 64, v3
    s_add_u32 s29, s29, 262144
    s_add_u32 s3, s3, 32
    s_cmp_lt_u32 s3, 224
    s_cbranch_scc1 T_wt_loop
    s_cmp_eq_u32 s76, 0
    s_cbranch_scc0 T_wt_end
    ds_read_u16 v8, v3
    ds_read_u16 v16, v3 offset:28800
    s_waitcnt lgkmcnt(0)
    v_lshl_or_b32 v8, v16, 16, v8
    buffer_store_dword v8, v4, s[56:59], s29 offen sc1
T_wt_end:
    s_branch K_tabd
K_tab:
    s_sub_u32 s52, s64, 32
    v_accvgpr_read_b32 v0, a255
    s_lshl_b32 s3, s52, 8
    v_add_u32 v1, s3, v0
    s_mov_b32 s29, 0
T_fd:
    v_add_u32 v39, s29, v1
    v_lshrrev_b32 v2, 6, v39
    s_mov_b32 s30, 306783379
    v_mul_hi_u32 v3, v2, s30
    v_mul_u32_u24 v4, 14, v3
    v_sub_u32 v4, v2, v4
    v_and_b32 v5, 15, v0
    v_bfe_u32 v6, v0, 4, 2
    v_and_b32 v7, 15, v3
    v_lshl_add_u32 v7, v7, 4, v5
    v_lshrrev_b32 v8, 4, v3
    v_lshlrev_b32 v9, 5, v4
    v_lshl_add_u32 v9, v6, 3, v9
    v_cmp_eq_u32 s[32:33], 0, v8
    v_mov_b32 v36, 224
    v_cmp_gt_u32 s[34:35], v7, v36
    v_add_u32 v10, 0, v9
    v_mul_u32_u24 v10, v7, v10
    s_mov_b32 s30, 9586981
    v_mul_hi_u32 v12, v10, s30
    v_mul_u32_u24 v12, 448, v12
    v_sub_u32 v12, v10, v12
    v_cvt_f32_u32 v11, v12
    v_mul_f32 v11, 0x3b124925, v11
    v_cos_f32 v12, v11
    v_sin_f32 v13, v11
    s_nop 0
    v_sub_f32 v13, 0, v13
    v_cndmask_b32 v20, v13, v12, s[32:33]
    v_cndmask_b32 v20, v20, 0, s[34:35]
    v_add_u32 v10, 1, v9
    v_mul_u32_u24 v10, v7, v10
    s_mov_b32 s30, 9586981
    v_mul_hi_u32 v12, v10, s30
    v_mul_u32_u24 v12, 448, v12
    v_sub_u32 v12, v10, v12
    v_cvt_f32_u32 v11, v12
    v_mul_f32 v11, 0x3b124925, v11
    v_cos_f32 v12, v11
    v_sin_f32 v13, v11
    s_nop 0
    v_sub_f32 v13, 0, v13
    v_cndmask_b32 v21, v13, v12, s[32:33]
    v_cndmask_b32 v21, v21, 0, s[34:35]
    v_add_u32 v10, 2, v9
    v_mul_u32_u24 v10, v7, v10
    s_mov_b32 s30, 9586981
    v_mul_hi_u32 v12, v10, s30
    v_mul_u32_u24 v12, 448, v12
    v_sub_u32 v12, v10, v12
    v_cvt_f32_u32 v11, v12
    v_mul_f32 v11, 0x3b124925, v11
    v_cos_f32 v12, v11
    v_sin_f32 v13, v11
    s_nop 0
    v_sub_f32 v13, 0, v13
    v_cndmask_b32 v22, v13, v12, s[32:33]
    v_cndmask_b32 v22, v22, 0, s[34:35]
    v_add_u32 v10, 3, v9
    v_mul_u32_u24 v10, v7, v10
    s_mov_b32 s30, 9586981
    v_mul_hi_u32 v12, v10, s30
    v_mul_u32_u24 v12, 448, v12
    v_sub_u32 v12, v10, v12
    v_cvt_f32_u32 v11, v12
    v_mul_f32 v11, 0x3b124925, v11
    v_cos_f32 v12, v11
    v_sin_f32 v13, v11
    s_nop 0
    v_sub_f32 v13, 0, v13
    v_cndmask_b32 v23, v13, v12, s[32:33]
    v_cndmask_b32 v23, v23, 0, s[34:35]
    v_add_u32 v10, 4, v9
    v_mul_u32_u24 v10, v7, v10
    s_mov_b32 s30, 9586981
    v_mul_hi_u32 v12, v10, s30
    v_mul_u32_u24 v12, 448, v12
    v_sub_u32 v12, v10, v12
    v_cvt_f32_u32 v11, v12
    v_mul_f32 v11, 0x3b124925, v11
    v_cos_f32 v12, v11
    v_sin_f32 v13, v11
    s_nop 0
    v_sub_f32 v13, 0, v13
    v_cndmask_b32 v24, v13, v12, s[32:33]
    v_cndmask_b32 v24, v24, 0, s[34:35]
    v_add_u32 v10, 5, v9
    v_mul_u32_u24 v10, v7, v10
    s_mov_b32 s30, 9586981
    v_mul_hi_u32 v12, v10, s30
    v_mul_u32_u24 v12, 448, v12
    v_sub_u32 v12, v10, v12
    v_cvt_f32_u32 v11, v12
    v_mul_f32 v11, 0x3b124925, v11
    v_cos_f32 v12, v11
    v_sin_f32 v13, v11
    s_nop 0
    v_sub_f32 v13, 0, v13
    v_cndmask_b32 v25, v13, v12, s[32:33]
    v_cndmask_b32 v25, v25, 0, s[34:35]
    v_add_u32 v10, 6, v9
    v_mul_u32_u24 v10, v7, v10
    s_mov_b32 s30, 9586981
    v_mul_hi_u32 v12, v10, s30
    v_mul_u32_u24 v12, 448, v12
    v_sub_u32 v12, v10, v12
    v_cvt_f32_u32 v11, v12
    v_mul_f32 v11, 0x3b124925, v11
    v_cos_f32 v12, v11
    v_sin_f32 v13, v11
    s_nop 0
    v_sub_f32 v13, 0, v13
    v_cndmask_b32 v26, v13, v12, s[32:33]
    v_cndmask_b32 v26, v26, 0, s[34:35]
    v_add_u32 v10, 7, v9
    v_mul_u32_u24 v10, v7, v10
    s_mov_b32 s30, 9586981
    v_mul_hi_u32 v12, v10, s30
    v_mul_u32_u24 v12, 448, v12
    v_sub_u32 v12, v10, v12
    v_cvt_f32_u32 v11, v12
    v_mul_f32 v11, 0x3b124925, v11
    v_cos_f32 v12, v11
    v_sin_f32 v13, v11
    s_nop 0
    v_sub_f32 v13, 0, v13
    v_cndmask_b32 v27, v13, v12, s[32:33]
    v_cndmask_b32 v27, v27, 0, s[34:35]
    v_cvt_pk_bf16_f32 v30, v20, v21
    v_cvt_pk_bf16_f32 v31, v22, v23
    v_cvt_pk_bf16_f32 v32, v24, v25
    v_cvt_pk_bf16_f32 v33, v26, v27
    v_mov_b32 v36, 28672
    v_cmp_gt_u32 vcc, v36, v39
    v_lshlrev_b32 v2, 4, v39
    v_mov_b32 v37, 0x7fffffff
    v_cndmask_b32 v2, v37, v2, vcc
    s_mov_b32 s31, 25690112
    buffer_store_dwordx4 v[30:33], v2, s[56:59], s31 offen sc1
    s_add_u32 s29, s29, 24576
    s_cmp_lt_u32 s29, 28672
    s_cbranch_scc1 T_fd
    v_accvgpr_read_b32 v0, a255
    s_lshl_b32 s3, s52, 8
    v_add_u32 v1, s3, v0
    s_mov_b32 s29, 0
T_gd:
    v_add_u32 v39, s29, v1
    v_lshrrev_b32 v2, 6, v39
    s_mov_b32 s30, 286331154
    v_mul_hi_u32 v3, v2, s30
    v_mul_u32_u24 v4, 15, v3
    v_sub_u32 v4, v2, v4
    v_and_b32 v5, 15, v0
    v_bfe_u32 v6, v0, 4, 2
    v_lshl_add_u32 v7, v3, 4, v5
    v_mov_b32 v36, 8
    v_cmp_lt_u32 s[32:33], v4, v36
    v_subrev_u32 v8, 8, v4
    s_nop 0
    v_cndmask_b32 v8, v8, v4, s[32:33]
    v_lshlrev_b32 v9, 5, v8
    v_lshl_add_u32 v9, v6, 3, v9
    v_add_u32 v14, 0, v9
    v_mul_u32_u24 v10, v7, v14
    s_mov_b32 s30, 9586981
    v_mul_hi_u32 v12, v10, s30
    v_mul_u32_u24 v12, 448, v12
    v_sub_u32 v12, v10, v12
    v_cvt_f32_u32 v11, v12
    v_mul_f32 v11, 0x3b124925, v11
    v_cos_f32 v12, v11
    v_sin_f32 v13, v11
    s_nop 0
    v_sub_f32 v13, 0, v13
    v_cndmask_b32 v12, v13, v12, s[32:33]
    v_mov_b32 v15, 0x3b924925
    v_mov_b32 v16, 0x3b124925
    v_cmp_eq_u32 vcc, 0, v14
    s_nop 1
    v_cndmask_b32 v15, v15, v16, vcc
    v_mov_b32 v36, 224
    v_cmp_eq_u32 vcc, v36, v14
    s_nop 1
    v_cndmask_b32 v15, v15, v16, vcc
    v_cmp_lt_u32 vcc, v36, v14
    s_nop 1
    v_cndmask_b32 v15, v15, 0, vcc
    v_mul_f32 v20, v12, v15
    v_add_u32 v14, 1, v9
    v_mul_u32_u24 v10, v7, v14
    s_mov_b32 s30, 9586981
    v_mul_hi_u32 v12, v10, s30
    v_mul_u32_u24 v12, 448, v12
    v_sub_u32 v12, v10, v12
    v_cvt_f32_u32 v11, v12
    v_mul_f32 v11, 0x3b124925, v11
    v_cos_f32 v12, v11
    v_sin_f32 v13, v11
    s_nop 0
    v_sub_f32 v13, 0, v13
    v_cndmask_b32 v12, v13, v12, s[32:33]
    v_mov_b32 v15, 0x3b924925
    v_mov_b32 v16, 0x3b124925
    v_cmp_eq_u32 vcc, 0, v14
    s_nop 1
    v_cndmask_b32 v15, v15, v16, vcc
    v_mov_b32 v36, 224
    v_cmp_eq_u32 vcc, v36, v14
    s_nop 1
    v_cndmask_b32 v15, v15, v16, vcc
    v_cmp_lt_u32 vcc, v36, v14
    s_nop 1
    v_cndmask_b32 v15, v15, 0, vcc
    v_mul_f32 v21, v12, v15
    v_add_u32 v14, 2, v9
    v_mul_u32_u24 v10, v7, v14
    s_mov_b32 s30, 9586981
    v_mul_hi_u32 v12, v10, s30
    v_mul_u32_u24 v12, 448, v12
    v_sub_u32 v12, v10, v12
    v_cvt_f32_u32 v11, v12
    v_mul_f32 v11, 0x3b124925, v11
    v_cos_f32 v12, v11
    v_sin_f32 v13, v11
    s_nop 0
    v_sub_f32 v13, 0, v13
    v_cndmask_b32 v12, v13, v12, s[32:33]
    v_mov_b32 v15, 0x3b924925
    v_mov_b32 v16, 0x3b124925
    v_cmp_eq_u32 vcc, 0, v14
    s_nop 1
    v_cndmask_b32 v15, v15, v16, vcc
    v_mov_b32 v36, 224
    v_cmp_eq_u32 vcc, v36, v14
    s_nop 1
    v_cndmask_b32 v15, v15, v16, vcc
    v_cmp_lt_u32 vcc, v36, v14
    s_nop 1
    v_cndmask_b32 v15, v15, 0, vcc
    v_mul_f32 v22, v12, v15
    v_add_u32 v14, 3, v9
    v_mul_u32_u24 v10, v7, v14
    s_mov_b32 s30, 9586981
    v_mul_hi_u32 v12, v10, s30
    v_mul_u32_u24 v12, 448, v12
    v_sub_u32 v12, v10, v12
    v_cvt_f32_u32 v11, v12
    v_mul_f32 v11, 0x3b124925, v11
    v_cos_f32 v12, v11
    v_sin_f32 v13, v11
    s_nop 0
    v_sub_f32 v13, 0, v13
    v_cndmask_b32 v12, v13, v12, s[32:33]
    v_mov_b32 v15, 0x3b924925
    v_mov_b32 v16, 0x3b124925
    v_cmp_eq_u32 vcc, 0, v14
    s_nop 1
    v_cndmask_b32 v15, v15, v16, vcc
    v_mov_b32 v36, 224
    v_cmp_eq_u32 vcc, v36, v14
    s_nop 1
    v_cndmask_b32 v15, v15, v16, vcc
    v_cmp_lt_u32 vcc, v36, v14
    s_nop 1
    v_cndmask_b32 v15, v15, 0, vcc
    v_mul_f32 v23, v12, v15
    v_add_u32 v14, 4, v9
    v_mul_u32_u24 v10, v7, v14
    s_mov_b32 s30, 9586981
    v_mul_hi_u32 v12, v10, s30
    v_mul_u32_u24 v12, 448, v12
    v_sub_u32 v12, v10, v12
    v_cvt_f32_u32 v11, v12
    v_mul_f32 v11, 0x3b124925, v11
    v_cos_f32 v12, v11
    v_sin_f32 v13, v11
    s_nop 0
    v_sub_f32 v13, 0, v13
    v_cndmask_b32 v12, v13, v12, s[32:33]
    v_mov_b32 v15, 0x3b924925
    v_mov_b32 v16, 0x3b124925
    v_cmp_eq_u32 vcc, 0, v14
    s_nop 1
    v_cndmask_b32 v15, v15, v16, vcc
    v_mov_b32 v36, 224
    v_cmp_eq_u32 vcc, v36, v14
    s_nop 1
    v_cndmask_b32 v15, v15, v16, vcc
    v_cmp_lt_u32 vcc, v36, v14
    s_nop 1
    v_cndmask_b32 v15, v15, 0, vcc
    v_mul_f32 v24, v12, v15
    v_add_u32 v14, 5, v9
    v_mul_u32_u24 v10, v7, v14
    s_mov_b32 s30, 9586981
    v_mul_hi_u32 v12, v10, s30
    v_mul_u32_u24 v12, 448, v12
    v_sub_u32 v12, v10, v12
    v_cvt_f32_u32 v11, v12
    v_mul_f32 v11, 0x3b124925, v11
    v_cos_f32 v12, v11
    v_sin_f32 v13, v11
    s_nop 0
    v_sub_f32 v13, 0, v13
    v_cndmask_b32 v12, v13, v12, s[32:33]
    v_mov_b32 v15, 0x3b924925
    v_mov_b32 v16, 0x3b124925
    v_cmp_eq_u32 vcc, 0, v14
    s_nop 1
    v_cndmask_b32 v15, v15, v16, vcc
    v_mov_b32 v36, 224
    v_cmp_eq_u32 vcc, v36, v14
    s_nop 1
    v_cndmask_b32 v15, v15, v16, vcc
    v_cmp_lt_u32 vcc, v36, v14
    s_nop 1
    v_cndmask_b32 v15, v15, 0, vcc
    v_mul_f32 v25, v12, v15
    v_add_u32 v14, 6, v9
    v_mul_u32_u24 v10, v7, v14
    s_mov_b32 s30, 9586981
    v_mul_hi_u32 v12, v10, s30
    v_mul_u32_u24 v12, 448, v12
    v_sub_u32 v12, v10, v12
    v_cvt_f32_u32 v11, v12
    v_mul_f32 v11, 0x3b124925, v11
    v_cos_f32 v12, v11
    v_sin_f32 v13, v11
    s_nop 0
    v_sub_f32 v13, 0, v13
    v_cndmask_b32 v12, v13, v12, s[32:33]
    v_mov_b32 v15, 0x3b924925
    v_mov_b32 v16, 0x3b124925
    v_cmp_eq_u32 vcc, 0, v14
    s_nop 1
    v_cndmask_b32 v15, v15, v16, vcc
    v_mov_b32 v36, 224
    v_cmp_eq_u32 vcc, v36, v14
    s_nop 1
    v_cndmask_b32 v15, v15, v16, vcc
    v_cmp_lt_u32 vcc, v36, v14
    s_nop 1
    v_cndmask_b32 v15, v15, 0, vcc
    v_mul_f32 v26, v12, v15
    v_add_u32 v14, 7, v9
    v_mul_u32_u24 v10, v7, v14
    s_mov_b32 s30, 9586981
    v_mul_hi_u32 v12, v10, s30
    v_mul_u32_u24 v12, 448, v12
    v_sub_u32 v12, v10, v12
    v_cvt_f32_u32 v11, v12
    v_mul_f32 v11, 0x3b124925, v11
    v_cos_f32 v12, v11
    v_sin_f32 v13, v11
    s_nop 0
    v_sub_f32 v13, 0, v13
    v_cndmask_b32 v12, v13, v12, s[32:33]
    v_mov_b32 v15, 0x3b924925
    v_mov_b32 v16, 0x3b124925
    v_cmp_eq_u32 vcc, 0, v14
    s_nop 1
    v_cndmask_b32 v15, v15, v16, vcc
    v_mov_b32 v36, 224
    v_cmp_eq_u32 vcc, v36, v14
    s_nop 1
    v_cndmask_b32 v15, v15, v16, vcc
    v_cmp_lt_u32 vcc, v36, v14
    s_nop 1
    v_cndmask_b32 v15, v15, 0, vcc
    v_mul_f32 v27, v12, v15
    v_cvt_pk_bf16_f32 v30, v20, v21
    v_cvt_pk_bf16_f32 v31, v22, v23
    v_cvt_pk_bf16_f32 v32, v24, v25
    v_cvt_pk_bf16_f32 v33, v26, v27
    v_mov_b32 v36, 14400
    v_cmp_gt_u32 vcc, v36, v39
    v_lshlrev_b32 v2, 4, v39
    v_mov_b32 v37, 0x7fffffff
    v_cndmask_b32 v2, v37, v2, vcc
    s_mov_b32 s31, 26148864
    buffer_store_dwordx4 v[30:33], v2, s[56:59], s31 offen sc1
    s_add_u32 s29, s29, 24576
    s_cmp_lt_u32 s29, 14400
    s_cbranch_scc1 T_gd
    v_accvgpr_read_b32 v0, a255
    v_and_b32 v5, 15, v0
    v_bfe_u32 v6, v0, 4, 2
    v_lshrrev_b32 v7, 6, v0
    v_and_b32 v40, 63, v0
    v_lshlrev_b32 v40, 4, v40
    s_cmp_eq_u32 s52, 0
    s_cbranch_scc1 T_t2_c64
    s_cmp_eq_u32 s52, 1
    s_cbranch_scc1 T_t2_f32
    s_cmp_eq_u32 s52, 2
    s_cbranch_scc0 T_t2_end
    v_lshlrev_b32 v8, 4, v7
    v_lshl_add_u32 v8, v6, 2, v8
    v_add_u32 v8, 0, v8
    v_add_u32 v9, 0, v5
    v_mul_u32_u24 v10, v8, v9
    v_and_b32 v12, 2047, v10
    v_cvt_f32_u32 v11, v12
    v_mul_f32 v11, 0x3a000000, v11
    v_cos_f32 v20, v11
    v_sin_f32 v24, v11
    v_lshlrev_b32 v8, 4, v7
    v_lshl_add_u32 v8, v6, 2, v8
    v_add_u32 v8, 1, v8
    v_add_u32 v9, 0, v5
    v_mul_u32_u24 v10, v8, v9
    v_and_b32 v12, 2047, v10
    v_cvt_f32_u32 v11, v12
    v_mul_f32 v11, 0x3a000000, v11
    v_cos_f32 v21, v11
    v_sin_f32 v25, v11
    v_lshlrev_b32 v8, 4, v7
    v_lshl_add_u32 v8, v6, 2, v8
    v_add_u32 v8, 2, v8
    v_add_u32 v9, 0, v5
    v_mul_u32_u24 v10, v8, v9
    v_and_b32 v12, 2047, v10
    v_cvt_f32_u32 v11, v12
    v_mul_f32 v11, 0x3a000000, v11
    v_cos_f32 v22, v11
    v_sin_f32 v26, v11
    v_lshlrev_b32 v8, 4, v7
    v_lshl_add_u32 v8, v6, 2, v8
    v_add_u32 v8, 3, v8
    v_add_u32 v9, 0, v5
    v_mul_u32_u24 v10, v8, v9
    v_and_b32 v12, 2047, v10
    v_cvt_f32_u32 v11, v12
    v_mul_f32 v11, 0x3a000000, v11
    v_cos_f32 v23, v11
    v_sin_f32 v27, v11
    v_lshl_add_u32 v1, v7, 11, v40
    s_mov_b32 s31, 26423296
    buffer_store_dwordx4 v[20:23], v1, s[56:59], s31 offen sc1
    buffer_store_dwordx4 v[24:27], v1, s[56:59], s31 offen offset:1024 sc1
    s_nop 1
    v_lshlrev_b32 v8, 4, v7
    v_lshl_add_u32 v8, v6, 2, v8
    v_add_u32 v8, 0, v8
    v_add_u32 v9, 16, v5
    v_mul_u32_u24 v10, v8, v9
    v_and_b32 v12, 2047, v10
    v_cvt_f32_u32 v11, v12
    v_mul_f32 v11, 0x3a000000, v11
    v_cos_f32 v20, v11
    v_sin_f32 v24, v11
    v_lshlrev_b32 v8, 4, v7
    v_lshl_add_u32 v8, v6, 2, v8
    v_add_u32 v8, 1, v8
    v_add_u32 v9, 16, v5
    v_mul_u32_u24 v10, v8, v9
    v_and_b32 v12, 2047, v10
    v_cvt_f32_u32 v11, v12
    v_mul_f32 v11, 0x3a000000, v11
    v_cos_f32 v21, v11
    v_sin_f32 v25, v11
    v_lshlrev_b32 v8, 4, v7
    v_lshl_add_u32 v8, v6, 2, v8
    v_add_u32 v8, 2, v8
    v_add_u32 v9, 16, v5
    v_mul_u32_u24 v10, v8, v9
    v_and_b32 v12, 2047, v10
    v_cvt_f32_u32 v11, v12
    v_mul_f32 v11, 0x3a000000, v11
    v_cos_f32 v22, v11
    v_sin_f32 v26, v11
    v_lshlrev_b32 v8, 4, v7
    v_lshl_add_u32 v8, v6, 2, v8
    v_add_u32 v8, 3, v8
    v_add_u32 v9, 16, v5
    v_mul_u32_u24 v10, v8, v9
    v_and_b32 v12, 2047, v10
    v_cvt_f32_u32 v11, v12
    v_mul_f32 v11, 0x3a000000, v11
    v_cos_f32 v23, v11
    v_sin_f32 v27, v11
    v_lshl_add_u32 v1, v7, 11, v40
    s_mov_b32 s31, 26431488
    buffer_store_dwordx4 v[20:23], v1, s[56:59], s31 offen sc1
    buffer_store_dwordx4 v[24:27], v1, s[56:59], s31 offen offset:1024 sc1
    s_nop 1
    s_branch T_t2_end
T_t2_c64:
    v_lshlrev_b32 v8, 2, v6
    v_add_u32 v8, 0, v8
    v_lshl_add_u32 v9, v7, 4, v5
    v_mul_u32_u24 v10, v8, v9
    v_and_b32 v12, 63, v10
    v_cvt_f32_u32 v11, v12
    v_mul_f32 v11, 0x3c800000, v11
    v_cos_f32 v20, v11
    v_sin_f32 v28, v11
    v_lshlrev_b32 v8, 2, v6
    v_add_u32 v8, 1, v8
    v_lshl_add_u32 v9, v7, 4, v5
    v_mul_u32_u24 v10, v8, v9
    v_and_b32 v12, 63, v10
    v_cvt_f32_u32 v11, v12
    v_mul_f32 v11, 0x3c800000, v11
    v_cos_f32 v21, v11
    v_sin_f32 v29, v11
    v_lshlrev_b32 v8, 2, v6
    v_add_u32 v8, 2, v8
    v_lshl_add_u32 v9, v7, 4, v5
    v_mul_u32_u24 v10, v8, v9
    v_and_b32 v12, 63, v10
    v_cvt_f32_u32 v11, v12
    v_mul_f32 v11, 0x3c800000, v11
    v_cos_f32 v22, v11
    v_sin_f32 v30, v11
    v_lshlrev_b32 v8, 2, v6
    v_add_u32 v8, 3, v8
    v_lshl_add_u32 v9, v7, 4, v5
    v_mul_u32_u24 v10, v8, v9
    v_and_b32 v12, 63, v10
    v_cvt_f32_u32 v11, v12
    v_mul_f32 v11, 0x3c800000, v11
    v_cos_f32 v23, v11
    v_sin_f32 v31, v11
    v_lshlrev_b32 v8, 2, v6
    v_add_u32 v8, 16, v8
    v_lshl_add_u32 v9, v7, 4, v5
    v_mul_u32_u24 v10, v8, v9
    v_and_b32 v12, 63, v10
    v_cvt_f32_u32 v11, v12
    v_mul_f32 v11, 0x3c800000, v11
    v_cos_f32 v24, v11
    v_sin_f32 v32, v11
    v_lshlrev_b32 v8, 2, v6
    v_add_u32 v8, 17, v8
    v_lshl_add_u32 v9, v7, 4, v5
    v_mul_u32_u24 v10, v8, v9
    v_and_b32 v12, 63, v10
    v_cvt_f32_u32 v11, v12
    v_mul_f32 v11, 0x3c800000, v11
    v_cos_f32 v25, v11
    v_sin_f32 v33, v11
    v_lshlrev_b32 v8, 2, v6
    v_add_u32 v8, 18, v8
    v_lshl_add_u32 v9, v7, 4, v5
    v_mul_u32_u24 v10, v8, v9
    v_and_b32 v12, 63, v10
    v_cvt_f32_u32 v11, v12
    v_mul_f32 v11, 0x3c800000, v11
    v_cos_f32 v26, v11
    v_sin_f32 v34, v11
    v_lshlrev_b32 v8, 2, v6
    v_add_u32 v8, 19, v8
    v_lshl_add_u32 v9, v7, 4, v5
    v_mul_u32_u24 v10, v8, v9
    v_and_b32 v12, 63, v10
    v_cvt_f32_u32 v11, v12
    v_mul_f32 v11, 0x3c800000, v11
    v_cos_f32 v27, v11
    v_sin_f32 v35, v11
    v_cvt_pk_bf16_f32 v44, v20, v21
    v_cvt_pk_bf16_f32 v48, v28, v29
    v_cvt_pk_bf16_f32 v45, v22, v23
    v_cvt_pk_bf16_f32 v49, v30, v31
    v_cvt_pk_bf16_f32 v46, v24, v25
    v_cvt_pk_bf16_f32 v50, v32, v33
    v_cvt_pk_bf16_f32 v47, v26, v27
    v_cvt_pk_bf16_f32 v51, v34, v35
    v_lshl_add_u32 v1, v7, 11, v40
    s_mov_b32 s31, 26394624
    buffer_store_dwordx4 v[44:47], v1, s[56:59], s31 offen sc1
    s_mov_b32 s31, 26402816
    buffer_store_dwordx4 v[48:51], v1, s[56:59], s31 offen sc1
    s_nop 1
    v_lshlrev_b32 v8, 2, v6
    v_add_u32 v8, 32, v8
    v_lshl_add_u32 v9, v7, 4, v5
    v_mul_u32_u24 v10, v8, v9
    v_and_b32 v12, 63, v10
    v_cvt_f32_u32 v11, v12
    v_mul_f32 v11, 0x3c800000, v11
    v_cos_f32 v20, v11
    v_sin_f32 v28, v11
    v_lshlrev_b32 v8, 2, v6
    v_add_u32 v8, 33, v8
    v_lshl_add_u32 v9, v7, 4, v5
    v_mul_u32_u24 v10, v8, v9
    v_and_b32 v12, 63, v10
    v_cvt_f32_u32 v11, v12
    v_mul_f32 v11, 0x3c800000, v11
    v_cos_f32 v21, v11
    v_sin_f32 v29, v11
    v_lshlrev_b32 v8, 2, v6
    v_add_u32 v8, 34, v8
    v_lshl_add_u32 v9, v7, 4, v5
    v_mul_u32_u24 v10, v8, v9
    v_and_b32 v12, 63, v10
    v_cvt_f32_u32 v11, v12
    v_mul_f32 v11, 0x3c800000, v11
    v_cos_f32 v22, v11
    v_sin_f32 v30, v11
    v_lshlrev_b32 v8, 2, v6
    v_add_u32 v8, 35, v8
    v_lshl_add_u32 v9, v7, 4, v5
    v_mul_u32_u24 v10, v8, v9
    v_and_b32 v12, 63, v10
    v_cvt_f32_u32 v11, v12
    v_mul_f32 v11, 0x3c800000, v11
    v_cos_f32 v23, v11
    v_sin_f32 v31, v11
    v_lshlrev_b32 v8, 2, v6
    v_add_u32 v8, 48, v8
    v_lshl_add_u32 v9, v7, 4, v5
    v_mul_u32_u24 v10, v8, v9
    v_and_b32 v12, 63, v10
    v_cvt_f32_u32 v11, v12
    v_mul_f32 v11, 0x3c800000, v11
    v_cos_f32 v24, v11
    v_sin_f32 v32, v11
    v_lshlrev_b32 v8, 2, v6
    v_add_u32 v8, 49, v8
    v_lshl_add_u32 v9, v7, 4, v5
    v_mul_u32_u24 v10, v8, v9
    v_and_b32 v12, 63, v10
    v_cvt_f32_u32 v11, v12
    v_mul_f32 v11, 0x3c800000, v11
    v_cos_f32 v25, v11
    v_sin_f32 v33, v11
    v_lshlrev_b32 v8, 2, v6
    v_add_u32 v8, 50, v8
    v_lshl_add_u32 v9, v7, 4, v5
    v_mul_u32_u24 v10, v8, v9
    v_and_b32 v12, 63, v10
    v_cvt_f32_u32 v11, v12
    v_mul_f32 v11, 0x3c800000, v11
    v_cos_f32 v26, v11
    v_sin_f32 v34, v11
    v_lshlrev_b32 v8, 2, v6
    v_add_u32 v8, 51, v8
    v_lshl_add_u32 v9, v7, 4, v5
    v_mul_u32_u24 v10, v8, v9
    v_and_b32 v12, 63, v10
    v_cvt_f32_u32 v11, v12
    v_mul_f32 v11, 0x3c800000, v11
    v_cos_f32 v27, v11
    v_sin_f32 v35, v11
    v_cvt_pk_bf16_f32 v44, v20, v21
    v_cvt_pk_bf16_f32 v48, v28, v29
    v_cvt_pk_bf16_f32 v45, v22, v23
    v_cvt_pk_bf16_f32 v49, v30, v31
    v_cvt_pk_bf16_f32 v46, v24, v25
    v_cvt_pk_bf16_f32 v50, v32, v33
    v_cvt_pk_bf16_f32 v47, v26, v27
    v_cvt_pk_bf16_f32 v51, v34, v35
    v_lshl_add_u32 v1, v7, 11, v40
    s_mov_b32 s31, 26395648
    buffer_store_dwordx4 v[44:47], v1, s[56:59], s31 offen sc1
    s_mov_b32 s31, 26403840
    buffer_store_dwordx4 v[48:51], v1, s[56:59], s31 offen sc1
    s_nop 1
    s_branch T_t2_end
T_t2_f32:
    v_and_b32 v13, 1, v7
    v_lshl_add_u32 v14, v13, 4, v5
    v_lshlrev_b32 v8, 3, v6
    v_add_u32 v8, 0, v8
    v_mul_u32_u24 v10, v8, v14
    v_and_b32 v12, 31, v10
    v_cvt_f32_u32 v11, v12
    v_mul_f32 v11, 0x3d000000, v11
    v_cos_f32 v20, v11
    v_sin_f32 v28, v11
    v_lshlrev_b32 v8, 3, v6
    v_add_u32 v8, 1, v8
    v_mul_u32_u24 v10, v8, v14
    v_and_b32 v12, 31, v10
    v_cvt_f32_u32 v11, v12
    v_mul_f32 v11, 0x3d000000, v11
    v_cos_f32 v21, v11
    v_sin_f32 v29, v11
    v_lshlrev_b32 v8, 3, v6
    v_add_u32 v8, 2, v8
    v_mul_u32_u24 v10, v8, v14
    v_and_b32 v12, 31, v10
    v_cvt_f32_u32 v11, v12
    v_mul_f32 v11, 0x3d000000, v11
    v_cos_f32 v22, v11
    v_sin_f32 v30, v11
    v_lshlrev_b32 v8, 3, v6
    v_add_u32 v8, 3, v8
    v_mul_u32_u24 v10, v8, v14
    v_and_b32 v12, 31, v10
    v_cvt_f32_u32 v11, v12
    v_mul_f32 v11, 0x3d000000, v11
    v_cos_f32 v23, v11
    v_sin_f32 v31, v11
    v_lshlrev_b32 v8, 3, v6
    v_add_u32 v8, 4, v8
    v_mul_u32_u24 v10, v8, v14
    v_and_b32 v12, 31, v10
    v_cvt_f32_u32 v11, v12
    v_mul_f32 v11, 0x3d000000, v11
    v_cos_f32 v24, v11
    v_sin_f32 v32, v11
    v_lshlrev_b32 v8, 3, v6
    v_add_u32 v8, 5, v8
    v_mul_u32_u24 v10, v8, v14
    v_and_b32 v12, 31, v10
    v_cvt_f32_u32 v11, v12
    v_mul_f32 v11, 0x3d000000, v11
    v_cos_f32 v25, v11
    v_sin_f32 v33, v11
    v_lshlrev_b32 v8, 3, v6
    v_add_u32 v8, 6, v8
    v_mul_u32_u24 v10, v8, v14
    v_and_b32 v12, 31, v10
    v_cvt_f32_u32 v11, v12
    v_mul_f32 v11, 0x3d000000, v11
    v_cos_f32 v26, v11
    v_sin_f32 v34, v11
    v_lshlrev_b32 v8, 3, v6
    v_add_u32 v8, 7, v8
    v_mul_u32_u24 v10, v8, v14
    v_and_b32 v12, 31, v10
    v_cvt_f32_u32 v11, v12
    v_mul_f32 v11, 0x3d000000, v11
    v_cos_f32 v27, v11
    v_sin_f32 v35, v11
    v_mov_b32 v17, 1.0
    v_mov_b32 v18, 0x3a000000
    v_cmp_gt_u32 vcc, 2, v7
    s_nop 1
    v_cndmask_b32 v17, v18, v17, vcc
    v_mul_f32 v20, v20, v17
    v_mul_f32 v28, v28, v17
    v_mul_f32 v21, v21, v17
    v_mul_f32 v29, v29, v17
    v_mul_f32 v22, v22, v17
    v_mul_f32 v30, v30, v17
    v_mul_f32 v23, v23, v17
    v_mul_f32 v31, v31, v17
    v_mul_f32 v24, v24, v17
    v_mul_f32 v32, v32, v17
    v_mul_f32 v25, v25, v17
    v_mul_f32 v33, v33, v17
    v_mul_f32 v26, v26, v17
    v_mul_f32 v34, v34, v17
    v_mul_f32 v27, v27, v17
    v_mul_f32 v35, v35, v17
    v_cvt_pk_bf16_f32 v44, v20, v21
    v_cvt_pk_bf16_f32 v48, v28, v29
    v_xor_b32 v52, 0x80008000, v48
    v_cvt_pk_bf16_f32 v45, v22, v23
    v_cvt_pk_bf16_f32 v49, v30, v31
    v_xor_b32 v53, 0x80008000, v49
    v_cvt_pk_bf16_f32 v46, v24, v25
    v_cvt_pk_bf16_f32 v50, v32, v33
    v_xor_b32 v54, 0x80008000, v50
    v_cvt_pk_bf16_f32 v47, v26, v27
    v_cvt_pk_bf16_f32 v51, v34, v35
    v_xor_b32 v55, 0x80008000, v51
    v_mul_u32_u24 v1, 3072, v7
    v_add_u32 v1, v1, v40
    s_mov_b32 s31, 26411008
    buffer_store_dwordx4 v[44:47], v1, s[56:59], s31 offen sc1
    buffer_store_dwordx4 v[48:51], v1, s[56:59], s31 offen offset:1024 sc1
    buffer_store_dwordx4 v[52:55], v1, s[56:59], s31 offen offset:2048 sc1
T_t2_end:
    v_accvgpr_read_b32 v0, a255
    s_lshl_b32 s3, s52, 8
    v_add_u32 v1, s3, v0
    v_lshlrev_b32 v38, 4, v1
    v_mov_b32 v4, -1
    v_mov_b32 v5, -1
    v_mov_b32 v6, -1
    v_mov_b32 v7, -1
    v_mov_b32 v8, 0
    v_mov_b32 v9, 0
    v_mov_b32 v10, 0
    v_mov_b32 v11, 0
    v_add_u32 v2, 0, v38
    v_mov_b32 v36, 126976
    v_cmp_gt_u32 vcc, v36, v2
    v_mov_b32 v37, 0x7fffffff
    s_nop 0
    v_cndmask_b32 v2, v37, v2, vcc
    s_mov_b32 s31, 103260160
    buffer_store_dwordx4 v[8:11], v2, s[56:59], s31 offen sc1
    v_add_u32 v2, 0, v38
    v_mov_b32 v36, 126976
    v_cmp_gt_u32 vcc, v36, v2
    v_mov_b32 v37, 0x7fffffff
    s_nop 0
    v_cndmask_b32 v2, v37, v2, vcc
    s_mov_b32 s31, 104308736
    buffer_store_dwordx4 v[8:11], v2, s[56:59], s31 offen sc1
    v_add_u32 v2, 0, v38
    v_mov_b32 v36, 126976
    v_cmp_gt_u32 vcc, v36, v2
    v_mov_b32 v37, 0x7fffffff
    s_nop 0
    v_cndmask_b32 v2, v37, v2, vcc
    s_mov_b32 s31, 182951936
    buffer_store_dwordx4 v[8:11], v2, s[56:59], s31 offen sc1
    v_add_u32 v2, 0, v38
    v_mov_b32 v36, 126976
    v_cmp_gt_u32 vcc, v36, v2
    v_mov_b32 v37, 0x7fffffff
    s_nop 0
    v_cndmask_b32 v2, v37, v2, vcc
    s_mov_b32 s31, 184000512
    buffer_store_dwordx4 v[8:11], v2, s[56:59], s31 offen sc1
K_tabd:
    s_waitcnt vmcnt(0)
    s_cmp_eq_u32 s76, 0
    s_cbranch_scc0 K_init0_ok
    s_mov_b32 s54, 1048576
K_init0:
    buffer_load_dword v2, off, s[8:11], 0 offset:64 sc1
    s_mov_b32 s90, 27
    s_sub_u32 s54, s54, 1
    s_cmp_eq_u32 s54, 0
    s_cbranch_scc1 L_abort1
    s_waitcnt vmcnt(0)
    v_readfirstlane_b32 s53, v2
    s_nop 0
    s_cmp_ge_u32 s53, 32
    s_cbranch_scc1 K_init0_ok
    s_sleep 2
    s_branch K_init0
K_init0_ok:
    s_barrier
    s_waitcnt vmcnt(0)
    s_barrier
    s_cmp_eq_u32 s76, 0
    s_cbranch_scc0 K_ft1
    s_lshl_b32 s53, s64, 4
    s_add_u32 s53, s53, 78643200
    s_mov_b64 exec, 1
    v_mov_b32 v2, 1
    buffer_store_dword v2, off, s[4:7], s53 sc1
    s_mov_b64 exec, -1
K_ft1:
    s_cmp_eq_u32 s76, 0
    s_cbranch_scc0 K_wt1_ok
    v_mbcnt_lo_u32_b32 v2, -1, 0
    v_mbcnt_hi_u32_b32 v2, -1, v2
    v_add_u32 v3, 0, v2
    v_min_u32 v3, 127, v3
    v_lshlrev_b32 v3, 4, v3
    v_add_u32 v4, 64, v2
    v_min_u32 v4, 127, v4
    v_lshlrev_b32 v4, 4, v4
    s_mov_b32 s53, 78643200
    s_mov_b32 s54, 1048576
K_wt1:
    buffer_load_dword v5, v3, s[4:7], s53 offen sc1
    buffer_load_dword v6, v4, s[4:7], s53 offen sc1
    s_mov_b32 s90, 28
    s_sub_u32 s54, s54, 1
    s_cmp_eq_u32 s54, 0
    s_cbranch_scc1 L_abort1
    s_waitcnt vmcnt(0)
    v_and_b32 v5, v5, v6
    v_cmp_ne_u32 vcc, 1, v5
    s_cbranch_vccz K_wt1_ok
    s_sleep 2
    s_branch K_wt1
K_wt1_ok:
    s_barrier
K_layer:
    s_mul_i32 s53, s65, 79691776
    s_add_u32 s53, s53, 30408704
    s_add_u32 s4, s68, s53
    s_addc_u32 s5, s69, 0
    s_and_b32 s5, s5, 0xffff
    s_mov_b32 s6, 79691776
    s_mov_b32 s7, 0x20000
    s_cmp_eq_u32 s65, 0
    s_cbranch_scc0 K_l1
    s_mov_b32 s8, s74
    s_and_b32 s9, s75, 0xffff
    s_mov_b32 s10, 1835008
    s_mov_b32 s11, 0x20000
    s_add_u32 s60, s68, 28311552
    s_addc_u32 s61, s69, 0
    s_and_b32 s61, s61, 0xffff
    s_mov_b32 s62, 1835008
    s_mov_b32 s63, 0x20000
    s_branch K_l2
K_l1:
    s_add_u32 s8, s68, 28311552
    s_addc_u32 s9, s69, 0
    s_and_b32 s9, s9, 0xffff
    s_mov_b32 s10, 1835008
    s_mov_b32 s11, 0x20000
    s_mov_b32 s60, s72
    s_and_b32 s61, s73, 0xffff
    s_mov_b32 s62, 1835008
    s_mov_b32 s63, 0x20000
K_l2:
    s_cmp_eq_u32 s65, 0
    s_cbranch_scc0 K_f1skip
    s_cmp_lt_u32 s64, 128
    s_cbranch_scc0 K_f1skip
    s_mov_b32 s55, s64
    s_mov_b32 s77, 0
K_f1:
    v_accvgpr_read_b32 v0, a255
    s_mov_b32 s14, s76
    v_and_b32 v0, 63, v0
    s_cmp_eq_u32 s77, 1
    s_cbranch_scc1 F1_uq
    s_lshr_b32 s12, s55, 1
    s_and_b32 s13, s55, 1
    s_lshl_b32 s20, s13, 4
    s_branch F1_ud
F1_uq:
    s_lshr_b32 s12, s55, 2
    s_and_b32 s13, s55, 3
    s_lshl_b32 s20, s13, 3
F1_ud:
    s_add_u32 s20, s20, s14
    v_lshlrev_b32 v2, 4, v0
    v_lshrrev_b32 v3, 3, v0
    s_lshl_b32 s17, s14, 3
    v_add_u32 v3, s17, v3
    s_lshl_b32 s17, s12, 5
    v_add_u32 v4, s17, v3
    v_mul_u32_u24 v4, 896, v4
    v_and_b32 v5, 7, v0
    v_lshl_add_u32 v4, v5, 4, v4
    v_mul_u32_u24 v96, 912, v3
    v_lshl_add_u32 v96, v5, 4, v96
    s_add_u32 s16, s20, 0
    s_mul_i32 s16, s16, 14336
    s_add_u32 s16, s16, 25690112
    buffer_load_dwordx4 v[128:131], v2, s[56:59], s16 offen offset:0 sc1
    buffer_load_dwordx4 v[132:135], v2, s[56:59], s16 offen offset:1024 sc1
    buffer_load_dwordx4 v[136:139], v2, s[56:59], s16 offen offset:2048 sc1
    buffer_load_dwordx4 v[140:143], v2, s[56:59], s16 offen offset:3072 sc1
    s_add_u32 s16, s16, 4096
    buffer_load_dwordx4 v[144:147], v2, s[56:59], s16 offen offset:0 sc1
    buffer_load_dwordx4 v[148:151], v2, s[56:59], s16 offen offset:1024 sc1
    buffer_load_dwordx4 v[152:155], v2, s[56:59], s16 offen offset:2048 sc1
    buffer_load_dwordx4 v[156:159], v2, s[56:59], s16 offen offset:3072 sc1
    s_add_u32 s16, s16, 4096
    buffer_load_dwordx4 v[160:163], v2, s[56:59], s16 offen offset:0 sc1
    buffer_load_dwordx4 v[164:167], v2, s[56:59], s16 offen offset:1024 sc1
    buffer_load_dwordx4 v[168:171], v2, s[56:59], s16 offen offset:2048 sc1
    buffer_load_dwordx4 v[172:175], v2, s[56:59], s16 offen offset:3072 sc1
    s_add_u32 s16, s16, 4096
    buffer_load_dwordx4 v[176:179], v2, s[56:59], s16 offen offset:0 sc1
    buffer_load_dwordx4 v[180:183], v2, s[56:59], s16 offen offset:1024 sc1
    s_add_u32 s16, s20, 4
    s_mul_i32 s16, s16, 14336
    s_add_u32 s16, s16, 25690112
    buffer_load_dwordx4 v[184:187], v2, s[56:59], s16 offen offset:0 sc1
    buffer_load_dwordx4 v[188:191], v2, s[56:59], s16 offen offset:1024 sc1
    buffer_load_dwordx4 v[192:195], v2, s[56:59], s16 offen offset:2048 sc1
    buffer_load_dwordx4 v[196:199], v2, s[56:59], s16 offen offset:3072 sc1
    s_add_u32 s16, s16, 4096
    buffer_load_dwordx4 v[200:203], v2, s[56:59], s16 offen offset:0 sc1
    buffer_load_dwordx4 v[204:207], v2, s[56:59], s16 offen offset:1024 sc1
    buffer_load_dwordx4 v[208:211], v2, s[56:59], s16 offen offset:2048 sc1
    buffer_load_dwordx4 v[212:215], v2, s[56:59], s16 offen offset:3072 sc1
    s_add_u32 s16, s16, 4096
    buffer_load_dwordx4 v[216:219], v2, s[56:59], s16 offen offset:0 sc1
    buffer_load_dwordx4 v[220:223], v2, s[56:59], s16 offen offset:1024 sc1
    buffer_load_dwordx4 v[224:227], v2, s[56:59], s16 offen offset:2048 sc1
    buffer_load_dwordx4 v[228:231], v2, s[56:59], s16 offen offset:3072 sc1
    s_add_u32 s16, s16, 4096
    buffer_load_dwordx4 v[232:235], v2, s[56:59], s16 offen offset:0 sc1
    buffer_load_dwordx4 v[236:239], v2, s[56:59], s16 offen offset:1024 sc1
    s_cmp_eq_u32 s77, 1
    s_cbranch_scc0 K_f1nw
    s_cmp_eq_u32 s76, 0
    s_cbranch_scc0 K_f1w_ok
    v_mbcnt_lo_u32_b32 v100, -1, 0
    v_mbcnt_hi_u32_b32 v100, -1, v100
    v_min_u32 v100, 6, v100
    v_lshlrev_b32 v100, 4, v100
    s_lshl_b32 s53, s12, 7
    s_add_u32 s53, s53, 109064192
    s_mov_b32 s54, 1048576
K_f1w:
    buffer_load_dword v101, v100, s[56:59], s53 offen sc1
    s_mov_b32 s90, 29
    s_sub_u32 s54, s54, 1
    s_cmp_eq_u32 s54, 0
    s_cbranch_scc1 L_abort1
    s_waitcnt vmcnt(0)
    v_cmp_ne_u32 vcc, 1, v101
    s_cbranch_vccz K_f1w_ok
    s_cmp_ge_u32 s12, 56
    s_cbranch_scc1 K_f1w
    s_sleep 16
    s_branch K_f1w
K_f1w_ok:
    s_barrier
K_f1nw:
    buffer_load_dwordx4 v[64:67], v4, s[8:11], 0 offen offset:0 sc1
    buffer_load_dwordx4 v[68:71], v4, s[8:11], 0 offen offset:128 sc1
    buffer_load_dwordx4 v[72:75], v4, s[8:11], 0 offen offset:256 sc1
    buffer_load_dwordx4 v[76:79], v4, s[8:11], 0 offen offset:384 sc1
    buffer_load_dwordx4 v[80:83], v4, s[8:11], 0 offen offset:512 sc1
    buffer_load_dwordx4 v[84:87], v4, s[8:11], 0 offen offset:640 sc1
    buffer_load_dwordx4 v[88:91], v4, s[8:11], 0 offen offset:768 sc1
    s_waitcnt vmcnt(0)
    v_lshlrev_b32 v4, 16, v64
    v_and_b32 v5, 0xffff0000, v64
    v_lshlrev_b32 v6, 16, v65
    v_and_b32 v7, 0xffff0000, v65
    v_lshlrev_b32 v8, 16, v66
    v_and_b32 v9, 0xffff0000, v66
    v_lshlrev_b32 v10, 16, v67
    v_and_b32 v11, 0xffff0000, v67
    v_lshlrev_b32 v12, 16, v68
    v_and_b32 v13, 0xffff0000, v68
    v_lshlrev_b32 v14, 16, v69
    v_and_b32 v15, 0xffff0000, v69
    v_lshlrev_b32 v16, 16, v70
    v_and_b32 v17, 0xffff0000, v70
    v_lshlrev_b32 v18, 16, v71
    v_and_b32 v19, 0xffff0000, v71
    v_lshlrev_b32 v20, 16, v72
    v_and_b32 v21, 0xffff0000, v72
    v_lshlrev_b32 v22, 16, v73
    v_and_b32 v23, 0xffff0000, v73
    v_lshlrev_b32 v24, 16, v74
    v_and_b32 v25, 0xffff0000, v74
    v_lshlrev_b32 v26, 16, v75
    v_and_b32 v27, 0xffff0000, v75
    v_lshlrev_b32 v28, 16, v76
    v_and_b32 v29, 0xffff0000, v76
    v_lshlrev_b32 v30, 16, v77
    v_and_b32 v31, 0xffff0000, v77
    v_lshlrev_b32 v32, 16, v78
    v_and_b32 v33, 0xffff0000, v78
    v_lshlrev_b32 v34, 16, v79
    v_and_b32 v35, 0xffff0000, v79
    v_lshlrev_b32 v36, 16, v80
    v_and_b32 v37, 0xffff0000, v80
    v_lshlrev_b32 v38, 16, v81
    v_and_b32 v39, 0xffff0000, v81
    v_lshlrev_b32 v40, 16, v82
    v_and_b32 v41, 0xffff0000, v82
    v_lshlrev_b32 v42, 16, v83
    v_and_b32 v43, 0xffff0000, v83
    v_lshlrev_b32 v44, 16, v84
    v_and_b32 v45, 0xffff0000, v84
    v_lshlrev_b32 v46, 16, v85
    v_and_b32 v47, 0xffff0000, v85
    v_lshlrev_b32 v48, 16, v86
    v_and_b32 v49, 0xffff0000, v86
    v_lshlrev_b32 v50, 16, v87
    v_and_b32 v51, 0xffff0000, v87
    v_lshlrev_b32 v52, 16, v88
    v_and_b32 v53, 0xffff0000, v88
    v_lshlrev_b32 v54, 16, v89
    v_and_b32 v55, 0xffff0000, v89
    v_lshlrev_b32 v56, 16, v90
    v_and_b32 v57, 0xffff0000, v90
    v_lshlrev_b32 v58, 16, v91
    v_and_b32 v59, 0xffff0000, v91
    v_add_f32 v60, v4, v5
    v_add_f32 v61, v6, v7
    v_add_f32 v60, v60, v8
    v_add_f32 v61, v61, v9
    v_add_f32 v60, v60, v10
    v_add_f32 v61, v61, v11
    v_add_f32 v60, v60, v12
    v_add_f32 v61, v61, v13
    v_add_f32 v60, v60, v14
    v_add_f32 v61, v61, v15
    v_add_f32 v60, v60, v16
    v_add_f32 v61, v61, v17
    v_add_f32 v60, v60, v18
    v_add_f32 v61, v61, v19
    v_add_f32 v60, v60, v20
    v_add_f32 v61, v61, v21
    v_add_f32 v60, v60, v22
    v_add_f32 v61, v61, v23
    v_add_f32 v60, v60, v24
    v_add_f32 v61, v61, v25
    v_add_f32 v60, v60, v26
    v_add_f32 v61, v61, v27
    v_add_f32 v60, v60, v28
    v_add_f32 v61, v61, v29
    v_add_f32 v60, v60, v30
    v_add_f32 v61, v61, v31
    v_add_f32 v60, v60, v32
    v_add_f32 v61, v61, v33
    v_add_f32 v60, v60, v34
    v_add_f32 v61, v61, v35
    v_add_f32 v60, v60, v36
    v_add_f32 v61, v61, v37
    v_add_f32 v60, v60, v38
    v_add_f32 v61, v61, v39
    v_add_f32 v60, v60, v40
    v_add_f32 v61, v61, v41
    v_add_f32 v60, v60, v42
    v_add_f32 v61, v61, v43
    v_add_f32 v60, v60, v44
    v_add_f32 v61, v61, v45
    v_add_f32 v60, v60, v46
    v_add_f32 v61, v61, v47
    v_add_f32 v60, v60, v48
    v_add_f32 v61, v61, v49
    v_add_f32 v60, v60, v50
    v_add_f32 v61, v61, v51
    v_add_f32 v60, v60, v52
    v_add_f32 v61, v61, v53
    v_add_f32 v60, v60, v54
    v_add_f32 v61, v61, v55
    v_add_f32 v60, v60, v56
    v_add_f32 v61, v61, v57
    v_add_f32 v60, v60, v58
    v_add_f32 v61, v61, v59
    v_add_f32 v60, v60, v61
    s_nop 1
    v_add_f32_dpp v60, v60, v60 quad_perm:[1,0,3,2] row_mask:0xf bank_mask:0xf
    s_nop 1
    v_add_f32_dpp v60, v60, v60 quad_perm:[2,3,0,1] row_mask:0xf bank_mask:0xf
    s_nop 1
    v_add_f32_dpp v60, v60, v60 row_half_mirror row_mask:0xf bank_mask:0xf
    v_mul_f32 v60, 0x3b124925, v60
    v_sub_f32 v92, v4, v60
    v_mul_f32 v61, v92, v92
    v_sub_f32 v93, v5, v60
    v_mul_f32 v62, v93, v93
    v_sub_f32 v92, v6, v60
    v_sub_f32 v93, v7, v60
    v_fmac_f32 v61, v92, v92
    v_fmac_f32 v62, v93, v93
    v_sub_f32 v92, v8, v60
    v_sub_f32 v93, v9, v60
    v_fmac_f32 v61, v92, v92
    v_fmac_f32 v62, v93, v93
    v_sub_f32 v92, v10, v60
    v_sub_f32 v93, v11, v60
    v_fmac_f32 v61, v92, v92
    v_fmac_f32 v62, v93, v93
    v_sub_f32 v92, v12, v60
    v_sub_f32 v93, v13, v60
    v_fmac_f32 v61, v92, v92
    v_fmac_f32 v62, v93, v93
    v_sub_f32 v92, v14, v60
    v_sub_f32 v93, v15, v60
    v_fmac_f32 v61, v92, v92
    v_fmac_f32 v62, v93, v93
    v_sub_f32 v92, v16, v60
    v_sub_f32 v93, v17, v60
    v_fmac_f32 v61, v92, v92
    v_fmac_f32 v62, v93, v93
    v_sub_f32 v92, v18, v60
    v_sub_f32 v93, v19, v60
    v_fmac_f32 v61, v92, v92
    v_fmac_f32 v62, v93, v93
    v_sub_f32 v92, v20, v60
    v_sub_f32 v93, v21, v60
    v_fmac_f32 v61, v92, v92
    v_fmac_f32 v62, v93, v93
    v_sub_f32 v92, v22, v60
    v_sub_f32 v93, v23, v60
    v_fmac_f32 v61, v92, v92
    v_fmac_f32 v62, v93, v93
    v_sub_f32 v92, v24, v60
    v_sub_f32 v93, v25, v60
    v_fmac_f32 v61, v92, v92
    v_fmac_f32 v62, v93, v93
    v_sub_f32 v92, v26, v60
    v_sub_f32 v93, v27, v60
    v_fmac_f32 v61, v92, v92
    v_fmac_f32 v62, v93, v93
    v_sub_f32 v92, v28, v60
    v_sub_f32 v93, v29, v60
    v_fmac_f32 v61, v92, v92
    v_fmac_f32 v62, v93, v93
    v_sub_f32 v92, v30, v60
    v_sub_f32 v93, v31, v60
    v_fmac_f32 v61, v92, v92
    v_fmac_f32 v62, v93, v93
    v_sub_f32 v92, v32, v60
    v_sub_f32 v93, v33, v60
    v_fmac_f32 v61, v92, v92
    v_fmac_f32 v62, v93, v93
    v_sub_f32 v92, v34, v60
    v_sub_f32 v93, v35, v60
    v_fmac_f32 v61, v92, v92
    v_fmac_f32 v62, v93, v93
    v_sub_f32 v92, v36, v60
    v_sub_f32 v93, v37, v60
    v_fmac_f32 v61, v92, v92
    v_fmac_f32 v62, v93, v93
    v_sub_f32 v92, v38, v60
    v_sub_f32 v93, v39, v60
    v_fmac_f32 v61, v92, v92
    v_fmac_f32 v62, v93, v93
    v_sub_f32 v92, v40, v60
    v_sub_f32 v93, v41, v60
    v_fmac_f32 v61, v92, v92
    v_fmac_f32 v62, v93, v93
    v_sub_f32 v92, v42, v60
    v_sub_f32 v93, v43, v60
    v_fmac_f32 v61, v92, v92
    v_fmac_f32 v62, v93, v93
    v_sub_f32 v92, v44, v60
    v_sub_f32 v93, v45, v60
    v_fmac_f32 v61, v92, v92
    v_fmac_f32 v62, v93, v93
    v_sub_f32 v92, v46, v60
    v_sub_f32 v93, v47, v60
    v_fmac_f32 v61, v92, v92
    v_fmac_f32 v62, v93, v93
    v_sub_f32 v92, v48, v60
    v_sub_f32 v93, v49, v60
    v_fmac_f32 v61, v92, v92
    v_fmac_f32 v62, v93, v93
    v_sub_f32 v92, v50, v60
    v_sub_f32 v93, v51, v60
    v_fmac_f32 v61, v92, v92
    v_fmac_f32 v62, v93, v93
    v_sub_f32 v92, v52, v60
    v_sub_f32 v93, v53, v60
    v_fmac_f32 v61, v92, v92
    v_fmac_f32 v62, v93, v93
    v_sub_f32 v92, v54, v60
    v_sub_f32 v93, v55, v60
    v_fmac_f32 v61, v92, v92
    v_fmac_f32 v62, v93, v93
    v_sub_f32 v92, v56, v60
    v_sub_f32 v93, v57, v60
    v_fmac_f32 v61, v92, v92
    v_fmac_f32 v62, v93, v93
    v_sub_f32 v92, v58, v60
    v_sub_f32 v93, v59, v60
    v_fmac_f32 v61, v92, v92
    v_fmac_f32 v62, v93, v93
    v_add_f32 v61, v61, v62
    s_nop 1
    v_add_f32_dpp v61, v61, v61 quad_perm:[1,0,3,2] row_mask:0xf bank_mask:0xf
    s_nop 1
    v_add_f32_dpp v61, v61, v61 quad_perm:[2,3,0,1] row_mask:0xf bank_mask:0xf
    s_nop 1
    v_add_f32_dpp v61, v61, v61 row_half_mirror row_mask:0xf bank_mask:0xf
    v_mul_f32 v61, 0x3b124925, v61
    v_cvt_pk_bf16_f32 v60, v60, v60
    v_lshlrev_b32 v60, 16, v60
    v_cvt_pk_bf16_f32 v61, v61, v61
    v_lshlrev_b32 v61, 16, v61
    v_add_f32 v61, 0x3727c5ac, v61
    v_cvt_pk_bf16_f32 v61, v61, v61
    v_lshlrev_b32 v61, 16, v61
    v_sqrt_f32 v61, v61
    s_nop 0
    v_cvt_pk_bf16_f32 v61, v61, v61
    v_lshlrev_b32 v61, 16, v61
    v_rcp_f32 v61, v61
    v_sub_f32 v4, v4, v60
    v_sub_f32 v5, v5, v60
    v_cvt_pk_bf16_f32 v92, v4, v5
    v_lshlrev_b32 v4, 16, v92
    v_and_b32 v5, 0xffff0000, v92
    v_mul_f32 v4, v4, v61
    v_mul_f32 v5, v5, v61
    v_sub_f32 v6, v6, v60
    v_sub_f32 v7, v7, v60
    v_cvt_pk_bf16_f32 v92, v6, v7
    v_lshlrev_b32 v6, 16, v92
    v_and_b32 v7, 0xffff0000, v92
    v_mul_f32 v6, v6, v61
    v_mul_f32 v7, v7, v61
    v_sub_f32 v8, v8, v60
    v_sub_f32 v9, v9, v60
    v_cvt_pk_bf16_f32 v92, v8, v9
    v_lshlrev_b32 v8, 16, v92
    v_and_b32 v9, 0xffff0000, v92
    v_mul_f32 v8, v8, v61
    v_mul_f32 v9, v9, v61
    v_sub_f32 v10, v10, v60
    v_sub_f32 v11, v11, v60
    v_cvt_pk_bf16_f32 v92, v10, v11
    v_lshlrev_b32 v10, 16, v92
    v_and_b32 v11, 0xffff0000, v92
    v_mul_f32 v10, v10, v61
    v_mul_f32 v11, v11, v61
    v_sub_f32 v12, v12, v60
    v_sub_f32 v13, v13, v60
    v_cvt_pk_bf16_f32 v92, v12, v13
    v_lshlrev_b32 v12, 16, v92
    v_and_b32 v13, 0xffff0000, v92
    v_mul_f32 v12, v12, v61
    v_mul_f32 v13, v13, v61
    v_sub_f32 v14, v14, v60
    v_sub_f32 v15, v15, v60
    v_cvt_pk_bf16_f32 v92, v14, v15
    v_lshlrev_b32 v14, 16, v92
    v_and_b32 v15, 0xffff0000, v92
    v_mul_f32 v14, v14, v61
    v_mul_f32 v15, v15, v61
    v_sub_f32 v16, v16, v60
    v_sub_f32 v17, v17, v60
    v_cvt_pk_bf16_f32 v92, v16, v17
    v_lshlrev_b32 v16, 16, v92
    v_and_b32 v17, 0xffff0000, v92
    v_mul_f32 v16, v16, v61
    v_mul_f32 v17, v17, v61
    v_sub_f32 v18, v18, v60
    v_sub_f32 v19, v19, v60
    v_cvt_pk_bf16_f32 v92, v18, v19
    v_lshlrev_b32 v18, 16, v92
    v_and_b32 v19, 0xffff0000, v92
    v_mul_f32 v18, v18, v61
    v_mul_f32 v19, v19, v61
    v_sub_f32 v20, v20, v60
    v_sub_f32 v21, v21, v60
    v_cvt_pk_bf16_f32 v92, v20, v21
    v_lshlrev_b32 v20, 16, v92
    v_and_b32 v21, 0xffff0000, v92
    v_mul_f32 v20, v20, v61
    v_mul_f32 v21, v21, v61
    v_sub_f32 v22, v22, v60
    v_sub_f32 v23, v23, v60
    v_cvt_pk_bf16_f32 v92, v22, v23
    v_lshlrev_b32 v22, 16, v92
    v_and_b32 v23, 0xffff0000, v92
    v_mul_f32 v22, v22, v61
    v_mul_f32 v23, v23, v61
    v_sub_f32 v24, v24, v60
    v_sub_f32 v25, v25, v60
    v_cvt_pk_bf16_f32 v92, v24, v25
    v_lshlrev_b32 v24, 16, v92
    v_and_b32 v25, 0xffff0000, v92
    v_mul_f32 v24, v24, v61
    v_mul_f32 v25, v25, v61
    v_sub_f32 v26, v26, v60
    v_sub_f32 v27, v27, v60
    v_cvt_pk_bf16_f32 v92, v26, v27
    v_lshlrev_b32 v26, 16, v92
    v_and_b32 v27, 0xffff0000, v92
    v_mul_f32 v26, v26, v61
    v_mul_f32 v27, v27, v61
    v_sub_f32 v28, v28, v60
    v_sub_f32 v29, v29, v60
    v_cvt_pk_bf16_f32 v92, v28, v29
    v_lshlrev_b32 v28, 16, v92
    v_and_b32 v29, 0xffff0000, v92
    v_mul_f32 v28, v28, v61
    v_mul_f32 v29, v29, v61
    v_sub_f32 v30, v30, v60
    v_sub_f32 v31, v31, v60
    v_cvt_pk_bf16_f32 v92, v30, v31
    v_lshlrev_b32 v30, 16, v92
    v_and_b32 v31, 0xffff0000, v92
    v_mul_f32 v30, v30, v61
    v_mul_f32 v31, v31, v61
    v_sub_f32 v32, v32, v60
    v_sub_f32 v33, v33, v60
    v_cvt_pk_bf16_f32 v92, v32, v33
    v_lshlrev_b32 v32, 16, v92
    v_and_b32 v33, 0xffff0000, v92
    v_mul_f32 v32, v32, v61
    v_mul_f32 v33, v33, v61
    v_sub_f32 v34, v34, v60
    v_sub_f32 v35, v35, v60
    v_cvt_pk_bf16_f32 v92, v34, v35
    v_lshlrev_b32 v34, 16, v92
    v_and_b32 v35, 0xffff0000, v92
    v_mul_f32 v34, v34, v61
    v_mul_f32 v35, v35, v61
    v_sub_f32 v36, v36, v60
    v_sub_f32 v37, v37, v60
    v_cvt_pk_bf16_f32 v92, v36, v37
    v_lshlrev_b32 v36, 16, v92
    v_and_b32 v37, 0xffff0000, v92
    v_mul_f32 v36, v36, v61
    v_mul_f32 v37, v37, v61
    v_sub_f32 v38, v38, v60
    v_sub_f32 v39, v39, v60
    v_cvt_pk_bf16_f32 v92, v38, v39
    v_lshlrev_b32 v38, 16, v92
    v_and_b32 v39, 0xffff0000, v92
    v_mul_f32 v38, v38, v61
    v_mul_f32 v39, v39, v61
    v_sub_f32 v40, v40, v60
    v_sub_f32 v41, v41, v60
    v_cvt_pk_bf16_f32 v92, v40, v41
    v_lshlrev_b32 v40, 16, v92
    v_and_b32 v41, 0xffff0000, v92
    v_mul_f32 v40, v40, v61
    v_mul_f32 v41, v41, v61
    v_sub_f32 v42, v42, v60
    v_sub_f32 v43, v43, v60
    v_cvt_pk_bf16_f32 v92, v42, v43
    v_lshlrev_b32 v42, 16, v92
    v_and_b32 v43, 0xffff0000, v92
    v_mul_f32 v42, v42, v61
    v_mul_f32 v43, v43, v61
    v_sub_f32 v44, v44, v60
    v_sub_f32 v45, v45, v60
    v_cvt_pk_bf16_f32 v92, v44, v45
    v_lshlrev_b32 v44, 16, v92
    v_and_b32 v45, 0xffff0000, v92
    v_mul_f32 v44, v44, v61
    v_mul_f32 v45, v45, v61
    v_sub_f32 v46, v46, v60
    v_sub_f32 v47, v47, v60
    v_cvt_pk_bf16_f32 v92, v46, v47
    v_lshlrev_b32 v46, 16, v92
    v_and_b32 v47, 0xffff0000, v92
    v_mul_f32 v46, v46, v61
    v_mul_f32 v47, v47, v61
    v_sub_f32 v48, v48, v60
    v_sub_f32 v49, v49, v60
    v_cvt_pk_bf16_f32 v92, v48, v49
    v_lshlrev_b32 v48, 16, v92
    v_and_b32 v49, 0xffff0000, v92
    v_mul_f32 v48, v48, v61
    v_mul_f32 v49, v49, v61
    v_sub_f32 v50, v50, v60
    v_sub_f32 v51, v51, v60
    v_cvt_pk_bf16_f32 v92, v50, v51
    v_lshlrev_b32 v50, 16, v92
    v_and_b32 v51, 0xffff0000, v92
    v_mul_f32 v50, v50, v61
    v_mul_f32 v51, v51, v61
    v_sub_f32 v52, v52, v60
    v_sub_f32 v53, v53, v60
    v_cvt_pk_bf16_f32 v92, v52, v53
    v_lshlrev_b32 v52, 16, v92
    v_and_b32 v53, 0xffff0000, v92
    v_mul_f32 v52, v52, v61
    v_mul_f32 v53, v53, v61
    v_sub_f32 v54, v54, v60
    v_sub_f32 v55, v55, v60
    v_cvt_pk_bf16_f32 v92, v54, v55
    v_lshlrev_b32 v54, 16, v92
    v_and_b32 v55, 0xffff0000, v92
    v_mul_f32 v54, v54, v61
    v_mul_f32 v55, v55, v61
    v_sub_f32 v56, v56, v60
    v_sub_f32 v57, v57, v60
    v_cvt_pk_bf16_f32 v92, v56, v57
    v_lshlrev_b32 v56, 16, v92
    v_and_b32 v57, 0xffff0000, v92
    v_mul_f32 v56, v56, v61
    v_mul_f32 v57, v57, v61
    v_sub_f32 v58, v58, v60
    v_sub_f32 v59, v59, v60
    v_cvt_pk_bf16_f32 v92, v58, v59
    v_lshlrev_b32 v58, 16, v92
    v_and_b32 v59, 0xffff0000, v92
    v_mul_f32 v58, v58, v61
    v_mul_f32 v59, v59, v61
    v_cvt_pk_bf16_f32 v64, v4, v5
    v_cvt_pk_bf16_f32 v65, v6, v7
    v_cvt_pk_bf16_f32 v66, v8, v9
    v_cvt_pk_bf16_f32 v67, v10, v11
    ds_write_b128 v96, v[64:67] offset:0
    s_nop 1
    v_cvt_pk_bf16_f32 v64, v12, v13
    v_cvt_pk_bf16_f32 v65, v14, v15
    v_cvt_pk_bf16_f32 v66, v16, v17
    v_cvt_pk_bf16_f32 v67, v18, v19
    ds_write_b128 v96, v[64:67] offset:128
    s_nop 1
    v_cvt_pk_bf16_f32 v64, v20, v21
    v_cvt_pk_bf16_f32 v65, v22, v23
    v_cvt_pk_bf16_f32 v66, v24, v25
    v_cvt_pk_bf16_f32 v67, v26, v27
    ds_write_b128 v96, v[64:67] offset:256
    s_nop 1
    v_cvt_pk_bf16_f32 v64, v28, v29
    v_cvt_pk_bf16_f32 v65, v30, v31
    v_cvt_pk_bf16_f32 v66, v32, v33
    v_cvt_pk_bf16_f32 v67, v34, v35
    ds_write_b128 v96, v[64:67] offset:384
    s_nop 1
    v_cvt_pk_bf16_f32 v64, v36, v37
    v_cvt_pk_bf16_f32 v65, v38, v39
    v_cvt_pk_bf16_f32 v66, v40, v41
    v_cvt_pk_bf16_f32 v67, v42, v43
    ds_write_b128 v96, v[64:67] offset:512
    s_nop 1
    v_cvt_pk_bf16_f32 v64, v44, v45
    v_cvt_pk_bf16_f32 v65, v46, v47
    v_cvt_pk_bf16_f32 v66, v48, v49
    v_cvt_pk_bf16_f32 v67, v50, v51
    ds_write_b128 v96, v[64:67] offset:640
    s_nop 1
    v_cvt_pk_bf16_f32 v64, v52, v53
    v_cvt_pk_bf16_f32 v65, v54, v55
    v_cvt_pk_bf16_f32 v66, v56, v57
    v_cvt_pk_bf16_f32 v67, v58, v59
    ds_write_b128 v96, v[64:67] offset:768
    s_nop 1
    s_cmp_eq_u32 s77, 1
    s_cbranch_scc1 F1_no3
    s_add_u32 s16, s20, 8
    s_mul_i32 s16, s16, 14336
    s_add_u32 s16, s16, 25690112
    buffer_load_dwordx4 v[40:43], v2, s[56:59], s16 offen offset:0 sc1
    buffer_load_dwordx4 v[44:47], v2, s[56:59], s16 offen offset:1024 sc1
    buffer_load_dwordx4 v[48:51], v2, s[56:59], s16 offen offset:2048 sc1
    buffer_load_dwordx4 v[52:55], v2, s[56:59], s16 offen offset:3072 sc1
    s_add_u32 s16, s16, 4096
    buffer_load_dwordx4 v[56:59], v2, s[56:59], s16 offen offset:0 sc1
    buffer_load_dwordx4 v[60:63], v2, s[56:59], s16 offen offset:1024 sc1
    buffer_load_dwordx4 v[64:67], v2, s[56:59], s16 offen offset:2048 sc1
    buffer_load_dwordx4 v[68:71], v2, s[56:59], s16 offen offset:3072 sc1
    s_add_u32 s16, s16, 4096
    buffer_load_dwordx4 v[72:75], v2, s[56:59], s16 offen offset:0 sc1
    buffer_load_dwordx4 v[76:79], v2, s[56:59], s16 offen offset:1024 sc1
    buffer_load_dwordx4 v[80:83], v2, s[56:59], s16 offen offset:2048 sc1
    buffer_load_dwordx4 v[84:87], v2, s[56:59], s16 offen offset:3072 sc1
    s_add_u32 s16, s16, 4096
    buffer_load_dwordx4 v[88:91], v2, s[56:59], s16 offen offset:0 sc1
    buffer_load_dwordx4 v[92:95], v2, s[56:59], s16 offen offset:1024 sc1
F1_no3:
    s_waitcnt lgkmcnt(0)
    s_barrier
    v_and_b32 v3, 15, v0
    v_lshrrev_b32 v4, 2, v3
    v_lshlrev_b32 v4, 3, v4
    v_and_b32 v3, 3, v3
    v_add_u32 v3, v3, v4
    v_mul_u32_u24 v3, 912, v3
    v_lshrrev_b32 v4, 4, v0
    v_lshl_add_u32 v3, v4, 4, v3
    v_and_b32 v36, 15, v0
    v_lshlrev_b32 v36, 6, v36
    v_lshrrev_b32 v37, 4, v0
    v_lshl_add_u32 v36, v37, 4, v36
    s_lshl_b32 s21, s12, 15
    s_lshl_b32 s17, s20, 10
    s_add_u32 s21, s21, s17
    s_add_u32 s21, s21, 69832704
    s_waitcnt vmcnt(14)
    ds_read_b128 v[4:7], v3 offset:0
    ds_read_b128 v[8:11], v3 offset:3648
    ds_read_b128 v[12:15], v3 offset:64
    ds_read_b128 v[16:19], v3 offset:3712
    ds_read_b128 v[20:23], v3 offset:128
    ds_read_b128 v[24:27], v3 offset:3776
    s_waitcnt lgkmcnt(5)
    v_mfma_f32_16x16x32_bf16 v[100:103], v[4:7], v[128:131], 0
    v_mfma_f32_16x16x32_bf16 v[108:111], v[4:7], v[184:187], 0
    ds_read_b128 v[28:31], v3 offset:192
    s_waitcnt lgkmcnt(5)
    v_mfma_f32_16x16x32_bf16 v[104:107], v[8:11], v[128:131], 0
    v_mfma_f32_16x16x32_bf16 v[112:115], v[8:11], v[184:187], 0
    ds_read_b128 v[32:35], v3 offset:3840
    s_waitcnt lgkmcnt(5)
    v_mfma_f32_16x16x32_bf16 v[100:103], v[12:15], v[132:135], v[100:103]
    v_mfma_f32_16x16x32_bf16 v[108:111], v[12:15], v[188:191], v[108:111]
    ds_read_b128 v[4:7], v3 offset:256
    s_waitcnt lgkmcnt(5)
    v_mfma_f32_16x16x32_bf16 v[104:107], v[16:19], v[132:135], v[104:107]
    v_mfma_f32_16x16x32_bf16 v[112:115], v[16:19], v[188:191], v[112:115]
    ds_read_b128 v[8:11], v3 offset:3904
    s_waitcnt lgkmcnt(5)
    v_mfma_f32_16x16x32_bf16 v[100:103], v[20:23], v[136:139], v[100:103]
    v_mfma_f32_16x16x32_bf16 v[108:111], v[20:23], v[192:195], v[108:111]
    ds_read_b128 v[12:15], v3 offset:320
    s_waitcnt lgkmcnt(5)
    v_mfma_f32_16x16x32_bf16 v[104:107], v[24:27], v[136:139], v[104:107]
    v_mfma_f32_16x16x32_bf16 v[112:115], v[24:27], v[192:195], v[112:115]
    ds_read_b128 v[16:19], v3 offset:3968
    s_waitcnt lgkmcnt(5)
    v_mfma_f32_16x16x32_bf16 v[100:103], v[28:31], v[140:143], v[100:103]
    v_mfma_f32_16x16x32_bf16 v[108:111], v[28:31], v[196:199], v[108:111]
    ds_read_b128 v[20:23], v3 offset:384
    s_waitcnt lgkmcnt(5)
    v_mfma_f32_16x16x32_bf16 v[104:107], v[32:35], v[140:143], v[104:107]
    v_mfma_f32_16x16x32_bf16 v[112:115], v[32:35], v[196:199], v[112:115]
    ds_read_b128 v[24:27], v3 offset:4032
    s_waitcnt lgkmcnt(5)
    v_mfma_f32_16x16x32_bf16 v[100:103], v[4:7], v[144:147], v[100:103]
    v_mfma_f32_16x16x32_bf16 v[108:111], v[4:7], v[200:203], v[108:111]
    ds_read_b128 v[28:31], v3 offset:448
    s_waitcnt lgkmcnt(5)
    v_mfma_f32_16x16x32_bf16 v[104:107], v[8:11], v[144:147], v[104:107]
    v_mfma_f32_16x16x32_bf16 v[112:115], v[8:11], v[200:203], v[112:115]
    ds_read_b128 v[32:35], v3 offset:4096
    s_waitcnt lgkmcnt(5)
    v_mfma_f32_16x16x32_bf16 v[100:103], v[12:15], v[148:151], v[100:103]
    v_mfma_f32_16x16x32_bf16 v[108:111], v[12:15], v[204:207], v[108:111]
    ds_read_b128 v[4:7], v3 offset:512
    s_waitcnt lgkmcnt(5)
    v_mfma_f32_16x16x32_bf16 v[104:107], v[16:19], v[148:151], v[104:107]
    v_mfma_f32_16x16x32_bf16 v[112:115], v[16:19], v[204:207], v[112:115]
    ds_read_b128 v[8:11], v3 offset:4160
    s_waitcnt lgkmcnt(5)
    v_mfma_f32_16x16x32_bf16 v[100:103], v[20:23], v[152:155], v[100:103]
    v_mfma_f32_16x16x32_bf16 v[108:111], v[20:23], v[208:211], v[108:111]
    ds_read_b128 v[12:15], v3 offset:576
    s_waitcnt lgkmcnt(5)
    v_mfma_f32_16x16x32_bf16 v[104:107], v[24:27], v[152:155], v[104:107]
    v_mfma_f32_16x16x32_bf16 v[112:115], v[24:27], v[208:211], v[112:115]
    ds_read_b128 v[16:19], v3 offset:4224
    s_waitcnt lgkmcnt(5)
    v_mfma_f32_16x16x32_bf16 v[100:103], v[28:31], v[156:159], v[100:103]
    v_mfma_f32_16x16x32_bf16 v[108:111], v[28:31], v[212:215], v[108:111]
    ds_read_b128 v[20:23], v3 offset:640
    s_waitcnt lgkmcnt(5)
    v_mfma_f32_16x16x32_bf16 v[104:107], v[32:35], v[156:159], v[104:107]
    v_mfma_f32_16x16x32_bf16 v[112:115], v[32:35], v[212:215], v[112:115]
    ds_read_b128 v[24:27], v3 offset:4288
    s_waitcnt lgkmcnt(5)
    v_mfma_f32_16x16x32_bf16 v[100:103], v[4:7], v[160:163], v[100:103]
    v_mfma_f32_16x16x32_bf16 v[108:111], v[4:7], v[216:219], v[108:111]
    ds_read_b128 v[28:31], v3 offset:704
    s_waitcnt lgkmcnt(5)
    v_mfma_f32_16x16x32_bf16 v[104:107], v[8:11], v[160:163], v[104:107]
    v_mfma_f32_16x16x32_bf16 v[112:115], v[8:11], v[216:219], v[112:115]
    ds_read_b128 v[32:35], v3 offset:4352
    s_waitcnt lgkmcnt(5)
    v_mfma_f32_16x16x32_bf16 v[100:103], v[12:15], v[164:167], v[100:103]
    v_mfma_f32_16x16x32_bf16 v[108:111], v[12:15], v[220:223], v[108:111]
    ds_read_b128 v[4:7], v3 offset:768
    s_waitcnt lgkmcnt(5)
    v_mfma_f32_16x16x32_bf16 v[104:107], v[16:19], v[164:167], v[104:107]
    v_mfma_f32_16x16x32_bf16 v[112:115], v[16:19], v[220:223], v[112:115]
    ds_read_b128 v[8:11], v3 offset:4416
    s_waitcnt lgkmcnt(5)
    v_mfma_f32_16x16x32_bf16 v[100:103], v[20:23], v[168:171], v[100:103]
    v_mfma_f32_16x16x32_bf16 v[108:111], v[20:23], v[224:227], v[108:111]
    ds_read_b128 v[12:15], v3 offset:832
    s_waitcnt lgkmcnt(5)
    v_mfma_f32_16x16x32_bf16 v[104:107], v[24:27], v[168:171], v[104:107]
    v_mfma_f32_16x16x32_bf16 v[112:115], v[24:27], v[224:227], v[112:115]
    ds_read_b128 v[16:19], v3 offset:4480
    s_waitcnt lgkmcnt(5)
    v_mfma_f32_16x16x32_bf16 v[100:103], v[28:31], v[172:175], v[100:103]
    v_mfma_f32_16x16x32_bf16 v[108:111], v[28:31], v[228:231], v[108:111]
    s_waitcnt lgkmcnt(4)
    v_mfma_f32_16x16x32_bf16 v[104:107], v[32:35], v[172:175], v[104:107]
    v_mfma_f32_16x16x32_bf16 v[112:115], v[32:35], v[228:231], v[112:115]
    s_waitcnt lgkmcnt(3)
    v_mfma_f32_16x16x32_bf16 v[100:103], v[4:7], v[176:179], v[100:103]
    v_mfma_f32_16x16x32_bf16 v[108:111], v[4:7], v[232:235], v[108:111]
    s_waitcnt lgkmcnt(2)
    v_mfma_f32_16x16x32_bf16 v[104:107], v[8:11], v[176:179], v[104:107]
    v_mfma_f32_16x16x32_bf16 v[112:115], v[8:11], v[232:235], v[112:115]
    s_waitcnt lgkmcnt(1)
    v_mfma_f32_16x16x32_bf16 v[100:103], v[12:15], v[180:183], v[100:103]
    v_mfma_f32_16x16x32_bf16 v[108:111], v[12:15], v[236:239], v[108:111]
    s_waitcnt lgkmcnt(0)
    v_mfma_f32_16x16x32_bf16 v[104:107], v[16:19], v[180:183], v[104:107]
    v_mfma_f32_16x16x32_bf16 v[112:115], v[16:19], v[236:239], v[112:115]
    s_cmp_eq_u32 s77, 1
    s_cbranch_scc0 F1_two
    s_nop 1
    v_cvt_pk_bf16_f32 v120, v100, v101
    v_cvt_pk_bf16_f32 v121, v102, v103
    s_nop 0
    v_cvt_pk_bf16_f32 v122, v104, v105
    v_cvt_pk_bf16_f32 v123, v106, v107
    s_add_u32 s17, s21, 0
    buffer_store_dwordx4 v[120:123], v36, s[4:7], s17 offen sc1
    s_and_b32 s16, s13, 1
    s_lshl_b32 s16, s16, 2
    s_add_u32 s16, s16, s14
    s_cmp_eq_u32 s16, 7
    s_cbranch_scc1 F1_no4
    v_cvt_pk_bf16_f32 v124, v108, v109
    v_cvt_pk_bf16_f32 v125, v110, v111
    v_cvt_pk_bf16_f32 v126, v112, v113
    v_cvt_pk_bf16_f32 v127, v114, v115
    s_add_u32 s17, s21, 4096
    buffer_store_dwordx4 v[124:127], v36, s[4:7], s17 offen sc1
    s_branch F1_no4
F1_two:
    s_add_u32 s16, s20, 12
    s_mul_i32 s16, s16, 14336
    s_add_u32 s16, s16, 25690112
    buffer_load_dwordx4 v[128:131], v2, s[56:59], s16 offen offset:0 sc1
    buffer_load_dwordx4 v[132:135], v2, s[56:59], s16 offen offset:1024 sc1
    buffer_load_dwordx4 v[136:139], v2, s[56:59], s16 offen offset:2048 sc1
    buffer_load_dwordx4 v[140:143], v2, s[56:59], s16 offen offset:3072 sc1
    s_add_u32 s16, s16, 4096
    buffer_load_dwordx4 v[144:147], v2, s[56:59], s16 offen offset:0 sc1
    buffer_load_dwordx4 v[148:151], v2, s[56:59], s16 offen offset:1024 sc1
    buffer_load_dwordx4 v[152:155], v2, s[56:59], s16 offen offset:2048 sc1
    buffer_load_dwordx4 v[156:159], v2, s[56:59], s16 offen offset:3072 sc1
    s_add_u32 s16, s16, 4096
    buffer_load_dwordx4 v[160:163], v2, s[56:59], s16 offen offset:0 sc1
    buffer_load_dwordx4 v[164:167], v2, s[56:59], s16 offen offset:1024 sc1
    buffer_load_dwordx4 v[168:171], v2, s[56:59], s16 offen offset:2048 sc1
    buffer_load_dwordx4 v[172:175], v2, s[56:59], s16 offen offset:3072 sc1
    s_add_u32 s16, s16, 4096
    buffer_load_dwordx4 v[176:179], v2, s[56:59], s16 offen offset:0 sc1
    buffer_load_dwordx4 v[180:183], v2, s[56:59], s16 offen offset:1024 sc1
    v_cvt_pk_bf16_f32 v120, v100, v101
    v_cvt_pk_bf16_f32 v121, v102, v103
    v_cvt_pk_bf16_f32 v122, v104, v105
    v_cvt_pk_bf16_f32 v123, v106, v107
    s_add_u32 s17, s21, 0
    buffer_store_dwordx4 v[120:123], v36, s[4:7], s17 offen sc1
    v_cvt_pk_bf16_f32 v124, v108, v109
    v_cvt_pk_bf16_f32 v125, v110, v111
    v_cvt_pk_bf16_f32 v126, v112, v113
    v_cvt_pk_bf16_f32 v127, v114, v115
    s_add_u32 s17, s21, 4096
    buffer_store_dwordx4 v[124:127], v36, s[4:7], s17 offen sc1
    s_waitcnt vmcnt(2)
    ds_read_b128 v[4:7], v3 offset:0
    ds_read_b128 v[8:11], v3 offset:3648
    ds_read_b128 v[12:15], v3 offset:64
    ds_read_b128 v[16:19], v3 offset:3712
    ds_read_b128 v[20:23], v3 offset:128
    ds_read_b128 v[24:27], v3 offset:3776
    s_waitcnt lgkmcnt(5)
    v_mfma_f32_16x16x32_bf16 v[100:103], v[4:7], v[40:43], 0
    v_mfma_f32_16x16x32_bf16 v[108:111], v[4:7], v[128:131], 0
    ds_read_b128 v[28:31], v3 offset:192
    s_waitcnt lgkmcnt(5)
    v_mfma_f32_16x16x32_bf16 v[104:107], v[8:11], v[40:43], 0
    v_mfma_f32_16x16x32_bf16 v[112:115], v[8:11], v[128:131], 0
    ds_read_b128 v[32:35], v3 offset:3840
    s_waitcnt lgkmcnt(5)
    v_mfma_f32_16x16x32_bf16 v[100:103], v[12:15], v[44:47], v[100:103]
    v_mfma_f32_16x16x32_bf16 v[108:111], v[12:15], v[132:135], v[108:111]
    ds_read_b128 v[4:7], v3 offset:256
    s_waitcnt lgkmcnt(5)
    v_mfma_f32_16x16x32_bf16 v[104:107], v[16:19], v[44:47], v[104:107]
    v_mfma_f32_16x16x32_bf16 v[112:115], v[16:19], v[132:135], v[112:115]
    ds_read_b128 v[8:11], v3 offset:3904
    s_waitcnt lgkmcnt(5)
    v_mfma_f32_16x16x32_bf16 v[100:103], v[20:23], v[48:51], v[100:103]
    v_mfma_f32_16x16x32_bf16 v[108:111], v[20:23], v[136:139], v[108:111]
    ds_read_b128 v[12:15], v3 offset:320
    s_waitcnt lgkmcnt(5)
    v_mfma_f32_16x16x32_bf16 v[104:107], v[24:27], v[48:51], v[104:107]
    v_mfma_f32_16x16x32_bf16 v[112:115], v[24:27], v[136:139], v[112:115]
    ds_read_b128 v[16:19], v3 offset:3968
    s_waitcnt lgkmcnt(5)
    v_mfma_f32_16x16x32_bf16 v[100:103], v[28:31], v[52:55], v[100:103]
    v_mfma_f32_16x16x32_bf16 v[108:111], v[28:31], v[140:143], v[108:111]
    ds_read_b128 v[20:23], v3 offset:384
    s_waitcnt lgkmcnt(5)
    v_mfma_f32_16x16x32_bf16 v[104:107], v[32:35], v[52:55], v[104:107]
    v_mfma_f32_16x16x32_bf16 v[112:115], v[32:35], v[140:143], v[112:115]
    ds_read_b128 v[24:27], v3 offset:4032
    s_waitcnt lgkmcnt(5)
    v_mfma_f32_16x16x32_bf16 v[100:103], v[4:7], v[56:59], v[100:103]
    v_mfma_f32_16x16x32_bf16 v[108:111], v[4:7], v[144:147], v[108:111]
    ds_read_b128 v[28:31], v3 offset:448
    s_waitcnt lgkmcnt(5)
    v_mfma_f32_16x16x32_bf16 v[104:107], v[8:11], v[56:59], v[104:107]
    v_mfma_f32_16x16x32_bf16 v[112:115], v[8:11], v[144:147], v[112:115]
    ds_read_b128 v[32:35], v3 offset:4096
    s_waitcnt lgkmcnt(5)
    v_mfma_f32_16x16x32_bf16 v[100:103], v[12:15], v[60:63], v[100:103]
    v_mfma_f32_16x16x32_bf16 v[108:111], v[12:15], v[148:151], v[108:111]
    ds_read_b128 v[4:7], v3 offset:512
    s_waitcnt lgkmcnt(5)
    v_mfma_f32_16x16x32_bf16 v[104:107], v[16:19], v[60:63], v[104:107]
    v_mfma_f32_16x16x32_bf16 v[112:115], v[16:19], v[148:151], v[112:115]
    ds_read_b128 v[8:11], v3 offset:4160
    s_waitcnt lgkmcnt(5)
    v_mfma_f32_16x16x32_bf16 v[100:103], v[20:23], v[64:67], v[100:103]
    v_mfma_f32_16x16x32_bf16 v[108:111], v[20:23], v[152:155], v[108:111]
    ds_read_b128 v[12:15], v3 offset:576
    s_waitcnt lgkmcnt(5)
    v_mfma_f32_16x16x32_bf16 v[104:107], v[24:27], v[64:67], v[104:107]
    v_mfma_f32_16x16x32_bf16 v[112:115], v[24:27], v[152:155], v[112:115]
    ds_read_b128 v[16:19], v3 offset:4224
    s_waitcnt lgkmcnt(5)
    v_mfma_f32_16x16x32_bf16 v[100:103], v[28:31], v[68:71], v[100:103]
    v_mfma_f32_16x16x32_bf16 v[108:111], v[28:31], v[156:159], v[108:111]
    ds_read_b128 v[20:23], v3 offset:640
    s_waitcnt lgkmcnt(5)
    v_mfma_f32_16x16x32_bf16 v[104:107], v[32:35], v[68:71], v[104:107]
    v_mfma_f32_16x16x32_bf16 v[112:115], v[32:35], v[156:159], v[112:115]
    ds_read_b128 v[24:27], v3 offset:4288
    s_waitcnt lgkmcnt(5)
    v_mfma_f32_16x16x32_bf16 v[100:103], v[4:7], v[72:75], v[100:103]
    v_mfma_f32_16x16x32_bf16 v[108:111], v[4:7], v[160:163], v[108:111]
    ds_read_b128 v[28:31], v3 offset:704
    s_waitcnt lgkmcnt(5)
    v_mfma_f32_16x16x32_bf16 v[104:107], v[8:11], v[72:75], v[104:107]
    v_mfma_f32_16x16x32_bf16 v[112:115], v[8:11], v[160:163], v[112:115]
    ds_read_b128 v[32:35], v3 offset:4352
    s_waitcnt lgkmcnt(5)
    v_mfma_f32_16x16x32_bf16 v[100:103], v[12:15], v[76:79], v[100:103]
    v_mfma_f32_16x16x32_bf16 v[108:111], v[12:15], v[164:167], v[108:111]
    ds_read_b128 v[4:7], v3 offset:768
    s_waitcnt lgkmcnt(5)
    v_mfma_f32_16x16x32_bf16 v[104:107], v[16:19], v[76:79], v[104:107]
    v_mfma_f32_16x16x32_bf16 v[112:115], v[16:19], v[164:167], v[112:115]
    ds_read_b128 v[8:11], v3 offset:4416
    s_waitcnt lgkmcnt(5)
    v_mfma_f32_16x16x32_bf16 v[100:103], v[20:23], v[80:83], v[100:103]
    v_mfma_f32_16x16x32_bf16 v[108:111], v[20:23], v[168:171], v[108:111]
    ds_read_b128 v[12:15], v3 offset:832
    s_waitcnt lgkmcnt(5)
    v_mfma_f32_16x16x32_bf16 v[104:107], v[24:27], v[80:83], v[104:107]
    v_mfma_f32_16x16x32_bf16 v[112:115], v[24:27], v[168:171], v[112:115]
    ds_read_b128 v[16:19], v3 offset:4480
    s_waitcnt lgkmcnt(5)
    v_mfma_f32_16x16x32_bf16 v[100:103], v[28:31], v[84:87], v[100:103]
    v_mfma_f32_16x16x32_bf16 v[108:111], v[28:31], v[172:175], v[108:111]
    s_waitcnt lgkmcnt(4)
    v_mfma_f32_16x16x32_bf16 v[104:107], v[32:35], v[84:87], v[104:107]
    v_mfma_f32_16x16x32_bf16 v[112:115], v[32:35], v[172:175], v[112:115]
    s_waitcnt lgkmcnt(3)
    v_mfma_f32_16x16x32_bf16 v[100:103], v[4:7], v[88:91], v[100:103]
    v_mfma_f32_16x16x32_bf16 v[108:111], v[4:7], v[176:179], v[108:111]
    s_waitcnt lgkmcnt(2)
    v_mfma_f32_16x16x32_bf16 v[104:107], v[8:11], v[88:91], v[104:107]
    v_mfma_f32_16x16x32_bf16 v[112:115], v[8:11], v[176:179], v[112:115]
    s_waitcnt lgkmcnt(1)
    v_mfma_f32_16x16x32_bf16 v[100:103], v[12:15], v[92:95], v[100:103]
    v_mfma_f32_16x16x32_bf16 v[108:111], v[12:15], v[180:183], v[108:111]
    s_waitcnt lgkmcnt(0)
    v_mfma_f32_16x16x32_bf16 v[104:107], v[16:19], v[92:95], v[104:107]
    v_mfma_f32_16x16x32_bf16 v[112:115], v[16:19], v[180:183], v[112:115]
    s_nop 3
    v_cvt_pk_bf16_f32 v120, v100, v101
    v_cvt_pk_bf16_f32 v121, v102, v103
    s_nop 0
    v_cvt_pk_bf16_f32 v122, v104, v105
    v_cvt_pk_bf16_f32 v123, v106, v107
    s_add_u32 s17, s21, 8192
    buffer_store_dwordx4 v[120:123], v36, s[4:7], s17 offen sc1
    s_cmp_lt_u32 s14, 3
    s_cbranch_scc0 F1_no4
    v_cvt_pk_bf16_f32 v124, v108, v109
    v_cvt_pk_bf16_f32 v125, v110, v111
    v_cvt_pk_bf16_f32 v126, v112, v113
    v_cvt_pk_bf16_f32 v127, v114, v115
    s_add_u32 s17, s21, 12288
    buffer_store_dwordx4 v[124:127], v36, s[4:7], s17 offen sc1
F1_no4:
    s_waitcnt vmcnt(0)
    s_barrier
    s_cmp_eq_u32 s76, 0
    s_cbranch_scc0 K_ff1
    s_lshl_b32 s53, s55, 4
    s_add_u32 s53, s53, 78626816
    s_mov_b64 exec, 1
    v_mov_b32 v2, 1
    buffer_store_dword v2, off, s[4:7], s53 sc1
    s_mov_b64 exec, -1
K_ff1:
    s_cmp_eq_u32 s77, 1
    s_cbranch_scc1 K_spare_next
    s_cmp_ge_u32 s64, 113
    s_cbranch_scc0 K_f1skip
    s_sub_u32 s52, s64, 113
    s_load_dwordx2 s[20:21], s[0:1], 32
    s_waitcnt lgkmcnt(0)
    s_mov_b32 s16, s20
    s_and_b32 s17, s21, 0xffff
    s_mov_b32 s18, 7168
    s_mov_b32 s19, 0x20000
    v_accvgpr_read_b32 v0, a255
    s_lshl_b32 s3, s52, 8
    v_add_u32 v1, s3, v0
    v_lshlrev_b32 v38, 4, v1
    v_mov_b32 v4, -1
    v_mov_b32 v5, -1
    v_mov_b32 v6, -1
    v_mov_b32 v7, -1
    v_mov_b32 v8, 0
    v_mov_b32 v9, 0
    v_mov_b32 v10, 0
    v_mov_b32 v11, 0
    s_mov_b32 s31, 32481280
    v_mov_b32 v2, v38
    s_mov_b32 s29, 0
T_fm0:
    v_mov_b32 v36, 516096
    v_cmp_gt_u32 vcc, v36, v2
    v_mov_b32 v37, 0x7fffffff
    s_nop 0
    v_cndmask_b32 v3, v37, v2, vcc
    buffer_store_dwordx4 v[4:7], v3, s[56:59], s31 offen sc1
    v_add_u32 v2, 61440, v2
    s_add_u32 s29, s29, 61440
    s_cmp_lt_u32 s29, 516096
    s_cbranch_scc1 T_fm0
    s_mov_b32 s31, 33030144
    v_mov_b32 v2, v38
    s_mov_b32 s29, 0
T_fp0:
    v_mov_b32 v36, 655360
    v_cmp_gt_u32 vcc, v36, v2
    v_mov_b32 v37, 0x7fffffff
    s_nop 0
    v_cndmask_b32 v3, v37, v2, vcc
    buffer_store_dwordx4 v[4:7], v3, s[56:59], s31 offen sc1
    v_add_u32 v2, 61440, v2
    s_add_u32 s29, s29, 61440
    s_cmp_lt_u32 s29, 655360
    s_cbranch_scc1 T_fp0
    s_mov_b32 s31, 41065472
    v_mov_b32 v2, v38
    s_mov_b32 s29, 0
T_fe0:
    v_mov_b32 v36, 451584
    v_cmp_gt_u32 vcc, v36, v2
    v_mov_b32 v37, 0x7fffffff
    s_nop 0
    v_cndmask_b32 v3, v37, v2, vcc
    buffer_store_dwordx4 v[4:7], v3, s[56:59], s31 offen sc1
    v_add_u32 v2, 61440, v2
    s_add_u32 s29, s29, 61440
    s_cmp_lt_u32 s29, 451584
    s_cbranch_scc1 T_fe0
    s_mov_b32 s31, 106270720
    v_mov_b32 v2, v38
    s_mov_b32 s29, 0
T_fx0:
    v_mov_b32 v36, 2097152
    v_cmp_gt_u32 vcc, v36, v2
    v_mov_b32 v37, 0x7fffffff
    s_nop 0
    v_cndmask_b32 v3, v37, v2, vcc
    buffer_store_dwordx4 v[4:7], v3, s[56:59], s31 offen sc1
    v_add_u32 v2, 61440, v2
    s_add_u32 s29, s29, 61440
    s_cmp_lt_u32 s29, 2097152
    s_cbranch_scc1 T_fx0
    s_mov_b32 s31, 108367872
    v_mov_b32 v2, v38
    s_mov_b32 s29, 0
T_fq0:
    v_mov_b32 v36, 524288
    v_cmp_gt_u32 vcc, v36, v2
    v_mov_b32 v37, 0x7fffffff
    s_nop 0
    v_cndmask_b32 v3, v37, v2, vcc
    buffer_store_dwordx4 v[4:7], v3, s[56:59], s31 offen sc1
    v_add_u32 v2, 61440, v2
    s_add_u32 s29, s29, 61440
    s_cmp_lt_u32 s29, 524288
    s_cbranch_scc1 T_fq0
    s_mov_b32 s31, 112173056
    v_mov_b32 v2, v38
    s_mov_b32 s29, 0
T_fm1:
    v_mov_b32 v36, 516096
    v_cmp_gt_u32 vcc, v36, v2
    v_mov_b32 v37, 0x7fffffff
    s_nop 0
    v_cndmask_b32 v3, v37, v2, vcc
    buffer_store_dwordx4 v[4:7], v3, s[56:59], s31 offen sc1
    v_add_u32 v2, 61440, v2
    s_add_u32 s29, s29, 61440
    s_cmp_lt_u32 s29, 516096
    s_cbranch_scc1 T_fm1
    s_mov_b32 s31, 112721920
    v_mov_b32 v2, v38
    s_mov_b32 s29, 0
T_fp1:
    v_mov_b32 v36, 655360
    v_cmp_gt_u32 vcc, v36, v2
    v_mov_b32 v37, 0x7fffffff
    s_nop 0
    v_cndmask_b32 v3, v37, v2, vcc
    buffer_store_dwordx4 v[4:7], v3, s[56:59], s31 offen sc1
    v_add_u32 v2, 61440, v2
    s_add_u32 s29, s29, 61440
    s_cmp_lt_u32 s29, 655360
    s_cbranch_scc1 T_fp1
    s_mov_b32 s31, 120757248
    v_mov_b32 v2, v38
    s_mov_b32 s29, 0
T_fe1:
    v_mov_b32 v36, 451584
    v_cmp_gt_u32 vcc, v36, v2
    v_mov_b32 v37, 0x7fffffff
    s_nop 0
    v_cndmask_b32 v3, v37, v2, vcc
    buffer_store_dwordx4 v[4:7], v3, s[56:59], s31 offen sc1
    v_add_u32 v2, 61440, v2
    s_add_u32 s29, s29, 61440
    s_cmp_lt_u32 s29, 451584
    s_cbranch_scc1 T_fe1
    s_mov_b32 s31, 185962496
    v_mov_b32 v2, v38
    s_mov_b32 s29, 0
T_fx1:
    v_mov_b32 v36, 2097152
    v_cmp_gt_u32 vcc, v36, v2
    v_mov_b32 v37, 0x7fffffff
    s_nop 0
    v_cndmask_b32 v3, v37, v2, vcc
    buffer_store_dwordx4 v[4:7], v3, s[56:59], s31 offen sc1
    v_add_u32 v2, 61440, v2
    s_add_u32 s29, s29, 61440
    s_cmp_lt_u32 s29, 2097152
    s_cbranch_scc1 T_fx1
    s_mov_b32 s31, 188059648
    v_mov_b32 v2, v38
    s_mov_b32 s29, 0
T_fq1:
    v_mov_b32 v36, 524288
    v_cmp_gt_u32 vcc, v36, v2
    v_mov_b32 v37, 0x7fffffff
    s_nop 0
    v_cndmask_b32 v3, v37, v2, vcc
    buffer_store_dwordx4 v[4:7], v3, s[56:59], s31 offen sc1
    v_add_u32 v2, 61440, v2
    s_add_u32 s29, s29, 61440
    s_cmp_lt_u32 s29, 524288
    s_cbranch_scc1 T_fq1
    s_cmp_eq_u32 s52, 3
    s_cbranch_scc0 T_fill_end
    v_add_u32 v2, 0, v0
    v_and_b32 v3, 7, v2
    v_mul_u32_u24 v3, 896, v3
    v_lshrrev_b32 v12, 3, v2
    v_lshl_add_u32 v3, v12, 4, v3
    v_mov_b32 v36, 448
    v_cmp_gt_u32 vcc, v36, v2
    v_mov_b32 v37, 0x7fffffff
    s_nop 0
    v_cndmask_b32 v3, v37, v3, vcc
    buffer_load_dwordx4 v[12:15], v3, s[16:19], 0 offen
    v_lshlrev_b32 v2, 4, v2
    v_cndmask_b32 v2, v37, v2, vcc
    s_waitcnt vmcnt(0)
    s_mov_b32 s31, 32473088
    buffer_store_dwordx4 v[12:15], v2, s[56:59], s31 offen sc1
    s_mov_b32 s31, 41058304
    buffer_store_dwordx4 v[12:15], v2, s[56:59], s31 offen sc1
    s_mov_b32 s31, 112164864
    buffer_store_dwordx4 v[12:15], v2, s[56:59], s31 offen sc1
    s_mov_b32 s31, 120750080
    buffer_store_dwordx4 v[12:15], v2, s[56:59], s31 offen sc1
    s_nop 1
    v_add_u32 v2, 256, v0
    v_and_b32 v3, 7, v2
    v_mul_u32_u24 v3, 896, v3
    v_lshrrev_b32 v12, 3, v2
    v_lshl_add_u32 v3, v12, 4, v3
    v_mov_b32 v36, 448
    v_cmp_gt_u32 vcc, v36, v2
    v_mov_b32 v37, 0x7fffffff
    s_nop 0
    v_cndmask_b32 v3, v37, v3, vcc
    buffer_load_dwordx4 v[12:15], v3, s[16:19], 0 offen
    v_lshlrev_b32 v2, 4, v2
    v_cndmask_b32 v2, v37, v2, vcc
    s_waitcnt vmcnt(0)
    s_mov_b32 s31, 32473088
    buffer_store_dwordx4 v[12:15], v2, s[56:59], s31 offen sc1
    s_mov_b32 s31, 41058304
    buffer_store_dwordx4 v[12:15], v2, s[56:59], s31 offen sc1
    s_mov_b32 s31, 112164864
    buffer_store_dwordx4 v[12:15], v2, s[56:59], s31 offen sc1
    s_mov_b32 s31, 120750080
    buffer_store_dwordx4 v[12:15], v2, s[56:59], s31 offen sc1
    s_nop 1
T_fill_end:
    s_waitcnt vmcnt(0)
    s_barrier
    s_cmp_eq_u32 s76, 0
    s_cbranch_scc0 K_ffill
    s_lshl_b32 s53, s52, 4
    s_add_u32 s53, s53, 78639104
    s_mov_b64 exec, 1
    v_mov_b32 v2, 1
    buffer_store_dword v2, off, s[4:7], s53 sc1
    s_mov_b64 exec, -1
K_ffill:
K_f1skip:
    s_cmp_lt_u32 s64, 113
    s_cbranch_scc0 K_nof2
    v_accvgpr_read_b32 v0, a255
    v_and_b32 v0, 63, v0
    s_and_b32 s14, s76, 1
    s_lshr_b32 s13, s76, 1
    s_lshl_b32 s12, s64, 1
    s_add_u32 s12, s12, s13
    v_lshlrev_b32 v2, 4, v0
    s_mul_i32 s16, s14, 3072
    s_add_u32 s16, s16, 26411008
    buffer_load_dwordx4 v[36:39], v2, s[56:59], s16 offen offset:0 sc1
    buffer_load_dwordx4 v[40:43], v2, s[56:59], s16 offen offset:1024 sc1
    buffer_load_dwordx4 v[44:47], v2, s[56:59], s16 offen offset:2048 sc1
    s_lshl_b32 s16, s14, 13
    s_add_u32 s16, s16, 26423296
    buffer_load_dwordx4 v[48:51], v2, s[56:59], s16 offen offset:0 sc1
    buffer_load_dwordx4 v[52:55], v2, s[56:59], s16 offen offset:1024 sc1
    buffer_load_dwordx4 v[56:59], v2, s[56:59], s16 offen offset:2048 sc1
    buffer_load_dwordx4 v[60:63], v2, s[56:59], s16 offen offset:3072 sc1
    s_add_u32 s16, s16, 4096
    buffer_load_dwordx4 v[64:67], v2, s[56:59], s16 offen offset:0 sc1
    buffer_load_dwordx4 v[68:71], v2, s[56:59], s16 offen offset:1024 sc1
    buffer_load_dwordx4 v[72:75], v2, s[56:59], s16 offen offset:2048 sc1
    buffer_load_dwordx4 v[76:79], v2, s[56:59], s16 offen offset:3072 sc1
    s_mov_b32 s16, 26394624
    buffer_load_dwordx4 v[80:83], v2, s[56:59], s16 offen offset:0 sc1
    buffer_load_dwordx4 v[84:87], v2, s[56:59], s16 offen offset:1024 sc1
    buffer_load_dwordx4 v[88:91], v2, s[56:59], s16 offen offset:2048 sc1
    buffer_load_dwordx4 v[92:95], v2, s[56:59], s16 offen offset:3072 sc1
    s_add_u32 s16, s16, 4096
    buffer_load_dwordx4 v[96:99], v2, s[56:59], s16 offen offset:0 sc1
    buffer_load_dwordx4 v[100:103], v2, s[56:59], s16 offen offset:1024 sc1
    buffer_load_dwordx4 v[104:107], v2, s[56:59], s16 offen offset:2048 sc1
    buffer_load_dwordx4 v[108:111], v2, s[56:59], s16 offen offset:3072 sc1
    s_add_u32 s16, s16, 4096
    buffer_load_dwordx4 v[112:115], v2, s[56:59], s16 offen offset:0 sc1
    buffer_load_dwordx4 v[116:119], v2, s[56:59], s16 offen offset:1024 sc1
    buffer_load_dwordx4 v[120:123], v2, s[56:59], s16 offen offset:2048 sc1
    buffer_load_dwordx4 v[124:127], v2, s[56:59], s16 offen offset:3072 sc1
    s_add_u32 s16, s16, 4096
    buffer_load_dwordx4 v[128:131], v2, s[56:59], s16 offen offset:0 sc1
    buffer_load_dwordx4 v[132:135], v2, s[56:59], s16 offen offset:1024 sc1
    buffer_load_dwordx4 v[136:139], v2, s[56:59], s16 offen offset:2048 sc1
    buffer_load_dwordx4 v[140:143], v2, s[56:59], s16 offen offset:3072 sc1
    s_add_u32 s16, s16, 4096
    v_and_b32 v1, 15, v0
    s_lshl_b32 s16, s14, 4
    v_add_u32 v1, s16, v1
    v_lshlrev_b32 v1, 2, v1
    v_lshrrev_b32 v240, 4, v0
    v_lshl_add_u32 v1, v240, 9, v1
    s_lshl_b32 s16, s12, 13
    s_add_u32 s16, s16, 26460160
    buffer_load_dword v144, v1, s[56:59], s16 offen offset:0 sc1
    buffer_load_dword v145, v1, s[56:59], s16 offen offset:128 sc1
    buffer_load_dword v146, v1, s[56:59], s16 offen offset:256 sc1
    buffer_load_dword v147, v1, s[56:59], s16 offen offset:384 sc1
    s_add_u32 s16, s16, 2048
    buffer_load_dword v148, v1, s[56:59], s16 offen offset:0 sc1
    buffer_load_dword v149, v1, s[56:59], s16 offen offset:128 sc1
    buffer_load_dword v150, v1, s[56:59], s16 offen offset:256 sc1
    buffer_load_dword v151, v1, s[56:59], s16 offen offset:384 sc1
    s_add_u32 s16, s16, 2048
    buffer_load_dword v152, v1, s[56:59], s16 offen offset:0 sc1
    buffer_load_dword v153, v1, s[56:59], s16 offen offset:128 sc1
    buffer_load_dword v154, v1, s[56:59], s16 offen offset:256 sc1
    buffer_load_dword v155, v1, s[56:59], s16 offen offset:384 sc1
    s_add_u32 s16, s16, 2048
    buffer_load_dword v156, v1, s[56:59], s16 offen offset:0 sc1
    buffer_load_dword v157, v1, s[56:59], s16 offen offset:128 sc1
    buffer_load_dword v158, v1, s[56:59], s16 offen offset:256 sc1
    buffer_load_dword v159, v1, s[56:59], s16 offen offset:384 sc1
    s_add_u32 s16, s16, 2048
    s_mov_b32 s16, 26417152
    buffer_load_dwordx4 v[160:163], v2, s[56:59], s16 offen offset:0 sc1
    buffer_load_dwordx4 v[164:167], v2, s[56:59], s16 offen offset:1024 sc1
    buffer_load_dwordx4 v[168:171], v2, s[56:59], s16 offen offset:2048 sc1
    buffer_load_dwordx4 v[172:175], v2, s[56:59], s16 offen offset:3072 sc1
    s_add_u32 s16, s16, 4096
    buffer_load_dwordx4 v[176:179], v2, s[56:59], s16 offen offset:0 sc1
    buffer_load_dwordx4 v[180:183], v2, s[56:59], s16 offen offset:1024 sc1
    s_cmp_eq_u32 s65, 0
    s_cbranch_scc0 K_wf1b
    s_cmp_eq_u32 s76, 0
    s_cbranch_scc0 K_wf1_ok
    v_mbcnt_lo_u32_b32 v240, -1, 0
    v_mbcnt_hi_u32_b32 v240, -1, v240
    v_add_u32 v241, 0, v240
    v_min_u32 v241, 127, v241
    v_lshlrev_b32 v241, 4, v241
    v_add_u32 v242, 64, v240
    v_min_u32 v242, 127, v242
    v_lshlrev_b32 v242, 4, v242
    s_mov_b32 s53, 78626816
    s_mov_b32 s54, 1048576
K_wf1:
    buffer_load_dword v243, v241, s[4:7], s53 offen sc1
    buffer_load_dword v244, v242, s[4:7], s53 offen sc1
    s_mov_b32 s90, 30
    s_sub_u32 s54, s54, 1
    s_cmp_eq_u32 s54, 0
    s_cbranch_scc1 L_abort1
    s_waitcnt vmcnt(0)
    v_and_b32 v243, v243, v244
    v_cmp_ne_u32 vcc, 1, v243
    s_cbranch_vccz K_wf1_ok
    s_sleep 2
    s_branch K_wf1
K_wf1_ok:
    s_barrier
    s_branch K_wf1d
K_wf1b:
    s_cmp_eq_u32 s76, 0
    s_cbranch_scc0 K_wf1c_ok
    v_mbcnt_lo_u32_b32 v238, -1, 0
    v_mbcnt_hi_u32_b32 v238, -1, v238
    v_add_u32 v239, 0, v238
    v_min_u32 v239, 255, v239
    v_lshlrev_b32 v239, 4, v239
    v_add_u32 v240, 64, v238
    v_min_u32 v240, 255, v240
    v_lshlrev_b32 v240, 4, v240
    v_add_u32 v241, 128, v238
    v_min_u32 v241, 255, v241
    v_lshlrev_b32 v241, 4, v241
    v_add_u32 v242, 192, v238
    v_min_u32 v242, 255, v242
    v_lshlrev_b32 v242, 4, v242
    s_mov_b32 s53, 78626816
    s_mov_b32 s54, 1048576
K_wf1c:
    buffer_load_dword v243, v239, s[4:7], s53 offen sc1
    buffer_load_dword v244, v240, s[4:7], s53 offen sc1
    buffer_load_dword v245, v241, s[4:7], s53 offen sc1
    buffer_load_dword v246, v242, s[4:7], s53 offen sc1
    s_mov_b32 s90, 31
    s_sub_u32 s54, s54, 1
    s_cmp_eq_u32 s54, 0
    s_cbranch_scc1 L_abort1
    s_waitcnt vmcnt(0)
    v_and_b32 v243, v243, v244
    v_and_b32 v243, v243, v245
    v_and_b32 v243, v243, v246
    v_cmp_ne_u32 vcc, 1, v243
    s_cbranch_vccz K_wf1c_ok
    s_sleep 2
    s_branch K_wf1c
K_wf1c_ok:
    s_barrier
K_wf1d:
    v_lshrrev_b32 v3, 2, v0
    v_lshlrev_b32 v3, 15, v3
    v_and_b32 v4, 3, v0
    v_lshl_add_u32 v3, v4, 4, v3
    s_lshl_b32 s15, s14, 8
    s_add_u32 s15, s15, s12
    s_lshl_b32 s15, s15, 6
    s_add_u32 s15, s15, 69832704
    s_lshl_b32 s18, s13, 13
    s_lshl_b32 s19, s14, 12
    s_add_u32 s19, s19, s18
    s_add_u32 s19, s19, 18432
    s_add_u32 m0, s19, 0
    s_add_u32 s16, s15, 0
    buffer_load_dwordx4 v3, s[4:7], s16 offen sc1 lds
    s_add_u32 m0, s19, 1024
    s_add_u32 s16, s15, 524288
    buffer_load_dwordx4 v3, s[4:7], s16 offen sc1 lds
    s_add_u32 m0, s19, 2048
    s_add_u32 s16, s15, 1048576
    buffer_load_dwordx4 v3, s[4:7], s16 offen sc1 lds
    s_add_u32 m0, s19, 3072
    s_add_u32 s16, s15, 1572864
    buffer_load_dwordx4 v3, s[4:7], s16 offen sc1 lds
    v_mov_b64 v[184:185], 0
    v_mov_b64 v[186:187], 0
    v_mov_b64 v[188:189], 0
    v_mov_b64 v[190:191], 0
    v_mov_b64 v[192:193], 0
    v_mov_b64 v[194:195], 0
    v_mov_b64 v[196:197], 0
    v_mov_b64 v[198:199], 0
    v_mov_b64 v[200:201], 0
    v_mov_b64 v[202:203], 0
    v_mov_b64 v[204:205], 0
    v_mov_b64 v[206:207], 0
    v_mov_b64 v[208:209], 0
    v_mov_b64 v[210:211], 0
    v_mov_b64 v[212:213], 0
    v_mov_b64 v[214:215], 0
    s_waitcnt vmcnt(0)
    s_barrier
    v_lshrrev_b32 v240, 4, v0
    v_lshlrev_b32 v240, 3, v240
    v_bfe_u32 v241, v0, 2, 2
    v_add_u32 v240, v240, v241
    v_lshlrev_b32 v240, 7, v240
    v_and_b32 v241, 3, v0
    v_lshl_add_u32 v240, v241, 3, v240
    s_add_u32 s18, s18, 18432
    v_add_u32 v240, s18, v240
    ds_read_b64_tr_b16 v[4:5], v240 offset:0
    ds_read_b64_tr_b16 v[6:7], v240 offset:512
    ds_read_b64_tr_b16 v[8:9], v240 offset:32
    ds_read_b64_tr_b16 v[10:11], v240 offset:544
    ds_read_b64_tr_b16 v[12:13], v240 offset:64
    ds_read_b64_tr_b16 v[14:15], v240 offset:576
    ds_read_b64_tr_b16 v[16:17], v240 offset:96
    ds_read_b64_tr_b16 v[18:19], v240 offset:608
    s_waitcnt lgkmcnt(0)
    ds_read_b64_tr_b16 v[20:21], v240 offset:4096
    ds_read_b64_tr_b16 v[22:23], v240 offset:4608
    ds_read_b64_tr_b16 v[24:25], v240 offset:4128
    ds_read_b64_tr_b16 v[26:27], v240 offset:4640
    ds_read_b64_tr_b16 v[28:29], v240 offset:4160
    ds_read_b64_tr_b16 v[30:31], v240 offset:4672
    ds_read_b64_tr_b16 v[32:33], v240 offset:4192
    ds_read_b64_tr_b16 v[34:35], v240 offset:4704
    s_waitcnt lgkmcnt(0)
    v_mfma_f32_16x16x32_bf16 v[184:187], v[4:7], v[36:39], v[184:187]
    v_mfma_f32_16x16x32_bf16 v[200:203], v[20:23], v[36:39], v[200:203]
    v_mfma_f32_16x16x32_bf16 v[188:191], v[8:11], v[36:39], v[188:191]
    v_mfma_f32_16x16x32_bf16 v[204:207], v[24:27], v[36:39], v[204:207]
    v_mfma_f32_16x16x32_bf16 v[192:195], v[12:15], v[36:39], v[192:195]
    v_mfma_f32_16x16x32_bf16 v[208:211], v[28:31], v[36:39], v[208:211]
    v_mfma_f32_16x16x32_bf16 v[196:199], v[16:19], v[36:39], v[196:199]
    v_mfma_f32_16x16x32_bf16 v[212:215], v[32:35], v[36:39], v[212:215]
    v_mfma_f32_16x16x32_bf16 v[184:187], v[20:23], v[40:43], v[184:187]
    v_mfma_f32_16x16x32_bf16 v[200:203], v[4:7], v[44:47], v[200:203]
    v_mfma_f32_16x16x32_bf16 v[188:191], v[24:27], v[40:43], v[188:191]
    v_mfma_f32_16x16x32_bf16 v[204:207], v[8:11], v[44:47], v[204:207]
    v_mfma_f32_16x16x32_bf16 v[192:195], v[28:31], v[40:43], v[192:195]
    v_mfma_f32_16x16x32_bf16 v[208:211], v[12:15], v[44:47], v[208:211]
    v_mfma_f32_16x16x32_bf16 v[196:199], v[32:35], v[40:43], v[196:199]
    v_mfma_f32_16x16x32_bf16 v[212:215], v[16:19], v[44:47], v[212:215]
    s_nop 0
    v_mul_f32 v240, v184, v48
    v_mul_f32 v241, v200, v48
    v_fmac_f32 v240, v200, v52
    v_fma_f32 v200, -v184, v52, v241
    v_mov_b32 v184, v240
    v_mul_f32 v242, v185, v49
    v_mul_f32 v243, v201, v49
    v_fmac_f32 v242, v201, v53
    v_fma_f32 v201, -v185, v53, v243
    v_mov_b32 v185, v242
    v_mul_f32 v240, v186, v50
    v_mul_f32 v241, v202, v50
    v_fmac_f32 v240, v202, v54
    v_fma_f32 v202, -v186, v54, v241
    v_mov_b32 v186, v240
    v_mul_f32 v242, v187, v51
    v_mul_f32 v243, v203, v51
    v_fmac_f32 v242, v203, v55
    v_fma_f32 v203, -v187, v55, v243
    v_mov_b32 v187, v242
    v_mul_f32 v240, v188, v56
    v_mul_f32 v241, v204, v56
    v_fmac_f32 v240, v204, v60
    v_fma_f32 v204, -v188, v60, v241
    v_mov_b32 v188, v240
    v_mul_f32 v242, v189, v57
    v_mul_f32 v243, v205, v57
    v_fmac_f32 v242, v205, v61
    v_fma_f32 v205, -v189, v61, v243
    v_mov_b32 v189, v242
    v_mul_f32 v240, v190, v58
    v_mul_f32 v241, v206, v58
    v_fmac_f32 v240, v206, v62
    v_fma_f32 v206, -v190, v62, v241
    v_mov_b32 v190, v240
    v_mul_f32 v242, v191, v59
    v_mul_f32 v243, v207, v59
    v_fmac_f32 v242, v207, v63
    v_fma_f32 v207, -v191, v63, v243
    v_mov_b32 v191, v242
    v_mul_f32 v240, v192, v64
    v_mul_f32 v241, v208, v64
    v_fmac_f32 v240, v208, v68
    v_fma_f32 v208, -v192, v68, v241
    v_mov_b32 v192, v240
    v_mul_f32 v242, v193, v65
    v_mul_f32 v243, v209, v65
    v_fmac_f32 v242, v209, v69
    v_fma_f32 v209, -v193, v69, v243
    v_mov_b32 v193, v242
    v_mul_f32 v240, v194, v66
    v_mul_f32 v241, v210, v66
    v_fmac_f32 v240, v210, v70
    v_fma_f32 v210, -v194, v70, v241
    v_mov_b32 v194, v240
    v_mul_f32 v242, v195, v67
    v_mul_f32 v243, v211, v67
    v_fmac_f32 v242, v211, v71
    v_fma_f32 v211, -v195, v71, v243
    v_mov_b32 v195, v242
    v_mul_f32 v240, v196, v72
    v_mul_f32 v241, v212, v72
    v_fmac_f32 v240, v212, v76
    v_fma_f32 v212, -v196, v76, v241
    v_mov_b32 v196, v240
    v_mul_f32 v242, v197, v73
    v_mul_f32 v243, v213, v73
    v_fmac_f32 v242, v213, v77
    v_fma_f32 v213, -v197, v77, v243
    v_mov_b32 v197, v242
    v_mul_f32 v240, v198, v74
    v_mul_f32 v241, v214, v74
    v_fmac_f32 v240, v214, v78
    v_fma_f32 v214, -v198, v78, v241
    v_mov_b32 v198, v240
    v_mul_f32 v242, v199, v75
    v_mul_f32 v243, v215, v75
    v_fmac_f32 v242, v215, v79
    v_fma_f32 v215, -v199, v79, v243
    v_mov_b32 v199, v242
    v_cvt_pk_bf16_f32 v216, v184, v185
    v_cvt_pk_bf16_f32 v217, v186, v187
    v_cvt_pk_bf16_f32 v218, v188, v189
    v_cvt_pk_bf16_f32 v219, v190, v191
    v_cvt_pk_bf16_f32 v220, v200, v201
    v_cvt_pk_bf16_f32 v221, v202, v203
    v_cvt_pk_bf16_f32 v222, v204, v205
    v_cvt_pk_bf16_f32 v223, v206, v207
    v_xor_b32 v224, 0x80008000, v216
    v_xor_b32 v225, 0x80008000, v217
    v_xor_b32 v226, 0x80008000, v218
    v_xor_b32 v227, 0x80008000, v219
    v_cvt_pk_bf16_f32 v228, v192, v193
    v_cvt_pk_bf16_f32 v229, v194, v195
    v_cvt_pk_bf16_f32 v230, v196, v197
    v_cvt_pk_bf16_f32 v231, v198, v199
    v_cvt_pk_bf16_f32 v232, v208, v209
    v_cvt_pk_bf16_f32 v233, v210, v211
    v_cvt_pk_bf16_f32 v234, v212, v213
    v_cvt_pk_bf16_f32 v235, v214, v215
    v_xor_b32 v236, 0x80008000, v228
    v_xor_b32 v237, 0x80008000, v229
    v_xor_b32 v238, 0x80008000, v230
    v_xor_b32 v239, 0x80008000, v231
    v_mov_b64 v[184:185], 0
    v_mov_b64 v[186:187], 0
    v_mov_b64 v[188:189], 0
    v_mov_b64 v[190:191], 0
    v_mov_b64 v[192:193], 0
    v_mov_b64 v[194:195], 0
    v_mov_b64 v[196:197], 0
    v_mov_b64 v[198:199], 0
    v_mov_b64 v[200:201], 0
    v_mov_b64 v[202:203], 0
    v_mov_b64 v[204:205], 0
    v_mov_b64 v[206:207], 0
    v_mov_b64 v[208:209], 0
    v_mov_b64 v[210:211], 0
    v_mov_b64 v[212:213], 0
    v_mov_b64 v[214:215], 0
    v_mfma_f32_16x16x32_bf16 v[184:187], v[80:83], v[216:219], v[184:187]
    v_mfma_f32_16x16x32_bf16 v[200:203], v[80:83], v[220:223], v[200:203]
    v_mfma_f32_16x16x32_bf16 v[184:187], v[84:87], v[228:231], v[184:187]
    v_mfma_f32_16x16x32_bf16 v[200:203], v[84:87], v[232:235], v[200:203]
    v_mfma_f32_16x16x32_bf16 v[184:187], v[112:115], v[220:223], v[184:187]
    v_mfma_f32_16x16x32_bf16 v[200:203], v[112:115], v[224:227], v[200:203]
    v_mfma_f32_16x16x32_bf16 v[184:187], v[116:119], v[232:235], v[184:187]
    v_mfma_f32_16x16x32_bf16 v[200:203], v[116:119], v[236:239], v[200:203]
    v_mfma_f32_16x16x32_bf16 v[188:191], v[88:91], v[216:219], v[188:191]
    v_mfma_f32_16x16x32_bf16 v[204:207], v[88:91], v[220:223], v[204:207]
    v_mfma_f32_16x16x32_bf16 v[188:191], v[92:95], v[228:231], v[188:191]
    v_mfma_f32_16x16x32_bf16 v[204:207], v[92:95], v[232:235], v[204:207]
    v_mfma_f32_16x16x32_bf16 v[188:191], v[120:123], v[220:223], v[188:191]
    v_mfma_f32_16x16x32_bf16 v[204:207], v[120:123], v[224:227], v[204:207]
    v_mfma_f32_16x16x32_bf16 v[188:191], v[124:127], v[232:235], v[188:191]
    v_mfma_f32_16x16x32_bf16 v[204:207], v[124:127], v[236:239], v[204:207]
    v_mfma_f32_16x16x32_bf16 v[192:195], v[96:99], v[216:219], v[192:195]
    v_mfma_f32_16x16x32_bf16 v[208:211], v[96:99], v[220:223], v[208:211]
    v_mfma_f32_16x16x32_bf16 v[192:195], v[100:103], v[228:231], v[192:195]
    v_mfma_f32_16x16x32_bf16 v[208:211], v[100:103], v[232:235], v[208:211]
    v_mfma_f32_16x16x32_bf16 v[192:195], v[128:131], v[220:223], v[192:195]
    v_mfma_f32_16x16x32_bf16 v[208:211], v[128:131], v[224:227], v[208:211]
    v_mfma_f32_16x16x32_bf16 v[192:195], v[132:135], v[232:235], v[192:195]
    v_mfma_f32_16x16x32_bf16 v[208:211], v[132:135], v[236:239], v[208:211]
    v_mfma_f32_16x16x32_bf16 v[196:199], v[104:107], v[216:219], v[196:199]
    v_mfma_f32_16x16x32_bf16 v[212:215], v[104:107], v[220:223], v[212:215]
    v_mfma_f32_16x16x32_bf16 v[196:199], v[108:111], v[228:231], v[196:199]
    v_mfma_f32_16x16x32_bf16 v[212:215], v[108:111], v[232:235], v[212:215]
    v_mfma_f32_16x16x32_bf16 v[196:199], v[136:139], v[220:223], v[196:199]
    v_mfma_f32_16x16x32_bf16 v[212:215], v[136:139], v[224:227], v[212:215]
    v_mfma_f32_16x16x32_bf16 v[196:199], v[140:143], v[232:235], v[196:199]
    v_mfma_f32_16x16x32_bf16 v[212:215], v[140:143], v[236:239], v[212:215]
    v_lshlrev_b32 v240, 16, v144
    v_and_b32 v241, 0xffff0000, v144
    v_mul_f32 v242, v184, v240
    v_mul_f32 v243, v200, v240
    v_fma_f32 v242, -v200, v241, v242
    v_fma_f32 v200, v184, v241, v243
    v_mov_b32 v184, v242
    v_lshlrev_b32 v244, 16, v145
    v_and_b32 v245, 0xffff0000, v145
    v_mul_f32 v246, v185, v244
    v_mul_f32 v247, v201, v244
    v_fma_f32 v246, -v201, v245, v246
    v_fma_f32 v201, v185, v245, v247
    v_mov_b32 v185, v246
    v_lshlrev_b32 v240, 16, v146
    v_and_b32 v241, 0xffff0000, v146
    v_mul_f32 v242, v186, v240
    v_mul_f32 v243, v202, v240
    v_fma_f32 v242, -v202, v241, v242
    v_fma_f32 v202, v186, v241, v243
    v_mov_b32 v186, v242
    v_lshlrev_b32 v244, 16, v147
    v_and_b32 v245, 0xffff0000, v147
    v_mul_f32 v246, v187, v244
    v_mul_f32 v247, v203, v244
    v_fma_f32 v246, -v203, v245, v246
    v_fma_f32 v203, v187, v245, v247
    v_mov_b32 v187, v246
    v_lshlrev_b32 v240, 16, v148
    v_and_b32 v241, 0xffff0000, v148
    v_mul_f32 v242, v188, v240
    v_mul_f32 v243, v204, v240
    v_fma_f32 v242, -v204, v241, v242
    v_fma_f32 v204, v188, v241, v243
    v_mov_b32 v188, v242
    v_lshlrev_b32 v244, 16, v149
    v_and_b32 v245, 0xffff0000, v149
    v_mul_f32 v246, v189, v244
    v_mul_f32 v247, v205, v244
    v_fma_f32 v246, -v205, v245, v246
    v_fma_f32 v205, v189, v245, v247
    v_mov_b32 v189, v246
    v_lshlrev_b32 v240, 16, v150
    v_and_b32 v241, 0xffff0000, v150
    v_mul_f32 v242, v190, v240
    v_mul_f32 v243, v206, v240
    v_fma_f32 v242, -v206, v241, v242
    v_fma_f32 v206, v190, v241, v243
    v_mov_b32 v190, v242
    v_lshlrev_b32 v244, 16, v151
    v_and_b32 v245, 0xffff0000, v151
    v_mul_f32 v246, v191, v244
    v_mul_f32 v247, v207, v244
    v_fma_f32 v246, -v207, v245, v246
    v_fma_f32 v207, v191, v245, v247
    v_mov_b32 v191, v246
    v_lshlrev_b32 v240, 16, v152
    v_and_b32 v241, 0xffff0000, v152
    v_mul_f32 v242, v192, v240
    v_mul_f32 v243, v208, v240
    v_fma_f32 v242, -v208, v241, v242
    v_fma_f32 v208, v192, v241, v243
    v_mov_b32 v192, v242
    v_lshlrev_b32 v244, 16, v153
    v_and_b32 v245, 0xffff0000, v153
    v_mul_f32 v246, v193, v244
    v_mul_f32 v247, v209, v244
    v_fma_f32 v246, -v209, v245, v246
    v_fma_f32 v209, v193, v245, v247
    v_mov_b32 v193, v246
    v_lshlrev_b32 v240, 16, v154
    v_and_b32 v241, 0xffff0000, v154
    v_mul_f32 v242, v194, v240
    v_mul_f32 v243, v210, v240
    v_fma_f32 v242, -v210, v241, v242
    v_fma_f32 v210, v194, v241, v243
    v_mov_b32 v194, v242
    v_lshlrev_b32 v244, 16, v155
    v_and_b32 v245, 0xffff0000, v155
    v_mul_f32 v246, v195, v244
    v_mul_f32 v247, v211, v244
    v_fma_f32 v246, -v211, v245, v246
    v_fma_f32 v211, v195, v245, v247
    v_mov_b32 v195, v246
    v_lshlrev_b32 v240, 16, v156
    v_and_b32 v241, 0xffff0000, v156
    v_mul_f32 v242, v196, v240
    v_mul_f32 v243, v212, v240
    v_fma_f32 v242, -v212, v241, v242
    v_fma_f32 v212, v196, v241, v243
    v_mov_b32 v196, v242
    v_lshlrev_b32 v244, 16, v157
    v_and_b32 v245, 0xffff0000, v157
    v_mul_f32 v246, v197, v244
    v_mul_f32 v247, v213, v244
    v_fma_f32 v246, -v213, v245, v246
    v_fma_f32 v213, v197, v245, v247
    v_mov_b32 v197, v246
    v_lshlrev_b32 v240, 16, v158
    v_and_b32 v241, 0xffff0000, v158
    v_mul_f32 v242, v198, v240
    v_mul_f32 v243, v214, v240
    v_fma_f32 v242, -v214, v241, v242
    v_fma_f32 v214, v198, v241, v243
    v_mov_b32 v198, v242
    v_lshlrev_b32 v244, 16, v159
    v_and_b32 v245, 0xffff0000, v159
    v_mul_f32 v246, v199, v244
    v_mul_f32 v247, v215, v244
    v_fma_f32 v246, -v215, v245, v246
    v_fma_f32 v215, v199, v245, v247
    v_mov_b32 v199, v246
    v_cvt_pk_bf16_f32 v216, v184, v185
    v_cvt_pk_bf16_f32 v217, v186, v187
    v_cvt_pk_bf16_f32 v218, v188, v189
    v_cvt_pk_bf16_f32 v219, v190, v191
    v_cvt_pk_bf16_f32 v220, v200, v201
    v_cvt_pk_bf16_f32 v221, v202, v203
    v_cvt_pk_bf16_f32 v222, v204, v205
    v_cvt_pk_bf16_f32 v223, v206, v207
    v_xor_b32 v224, 0x80008000, v220
    v_xor_b32 v225, 0x80008000, v221
    v_xor_b32 v226, 0x80008000, v222
    v_xor_b32 v227, 0x80008000, v223
    v_cvt_pk_bf16_f32 v228, v192, v193
    v_cvt_pk_bf16_f32 v229, v194, v195
    v_cvt_pk_bf16_f32 v230, v196, v197
    v_cvt_pk_bf16_f32 v231, v198, v199
    v_cvt_pk_bf16_f32 v232, v208, v209
    v_cvt_pk_bf16_f32 v233, v210, v211
    v_cvt_pk_bf16_f32 v234, v212, v213
    v_cvt_pk_bf16_f32 v235, v214, v215
    v_xor_b32 v236, 0x80008000, v232
    v_xor_b32 v237, 0x80008000, v233
    v_xor_b32 v238, 0x80008000, v234
    v_xor_b32 v239, 0x80008000, v235
    v_mov_b64 v[184:185], 0
    v_mov_b64 v[186:187], 0
    v_mov_b64 v[188:189], 0
    v_mov_b64 v[190:191], 0
    v_mov_b64 v[192:193], 0
    v_mov_b64 v[194:195], 0
    v_mov_b64 v[196:197], 0
    v_mov_b64 v[198:199], 0
    v_mov_b64 v[200:201], 0
    v_mov_b64 v[202:203], 0
    v_mov_b64 v[204:205], 0
    v_mov_b64 v[206:207], 0
    v_mov_b64 v[208:209], 0
    v_mov_b64 v[210:211], 0
    v_mov_b64 v[212:213], 0
    v_mov_b64 v[214:215], 0
    v_mfma_f32_16x16x32_bf16 v[184:187], v[80:83], v[216:219], v[184:187]
    v_mfma_f32_16x16x32_bf16 v[200:203], v[80:83], v[220:223], v[200:203]
    v_mfma_f32_16x16x32_bf16 v[184:187], v[84:87], v[228:231], v[184:187]
    v_mfma_f32_16x16x32_bf16 v[200:203], v[84:87], v[232:235], v[200:203]
    v_mfma_f32_16x16x32_bf16 v[184:187], v[112:115], v[224:227], v[184:187]
    v_mfma_f32_16x16x32_bf16 v[200:203], v[112:115], v[216:219], v[200:203]
    v_mfma_f32_16x16x32_bf16 v[184:187], v[116:119], v[236:239], v[184:187]
    v_mfma_f32_16x16x32_bf16 v[200:203], v[116:119], v[228:231], v[200:203]
    v_mfma_f32_16x16x32_bf16 v[188:191], v[88:91], v[216:219], v[188:191]
    v_mfma_f32_16x16x32_bf16 v[204:207], v[88:91], v[220:223], v[204:207]
    v_mfma_f32_16x16x32_bf16 v[188:191], v[92:95], v[228:231], v[188:191]
    v_mfma_f32_16x16x32_bf16 v[204:207], v[92:95], v[232:235], v[204:207]
    v_mfma_f32_16x16x32_bf16 v[188:191], v[120:123], v[224:227], v[188:191]
    v_mfma_f32_16x16x32_bf16 v[204:207], v[120:123], v[216:219], v[204:207]
    v_mfma_f32_16x16x32_bf16 v[188:191], v[124:127], v[236:239], v[188:191]
    v_mfma_f32_16x16x32_bf16 v[204:207], v[124:127], v[228:231], v[204:207]
    v_mfma_f32_16x16x32_bf16 v[192:195], v[96:99], v[216:219], v[192:195]
    v_mfma_f32_16x16x32_bf16 v[208:211], v[96:99], v[220:223], v[208:211]
    v_mfma_f32_16x16x32_bf16 v[192:195], v[100:103], v[228:231], v[192:195]
    v_mfma_f32_16x16x32_bf16 v[208:211], v[100:103], v[232:235], v[208:211]
    v_mfma_f32_16x16x32_bf16 v[192:195], v[128:131], v[224:227], v[192:195]
    v_mfma_f32_16x16x32_bf16 v[208:211], v[128:131], v[216:219], v[208:211]
    v_mfma_f32_16x16x32_bf16 v[192:195], v[132:135], v[236:239], v[192:195]
    v_mfma_f32_16x16x32_bf16 v[208:211], v[132:135], v[228:231], v[208:211]
    v_mfma_f32_16x16x32_bf16 v[196:199], v[104:107], v[216:219], v[196:199]
    v_mfma_f32_16x16x32_bf16 v[212:215], v[104:107], v[220:223], v[212:215]
    v_mfma_f32_16x16x32_bf16 v[196:199], v[108:111], v[228:231], v[196:199]
    v_mfma_f32_16x16x32_bf16 v[212:215], v[108:111], v[232:235], v[212:215]
    v_mfma_f32_16x16x32_bf16 v[196:199], v[136:139], v[224:227], v[196:199]
    v_mfma_f32_16x16x32_bf16 v[212:215], v[136:139], v[216:219], v[212:215]
    v_mfma_f32_16x16x32_bf16 v[196:199], v[140:143], v[236:239], v[196:199]
    v_mfma_f32_16x16x32_bf16 v[212:215], v[140:143], v[228:231], v[212:215]
    v_mul_f32 v240, v184, v48
    v_mul_f32 v241, v200, v48
    v_fma_f32 v240, -v200, v52, v240
    v_fma_f32 v200, v184, v52, v241
    v_mov_b32 v184, v240
    v_mul_f32 v242, v185, v49
    v_mul_f32 v243, v201, v49
    v_fma_f32 v242, -v201, v53, v242
    v_fma_f32 v201, v185, v53, v243
    v_mov_b32 v185, v242
    v_mul_f32 v240, v186, v50
    v_mul_f32 v241, v202, v50
    v_fma_f32 v240, -v202, v54, v240
    v_fma_f32 v202, v186, v54, v241
    v_mov_b32 v186, v240
    v_mul_f32 v242, v187, v51
    v_mul_f32 v243, v203, v51
    v_fma_f32 v242, -v203, v55, v242
    v_fma_f32 v203, v187, v55, v243
    v_mov_b32 v187, v242
    v_mul_f32 v240, v188, v56
    v_mul_f32 v241, v204, v56
    v_fma_f32 v240, -v204, v60, v240
    v_fma_f32 v204, v188, v60, v241
    v_mov_b32 v188, v240
    v_mul_f32 v242, v189, v57
    v_mul_f32 v243, v205, v57
    v_fma_f32 v242, -v205, v61, v242
    v_fma_f32 v205, v189, v61, v243
    v_mov_b32 v189, v242
    v_mul_f32 v240, v190, v58
    v_mul_f32 v241, v206, v58
    v_fma_f32 v240, -v206, v62, v240
    v_fma_f32 v206, v190, v62, v241
    v_mov_b32 v190, v240
    v_mul_f32 v242, v191, v59
    v_mul_f32 v243, v207, v59
    v_fma_f32 v242, -v207, v63, v242
    v_fma_f32 v207, v191, v63, v243
    v_mov_b32 v191, v242
    v_mul_f32 v240, v192, v64
    v_mul_f32 v241, v208, v64
    v_fma_f32 v240, -v208, v68, v240
    v_fma_f32 v208, v192, v68, v241
    v_mov_b32 v192, v240
    v_mul_f32 v242, v193, v65
    v_mul_f32 v243, v209, v65
    v_fma_f32 v242, -v209, v69, v242
    v_fma_f32 v209, v193, v69, v243
    v_mov_b32 v193, v242
    v_mul_f32 v240, v194, v66
    v_mul_f32 v241, v210, v66
    v_fma_f32 v240, -v210, v70, v240
    v_fma_f32 v210, v194, v70, v241
    v_mov_b32 v194, v240
    v_mul_f32 v242, v195, v67
    v_mul_f32 v243, v211, v67
    v_fma_f32 v242, -v211, v71, v242
    v_fma_f32 v211, v195, v71, v243
    v_mov_b32 v195, v242
    v_mul_f32 v240, v196, v72
    v_mul_f32 v241, v212, v72
    v_fma_f32 v240, -v212, v76, v240
    v_fma_f32 v212, v196, v76, v241
    v_mov_b32 v196, v240
    v_mul_f32 v242, v197, v73
    v_mul_f32 v243, v213, v73
    v_fma_f32 v242, -v213, v77, v242
    v_fma_f32 v213, v197, v77, v243
    v_mov_b32 v197, v242
    v_mul_f32 v240, v198, v74
    v_mul_f32 v241, v214, v74
    v_fma_f32 v240, -v214, v78, v240
    v_fma_f32 v214, v198, v78, v241
    v_mov_b32 v198, v240
    v_mul_f32 v242, v199, v75
    v_mul_f32 v243, v215, v75
    v_fma_f32 v242, -v215, v79, v242
    v_fma_f32 v215, v199, v79, v243
    v_mov_b32 v199, v242
    v_and_b32 v1, 15, v0
    s_lshl_b32 s16, s14, 4
    v_add_u32 v1, s16, v1
    v_mul_u32_u24 v1, 144, v1
    v_lshrrev_b32 v4, 4, v0
    v_lshl_add_u32 v1, v4, 3, v1
    s_mul_i32 s17, s13, 9216
    v_add_u32 v1, s17, v1
    v_cvt_pk_bf16_f32 v240, v184, v185
    v_cvt_pk_bf16_f32 v241, v186, v187
    ds_write_b64 v1, v[240:241] offset:0
    v_cvt_pk_bf16_f32 v242, v188, v189
    v_cvt_pk_bf16_f32 v243, v190, v191
    ds_write_b64 v1, v[242:243] offset:32
    v_cvt_pk_bf16_f32 v240, v192, v193
    v_cvt_pk_bf16_f32 v241, v194, v195
    ds_write_b64 v1, v[240:241] offset:64
    v_cvt_pk_bf16_f32 v242, v196, v197
    v_cvt_pk_bf16_f32 v243, v198, v199
    ds_write_b64 v1, v[242:243] offset:96
    v_cvt_pk_bf16_f32 v240, v200, v201
    v_cvt_pk_bf16_f32 v241, v202, v203
    ds_write_b64 v1, v[240:241] offset:4608
    v_cvt_pk_bf16_f32 v242, v204, v205
    v_cvt_pk_bf16_f32 v243, v206, v207
    ds_write_b64 v1, v[242:243] offset:4640
    v_cvt_pk_bf16_f32 v240, v208, v209
    v_cvt_pk_bf16_f32 v241, v210, v211
    ds_write_b64 v1, v[240:241] offset:4672
    v_cvt_pk_bf16_f32 v242, v212, v213
    v_cvt_pk_bf16_f32 v243, v214, v215
    ds_write_b64 v1, v[242:243] offset:4704
    s_waitcnt lgkmcnt(0)
    s_barrier
    v_lshrrev_b32 v1, 4, v0
    v_lshlrev_b32 v1, 3, v1
    v_bfe_u32 v4, v0, 2, 2
    v_add_u32 v1, v1, v4
    v_mul_u32_u24 v1, 144, v1
    v_and_b32 v4, 3, v0
    v_lshl_add_u32 v1, v4, 4, v1
    s_lshl_b32 s16, s14, 6
    s_add_u32 s16, s16, s17
    v_add_u32 v1, s16, v1
    ds_read_b64_tr_b16 v[4:5], v1 offset:0
    ds_read_b64_tr_b16 v[6:7], v1 offset:576
    ds_read_b64_tr_b16 v[8:9], v1 offset:8
    ds_read_b64_tr_b16 v[10:11], v1 offset:584
    ds_read_b64_tr_b16 v[12:13], v1 offset:4608
    ds_read_b64_tr_b16 v[14:15], v1 offset:5184
    ds_read_b64_tr_b16 v[16:17], v1 offset:4616
    ds_read_b64_tr_b16 v[18:19], v1 offset:5192
    v_mov_b64 v[184:185], 0
    v_mov_b64 v[186:187], 0
    v_mov_b64 v[188:189], 0
    v_mov_b64 v[190:191], 0
    v_mov_b64 v[192:193], 0
    v_mov_b64 v[194:195], 0
    v_mov_b64 v[196:197], 0
    v_mov_b64 v[198:199], 0
    v_mov_b64 v[200:201], 0
    v_mov_b64 v[202:203], 0
    v_mov_b64 v[204:205], 0
    v_mov_b64 v[206:207], 0
    v_mov_b64 v[208:209], 0
    v_mov_b64 v[210:211], 0
    v_mov_b64 v[212:213], 0
    v_mov_b64 v[214:215], 0
    s_waitcnt vmcnt(0) lgkmcnt(0)
    v_mfma_f32_16x16x32_bf16 v[184:187], v[4:7], v[160:163], v[184:187]
    v_mfma_f32_16x16x32_bf16 v[188:191], v[8:11], v[160:163], v[188:191]
    v_mfma_f32_16x16x32_bf16 v[192:195], v[4:7], v[172:175], v[192:195]
    v_mfma_f32_16x16x32_bf16 v[196:199], v[8:11], v[172:175], v[196:199]
    v_mfma_f32_16x16x32_bf16 v[200:203], v[12:15], v[160:163], v[200:203]
    v_mfma_f32_16x16x32_bf16 v[204:207], v[16:19], v[160:163], v[204:207]
    v_mfma_f32_16x16x32_bf16 v[208:211], v[12:15], v[172:175], v[208:211]
    v_mfma_f32_16x16x32_bf16 v[212:215], v[16:19], v[172:175], v[212:215]
    v_mfma_f32_16x16x32_bf16 v[184:187], v[12:15], v[168:171], v[184:187]
    v_mfma_f32_16x16x32_bf16 v[188:191], v[16:19], v[168:171], v[188:191]
    v_mfma_f32_16x16x32_bf16 v[192:195], v[12:15], v[180:183], v[192:195]
    v_mfma_f32_16x16x32_bf16 v[196:199], v[16:19], v[180:183], v[196:199]
    v_mfma_f32_16x16x32_bf16 v[200:203], v[4:7], v[164:167], v[200:203]
    v_mfma_f32_16x16x32_bf16 v[204:207], v[8:11], v[164:167], v[204:207]
    v_mfma_f32_16x16x32_bf16 v[208:211], v[4:7], v[176:179], v[208:211]
    v_mfma_f32_16x16x32_bf16 v[212:215], v[8:11], v[176:179], v[212:215]
    s_cmp_ge_u32 s12, 225
    s_cbranch_scc1 F2_end
    v_and_b32 v3, 15, v0
    v_lshlrev_b32 v3, 7, v3
    v_lshrrev_b32 v4, 4, v0
    v_lshl_add_u32 v3, v4, 4, v3
    s_lshl_b32 s15, s12, 12
    s_add_u32 s15, s15, 71929856
    s_lshl_b32 s16, s14, 6
    s_add_u32 s15, s15, s16
    v_cvt_pk_bf16_f32 v216, v184, v185
    v_cvt_pk_bf16_f32 v217, v186, v187
    v_cvt_pk_bf16_f32 v218, v188, v189
    v_cvt_pk_bf16_f32 v219, v190, v191
    buffer_store_dwordx4 v[216:219], v3, s[4:7], s15 offen offset:0 sc1
    v_cvt_pk_bf16_f32 v220, v192, v193
    v_cvt_pk_bf16_f32 v221, v194, v195
    v_cvt_pk_bf16_f32 v222, v196, v197
    v_cvt_pk_bf16_f32 v223, v198, v199
    buffer_store_dwordx4 v[220:223], v3, s[4:7], s15 offen offset:2048 sc1
    s_add_u32 s15, s15, 1048576
    v_cvt_pk_bf16_f32 v224, v200, v201
    v_cvt_pk_bf16_f32 v225, v202, v203
    v_cvt_pk_bf16_f32 v226, v204, v205
    v_cvt_pk_bf16_f32 v227, v206, v207
    buffer_store_dwordx4 v[224:227], v3, s[4:7], s15 offen offset:0 sc1
    v_cvt_pk_bf16_f32 v228, v208, v209
    v_cvt_pk_bf16_f32 v229, v210, v211
    v_cvt_pk_bf16_f32 v230, v212, v213
    v_cvt_pk_bf16_f32 v231, v214, v215
    buffer_store_dwordx4 v[228:231], v3, s[4:7], s15 offen offset:2048 sc1
F2_end:
    s_waitcnt vmcnt(0)
    s_barrier
    s_cmp_eq_u32 s76, 0
    s_cbranch_scc0 K_ff2
    s_lshl_b32 s53, s64, 4
    s_add_u32 s53, s53, 78630912
    s_mov_b64 exec, 1
    v_mov_b32 v2, 1
    buffer_store_dword v2, off, s[4:7], s53 sc1
    s_mov_b64 exec, -1
K_ff2:
K_nof2:
    s_cmp_lt_u32 s64, 64
    s_cbranch_scc0 K_nof3
    v_accvgpr_read_b32 v0, a255
    s_mov_b32 s14, s76
    v_and_b32 v0, 63, v0
    s_mov_b32 s12, s64
    v_lshlrev_b32 v2, 4, v0
    s_mul_i32 s20, s14, 15360
    s_add_u32 s20, s20, 26148864
    s_add_u32 s19, s20, 0
    buffer_load_dwordx4 v[176:179], v2, s[56:59], s19 offen sc1
    s_add_u32 s19, s20, 61440
    buffer_load_dwordx4 v[180:183], v2, s[56:59], s19 offen sc1
    s_add_u32 s19, s20, 122880
    buffer_load_dwordx4 v[184:187], v2, s[56:59], s19 offen sc1
    s_add_u32 s19, s20, 184320
    buffer_load_dwordx4 v[188:191], v2, s[56:59], s19 offen sc1
    s_add_u32 s19, s20, 1024
    buffer_load_dwordx4 v[192:195], v2, s[56:59], s19 offen sc1
    s_add_u32 s19, s20, 62464
    buffer_load_dwordx4 v[196:199], v2, s[56:59], s19 offen sc1
    s_add_u32 s19, s20, 123904
    buffer_load_dwordx4 v[200:203], v2, s[56:59], s19 offen sc1
    s_add_u32 s19, s20, 185344
    buffer_load_dwordx4 v[204:207], v2, s[56:59], s19 offen sc1
    s_add_u32 s19, s20, 2048
    buffer_load_dwordx4 v[208:211], v2, s[56:59], s19 offen sc1
    s_add_u32 s19, s20, 63488
    buffer_load_dwordx4 v[212:215], v2, s[56:59], s19 offen sc1
    s_add_u32 s19, s20, 124928
    buffer_load_dwordx4 v[216:219], v2, s[56:59], s19 offen sc1
    s_add_u32 s19, s20, 186368
    buffer_load_dwordx4 v[220:223], v2, s[56:59], s19 offen sc1
    s_add_u32 s19, s20, 3072
    buffer_load_dwordx4 v[224:227], v2, s[56:59], s19 offen sc1
    s_add_u32 s19, s20, 64512
    buffer_load_dwordx4 v[228:231], v2, s[56:59], s19 offen sc1
    s_add_u32 s19, s20, 125952
    buffer_load_dwordx4 v[232:235], v2, s[56:59], s19 offen sc1
    s_add_u32 s19, s20, 187392
    buffer_load_dwordx4 v[236:239], v2, s[56:59], s19 offen sc1
    s_add_u32 s19, s20, 4096
    buffer_load_dwordx4 v[8:11], v2, s[56:59], s19 offen sc1
    s_add_u32 s19, s20, 65536
    buffer_load_dwordx4 v[12:15], v2, s[56:59], s19 offen sc1
    s_add_u32 s19, s20, 126976
    buffer_load_dwordx4 v[16:19], v2, s[56:59], s19 offen sc1
    s_add_u32 s19, s20, 188416
    buffer_load_dwordx4 v[20:23], v2, s[56:59], s19 offen sc1
    s_add_u32 s19, s20, 5120
    buffer_load_dwordx4 v[24:27], v2, s[56:59], s19 offen sc1
    s_add_u32 s19, s20, 66560
    buffer_load_dwordx4 v[28:31], v2, s[56:59], s19 offen sc1
    s_add_u32 s19, s20, 128000
    buffer_load_dwordx4 v[32:35], v2, s[56:59], s19 offen sc1
    s_add_u32 s19, s20, 189440
    buffer_load_dwordx4 v[36:39], v2, s[56:59], s19 offen sc1
    s_add_u32 s19, s20, 6144
    buffer_load_dwordx4 v[40:43], v2, s[56:59], s19 offen sc1
    s_add_u32 s19, s20, 67584
    buffer_load_dwordx4 v[44:47], v2, s[56:59], s19 offen sc1
    s_add_u32 s19, s20, 129024
    buffer_load_dwordx4 v[48:51], v2, s[56:59], s19 offen sc1
    s_add_u32 s19, s20, 190464
    buffer_load_dwordx4 v[52:55], v2, s[56:59], s19 offen sc1
    v_lshrrev_b32 v3, 3, v0
    s_lshl_b32 s17, s14, 3
    v_add_u32 v3, s17, v3
    s_lshl_b32 s17, s12, 5
    v_add_u32 v104, s17, v3
    v_mul_u32_u24 v4, 896, v104
    v_and_b32 v5, 7, v0
    v_lshl_add_u32 v105, v5, 4, v4
    buffer_load_dwordx4 v[64:67], v105, s[8:11], 0 offen offset:0 sc1
    buffer_load_dwordx4 v[68:71], v105, s[8:11], 0 offen offset:128 sc1
    buffer_load_dwordx4 v[72:75], v105, s[8:11], 0 offen offset:256 sc1
    buffer_load_dwordx4 v[76:79], v105, s[8:11], 0 offen offset:384 sc1
    buffer_load_dwordx4 v[80:83], v105, s[8:11], 0 offen offset:512 sc1
    buffer_load_dwordx4 v[84:87], v105, s[8:11], 0 offen offset:640 sc1
    buffer_load_dwordx4 v[88:91], v105, s[8:11], 0 offen offset:768 sc1
    v_mov_b32 v106, v3
    v_mov_b32 v107, v5
    v_mov_b64 v[112:113], 0
    v_mov_b64 v[114:115], 0
    v_mov_b64 v[116:117], 0
    v_mov_b64 v[118:119], 0
    v_mov_b64 v[120:121], 0
    v_mov_b64 v[122:123], 0
    v_mov_b64 v[124:125], 0
    v_mov_b64 v[126:127], 0
    v_mov_b64 v[128:129], 0
    v_mov_b64 v[130:131], 0
    v_mov_b64 v[132:133], 0
    v_mov_b64 v[134:135], 0
    v_mov_b64 v[136:137], 0
    v_mov_b64 v[138:139], 0
    v_mov_b64 v[140:141], 0
    v_mov_b64 v[142:143], 0
    v_mov_b64 v[144:145], 0
    v_mov_b64 v[146:147], 0
    v_mov_b64 v[148:149], 0
    v_mov_b64 v[150:151], 0
    v_mov_b64 v[152:153], 0
    v_mov_b64 v[154:155], 0
    v_mov_b64 v[156:157], 0
    v_mov_b64 v[158:159], 0
    v_mov_b64 v[160:161], 0
    v_mov_b64 v[162:163], 0
    v_mov_b64 v[164:165], 0
    v_mov_b64 v[166:167], 0
    v_mov_b64 v[168:169], 0
    v_mov_b64 v[170:171], 0
    v_mov_b64 v[172:173], 0
    v_mov_b64 v[174:175], 0
    s_waitcnt vmcnt(0)
    s_cmp_eq_u32 s76, 0
    s_cbranch_scc0 K_wf2_ok
    v_mbcnt_lo_u32_b32 v58, -1, 0
    v_mbcnt_hi_u32_b32 v58, -1, v58
    v_add_u32 v59, 0, v58
    v_min_u32 v59, 112, v59
    v_lshlrev_b32 v59, 4, v59
    v_add_u32 v60, 64, v58
    v_min_u32 v60, 112, v60
    v_lshlrev_b32 v60, 4, v60
    s_mov_b32 s53, 78630912
    s_mov_b32 s54, 1048576
K_wf2:
    buffer_load_dword v61, v59, s[4:7], s53 offen sc1
    buffer_load_dword v62, v60, s[4:7], s53 offen sc1
    s_mov_b32 s90, 32
    s_sub_u32 s54, s54, 1
    s_cmp_eq_u32 s54, 0
    s_cbranch_scc1 L_abort1
    s_waitcnt vmcnt(0)
    v_and_b32 v61, v61, v62
    v_cmp_ne_u32 vcc, 1, v61
    s_cbranch_vccz K_wf2_ok
    s_sleep 2
    s_branch K_wf2
K_wf2_ok:
    s_barrier
    v_lshlrev_b32 v2, 4, v0
    v_lshrrev_b32 v58, 2, v0
    v_lshlrev_b32 v58, 12, v58
    v_and_b32 v59, 3, v0
    v_lshl_add_u32 v58, v59, 4, v58
    s_lshl_b32 s15, s12, 6
    s_add_u32 s15, s15, 71929856
    s_cmp_eq_u32 s14, 0
    s_cbranch_scc0 F3_dma0
    s_mov_b32 m0, 0
    s_add_u32 s16, s15, 0
    buffer_load_dwordx4 v58, s[4:7], s16 offen sc1 lds
    s_mov_b32 m0, 4096
    s_add_u32 s16, s15, 262144
    buffer_load_dwordx4 v58, s[4:7], s16 offen sc1 lds
    s_mov_b32 m0, 8192
    s_add_u32 s16, s15, 524288
    buffer_load_dwordx4 v58, s[4:7], s16 offen sc1 lds
    s_mov_b32 m0, 12288
    s_add_u32 s16, s15, 786432
    buffer_load_dwordx4 v58, s[4:7], s16 offen sc1 lds
    s_mov_b32 m0, 16384
    s_add_u32 s16, s15, 1114112
    buffer_load_dwordx4 v58, s[4:7], s16 offen sc1 lds
    s_mov_b32 m0, 20480
    s_add_u32 s16, s15, 1376256
    buffer_load_dwordx4 v58, s[4:7], s16 offen sc1 lds
    s_mov_b32 m0, 24576
    s_add_u32 s16, s15, 1638400
    buffer_load_dwordx4 v58, s[4:7], s16 offen sc1 lds
    s_mov_b32 m0, 28672
    s_add_u32 s16, s15, 1900544
    buffer_load_dwordx4 v58, s[4:7], s16 offen sc1 lds
F3_dma0:
    s_cmp_eq_u32 s14, 1
    s_cbranch_scc0 F3_dma1
    s_mov_b32 m0, 1024
    s_add_u32 s16, s15, 65536
    buffer_load_dwordx4 v58, s[4:7], s16 offen sc1 lds
    s_mov_b32 m0, 5120
    s_add_u32 s16, s15, 327680
    buffer_load_dwordx4 v58, s[4:7], s16 offen sc1 lds
    s_mov_b32 m0, 9216
    s_add_u32 s16, s15, 589824
    buffer_load_dwordx4 v58, s[4:7], s16 offen sc1 lds
    s_mov_b32 m0, 13312
    s_add_u32 s16, s15, 851968
    buffer_load_dwordx4 v58, s[4:7], s16 offen sc1 lds
    s_mov_b32 m0, 17408
    s_add_u32 s16, s15, 1179648
    buffer_load_dwordx4 v58, s[4:7], s16 offen sc1 lds
    s_mov_b32 m0, 21504
    s_add_u32 s16, s15, 1441792
    buffer_load_dwordx4 v58, s[4:7], s16 offen sc1 lds
    s_mov_b32 m0, 25600
    s_add_u32 s16, s15, 1703936
    buffer_load_dwordx4 v58, s[4:7], s16 offen sc1 lds
    s_mov_b32 m0, 29696
    s_add_u32 s16, s15, 1966080
    buffer_load_dwordx4 v58, s[4:7], s16 offen sc1 lds
F3_dma1:
    s_cmp_eq_u32 s14, 2
    s_cbranch_scc0 F3_dma2
    s_mov_b32 m0, 2048
    s_add_u32 s16, s15, 131072
    buffer_load_dwordx4 v58, s[4:7], s16 offen sc1 lds
    s_mov_b32 m0, 6144
    s_add_u32 s16, s15, 393216
    buffer_load_dwordx4 v58, s[4:7], s16 offen sc1 lds
    s_mov_b32 m0, 10240
    s_add_u32 s16, s15, 655360
    buffer_load_dwordx4 v58, s[4:7], s16 offen sc1 lds
    s_mov_b32 m0, 14336
    s_add_u32 s16, s15, 917504
    buffer_load_dwordx4 v58, s[4:7], s16 offen sc1 lds
    s_mov_b32 m0, 18432
    s_add_u32 s16, s15, 1245184
    buffer_load_dwordx4 v58, s[4:7], s16 offen sc1 lds
    s_mov_b32 m0, 22528
    s_add_u32 s16, s15, 1507328
    buffer_load_dwordx4 v58, s[4:7], s16 offen sc1 lds
    s_mov_b32 m0, 26624
    s_add_u32 s16, s15, 1769472
    buffer_load_dwordx4 v58, s[4:7], s16 offen sc1 lds
F3_dma2:
    s_cmp_eq_u32 s14, 3
    s_cbranch_scc0 F3_dma3
    s_mov_b32 m0, 3072
    s_add_u32 s16, s15, 196608
    buffer_load_dwordx4 v58, s[4:7], s16 offen sc1 lds
    s_mov_b32 m0, 7168
    s_add_u32 s16, s15, 458752
    buffer_load_dwordx4 v58, s[4:7], s16 offen sc1 lds
    s_mov_b32 m0, 11264
    s_add_u32 s16, s15, 720896
    buffer_load_dwordx4 v58, s[4:7], s16 offen sc1 lds
    s_mov_b32 m0, 15360
    s_add_u32 s16, s15, 1048576
    buffer_load_dwordx4 v58, s[4:7], s16 offen sc1 lds
    s_mov_b32 m0, 19456
    s_add_u32 s16, s15, 1310720
    buffer_load_dwordx4 v58, s[4:7], s16 offen sc1 lds
    s_mov_b32 m0, 23552
    s_add_u32 s16, s15, 1572864
    buffer_load_dwordx4 v58, s[4:7], s16 offen sc1 lds
    s_mov_b32 m0, 27648
    s_add_u32 s16, s15, 1835008
    buffer_load_dwordx4 v58, s[4:7], s16 offen sc1 lds
F3_dma3:
    v_lshrrev_b32 v6, 4, v0
    v_lshlrev_b32 v6, 3, v6
    v_bfe_u32 v7, v0, 2, 2
    v_add_u32 v6, v6, v7
    v_lshlrev_b32 v6, 6, v6
    v_and_b32 v7, 3, v0
    v_lshl_add_u32 v6, v7, 3, v6
    v_add_u32 v6, 0, v6
    s_waitcnt vmcnt(0)
    s_barrier
    ds_read_b64_tr_b16 v[240:241], v6 offset:0
    ds_read_b64_tr_b16 v[242:243], v6 offset:256
    ds_read_b64_tr_b16 v[244:245], v6 offset:32
    ds_read_b64_tr_b16 v[246:247], v6 offset:288
    ds_read_b64_tr_b16 v[248:249], v6 offset:2048
    ds_read_b64_tr_b16 v[250:251], v6 offset:2304
    ds_read_b64_tr_b16 v[252:253], v6 offset:2080
    ds_read_b64_tr_b16 v[254:255], v6 offset:2336
    s_waitcnt lgkmcnt(4)
    v_mfma_f32_16x16x32_bf16 v[112:115], v[176:179], v[240:243], v[112:115]
    v_mfma_f32_16x16x32_bf16 v[116:119], v[176:179], v[244:247], v[116:119]
    v_mfma_f32_16x16x32_bf16 v[128:131], v[180:183], v[240:243], v[128:131]
    v_mfma_f32_16x16x32_bf16 v[132:135], v[180:183], v[244:247], v[132:135]
    v_mfma_f32_16x16x32_bf16 v[144:147], v[184:187], v[240:243], v[144:147]
    v_mfma_f32_16x16x32_bf16 v[148:151], v[184:187], v[244:247], v[148:151]
    v_mfma_f32_16x16x32_bf16 v[160:163], v[188:191], v[240:243], v[160:163]
    v_mfma_f32_16x16x32_bf16 v[164:167], v[188:191], v[244:247], v[164:167]
    s_add_u32 s19, s20, 7168
    buffer_load_dwordx4 v[176:179], v2, s[56:59], s19 offen sc1
    s_add_u32 s19, s20, 68608
    buffer_load_dwordx4 v[180:183], v2, s[56:59], s19 offen sc1
    s_add_u32 s19, s20, 130048
    buffer_load_dwordx4 v[184:187], v2, s[56:59], s19 offen sc1
    s_add_u32 s19, s20, 191488
    buffer_load_dwordx4 v[188:191], v2, s[56:59], s19 offen sc1
    ds_read_b64_tr_b16 v[240:241], v6 offset:4096
    ds_read_b64_tr_b16 v[242:243], v6 offset:4352
    ds_read_b64_tr_b16 v[244:245], v6 offset:4128
    ds_read_b64_tr_b16 v[246:247], v6 offset:4384
    s_waitcnt lgkmcnt(4)
    v_mfma_f32_16x16x32_bf16 v[112:115], v[192:195], v[248:251], v[112:115]
    v_mfma_f32_16x16x32_bf16 v[116:119], v[192:195], v[252:255], v[116:119]
    v_mfma_f32_16x16x32_bf16 v[128:131], v[196:199], v[248:251], v[128:131]
    v_mfma_f32_16x16x32_bf16 v[132:135], v[196:199], v[252:255], v[132:135]
    v_mfma_f32_16x16x32_bf16 v[144:147], v[200:203], v[248:251], v[144:147]
    v_mfma_f32_16x16x32_bf16 v[148:151], v[200:203], v[252:255], v[148:151]
    v_mfma_f32_16x16x32_bf16 v[160:163], v[204:207], v[248:251], v[160:163]
    v_mfma_f32_16x16x32_bf16 v[164:167], v[204:207], v[252:255], v[164:167]
    s_add_u32 s19, s20, 8192
    buffer_load_dwordx4 v[192:195], v2, s[56:59], s19 offen sc1
    s_add_u32 s19, s20, 69632
    buffer_load_dwordx4 v[196:199], v2, s[56:59], s19 offen sc1
    s_add_u32 s19, s20, 131072
    buffer_load_dwordx4 v[200:203], v2, s[56:59], s19 offen sc1
    s_add_u32 s19, s20, 192512
    buffer_load_dwordx4 v[204:207], v2, s[56:59], s19 offen sc1
    ds_read_b64_tr_b16 v[248:249], v6 offset:6144
    ds_read_b64_tr_b16 v[250:251], v6 offset:6400
    ds_read_b64_tr_b16 v[252:253], v6 offset:6176
    ds_read_b64_tr_b16 v[254:255], v6 offset:6432
    s_waitcnt lgkmcnt(4)
    v_mfma_f32_16x16x32_bf16 v[112:115], v[208:211], v[240:243], v[112:115]
    v_mfma_f32_16x16x32_bf16 v[116:119], v[208:211], v[244:247], v[116:119]
    v_mfma_f32_16x16x32_bf16 v[128:131], v[212:215], v[240:243], v[128:131]
    v_mfma_f32_16x16x32_bf16 v[132:135], v[212:215], v[244:247], v[132:135]
    v_mfma_f32_16x16x32_bf16 v[144:147], v[216:219], v[240:243], v[144:147]
    v_mfma_f32_16x16x32_bf16 v[148:151], v[216:219], v[244:247], v[148:151]
    v_mfma_f32_16x16x32_bf16 v[160:163], v[220:223], v[240:243], v[160:163]
    v_mfma_f32_16x16x32_bf16 v[164:167], v[220:223], v[244:247], v[164:167]
    s_add_u32 s19, s20, 9216
    buffer_load_dwordx4 v[208:211], v2, s[56:59], s19 offen sc1
    s_add_u32 s19, s20, 70656
    buffer_load_dwordx4 v[212:215], v2, s[56:59], s19 offen sc1
    s_add_u32 s19, s20, 132096
    buffer_load_dwordx4 v[216:219], v2, s[56:59], s19 offen sc1
    s_add_u32 s19, s20, 193536
    buffer_load_dwordx4 v[220:223], v2, s[56:59], s19 offen sc1
    ds_read_b64_tr_b16 v[240:241], v6 offset:8192
    ds_read_b64_tr_b16 v[242:243], v6 offset:8448
    ds_read_b64_tr_b16 v[244:245], v6 offset:8224
    ds_read_b64_tr_b16 v[246:247], v6 offset:8480
    s_waitcnt lgkmcnt(4)
    v_mfma_f32_16x16x32_bf16 v[112:115], v[224:227], v[248:251], v[112:115]
    v_mfma_f32_16x16x32_bf16 v[116:119], v[224:227], v[252:255], v[116:119]
    v_mfma_f32_16x16x32_bf16 v[128:131], v[228:231], v[248:251], v[128:131]
    v_mfma_f32_16x16x32_bf16 v[132:135], v[228:231], v[252:255], v[132:135]
    v_mfma_f32_16x16x32_bf16 v[144:147], v[232:235], v[248:251], v[144:147]
    v_mfma_f32_16x16x32_bf16 v[148:151], v[232:235], v[252:255], v[148:151]
    v_mfma_f32_16x16x32_bf16 v[160:163], v[236:239], v[248:251], v[160:163]
    v_mfma_f32_16x16x32_bf16 v[164:167], v[236:239], v[252:255], v[164:167]
    s_add_u32 s19, s20, 10240
    buffer_load_dwordx4 v[224:227], v2, s[56:59], s19 offen sc1
    s_add_u32 s19, s20, 71680
    buffer_load_dwordx4 v[228:231], v2, s[56:59], s19 offen sc1
    s_add_u32 s19, s20, 133120
    buffer_load_dwordx4 v[232:235], v2, s[56:59], s19 offen sc1
    s_add_u32 s19, s20, 194560
    buffer_load_dwordx4 v[236:239], v2, s[56:59], s19 offen sc1
    ds_read_b64_tr_b16 v[248:249], v6 offset:10240
    ds_read_b64_tr_b16 v[250:251], v6 offset:10496
    ds_read_b64_tr_b16 v[252:253], v6 offset:10272
    ds_read_b64_tr_b16 v[254:255], v6 offset:10528
    s_waitcnt lgkmcnt(4)
    v_mfma_f32_16x16x32_bf16 v[112:115], v[8:11], v[240:243], v[112:115]
    v_mfma_f32_16x16x32_bf16 v[116:119], v[8:11], v[244:247], v[116:119]
    v_mfma_f32_16x16x32_bf16 v[128:131], v[12:15], v[240:243], v[128:131]
    v_mfma_f32_16x16x32_bf16 v[132:135], v[12:15], v[244:247], v[132:135]
    v_mfma_f32_16x16x32_bf16 v[144:147], v[16:19], v[240:243], v[144:147]
    v_mfma_f32_16x16x32_bf16 v[148:151], v[16:19], v[244:247], v[148:151]
    v_mfma_f32_16x16x32_bf16 v[160:163], v[20:23], v[240:243], v[160:163]
    v_mfma_f32_16x16x32_bf16 v[164:167], v[20:23], v[244:247], v[164:167]
    s_add_u32 s19, s20, 11264
    buffer_load_dwordx4 v[8:11], v2, s[56:59], s19 offen sc1
    s_add_u32 s19, s20, 72704
    buffer_load_dwordx4 v[12:15], v2, s[56:59], s19 offen sc1
    s_add_u32 s19, s20, 134144
    buffer_load_dwordx4 v[16:19], v2, s[56:59], s19 offen sc1
    s_add_u32 s19, s20, 195584
    buffer_load_dwordx4 v[20:23], v2, s[56:59], s19 offen sc1
    ds_read_b64_tr_b16 v[240:241], v6 offset:12288
    ds_read_b64_tr_b16 v[242:243], v6 offset:12544
    ds_read_b64_tr_b16 v[244:245], v6 offset:12320
    ds_read_b64_tr_b16 v[246:247], v6 offset:12576
    s_waitcnt lgkmcnt(4)
    v_mfma_f32_16x16x32_bf16 v[112:115], v[24:27], v[248:251], v[112:115]
    v_mfma_f32_16x16x32_bf16 v[116:119], v[24:27], v[252:255], v[116:119]
    v_mfma_f32_16x16x32_bf16 v[128:131], v[28:31], v[248:251], v[128:131]
    v_mfma_f32_16x16x32_bf16 v[132:135], v[28:31], v[252:255], v[132:135]
    v_mfma_f32_16x16x32_bf16 v[144:147], v[32:35], v[248:251], v[144:147]
    v_mfma_f32_16x16x32_bf16 v[148:151], v[32:35], v[252:255], v[148:151]
    v_mfma_f32_16x16x32_bf16 v[160:163], v[36:39], v[248:251], v[160:163]
    v_mfma_f32_16x16x32_bf16 v[164:167], v[36:39], v[252:255], v[164:167]
    s_add_u32 s19, s20, 12288
    buffer_load_dwordx4 v[24:27], v2, s[56:59], s19 offen sc1
    s_add_u32 s19, s20, 73728
    buffer_load_dwordx4 v[28:31], v2, s[56:59], s19 offen sc1
    s_add_u32 s19, s20, 135168
    buffer_load_dwordx4 v[32:35], v2, s[56:59], s19 offen sc1
    s_add_u32 s19, s20, 196608
    buffer_load_dwordx4 v[36:39], v2, s[56:59], s19 offen sc1
    ds_read_b64_tr_b16 v[248:249], v6 offset:14336
    ds_read_b64_tr_b16 v[250:251], v6 offset:14592
    ds_read_b64_tr_b16 v[252:253], v6 offset:14368
    ds_read_b64_tr_b16 v[254:255], v6 offset:14624
    s_waitcnt lgkmcnt(4)
    v_mfma_f32_16x16x32_bf16 v[112:115], v[40:43], v[240:243], v[112:115]
    v_mfma_f32_16x16x32_bf16 v[116:119], v[40:43], v[244:247], v[116:119]
    v_mfma_f32_16x16x32_bf16 v[128:131], v[44:47], v[240:243], v[128:131]
    v_mfma_f32_16x16x32_bf16 v[132:135], v[44:47], v[244:247], v[132:135]
    v_mfma_f32_16x16x32_bf16 v[144:147], v[48:51], v[240:243], v[144:147]
    v_mfma_f32_16x16x32_bf16 v[148:151], v[48:51], v[244:247], v[148:151]
    v_mfma_f32_16x16x32_bf16 v[160:163], v[52:55], v[240:243], v[160:163]
    v_mfma_f32_16x16x32_bf16 v[164:167], v[52:55], v[244:247], v[164:167]
    s_add_u32 s19, s20, 13312
    buffer_load_dwordx4 v[40:43], v2, s[56:59], s19 offen sc1
    s_add_u32 s19, s20, 74752
    buffer_load_dwordx4 v[44:47], v2, s[56:59], s19 offen sc1
    s_add_u32 s19, s20, 136192
    buffer_load_dwordx4 v[48:51], v2, s[56:59], s19 offen sc1
    s_add_u32 s19, s20, 197632
    buffer_load_dwordx4 v[52:55], v2, s[56:59], s19 offen sc1
    ds_read_b64_tr_b16 v[240:241], v6 offset:15360
    ds_read_b64_tr_b16 v[242:243], v6 offset:15616
    ds_read_b64_tr_b16 v[244:245], v6 offset:15392
    ds_read_b64_tr_b16 v[246:247], v6 offset:15648
    s_waitcnt vmcnt(24)
    s_waitcnt lgkmcnt(4)
    v_mfma_f32_16x16x32_bf16 v[112:115], v[176:179], v[248:251], v[112:115]
    v_mfma_f32_16x16x32_bf16 v[116:119], v[176:179], v[252:255], v[116:119]
    v_mfma_f32_16x16x32_bf16 v[128:131], v[180:183], v[248:251], v[128:131]
    v_mfma_f32_16x16x32_bf16 v[132:135], v[180:183], v[252:255], v[132:135]
    v_mfma_f32_16x16x32_bf16 v[144:147], v[184:187], v[248:251], v[144:147]
    v_mfma_f32_16x16x32_bf16 v[148:151], v[184:187], v[252:255], v[148:151]
    v_mfma_f32_16x16x32_bf16 v[160:163], v[188:191], v[248:251], v[160:163]
    v_mfma_f32_16x16x32_bf16 v[164:167], v[188:191], v[252:255], v[164:167]
    s_add_u32 s19, s20, 14336
    buffer_load_dwordx4 v[176:179], v2, s[56:59], s19 offen sc1
    s_add_u32 s19, s20, 75776
    buffer_load_dwordx4 v[180:183], v2, s[56:59], s19 offen sc1
    s_add_u32 s19, s20, 137216
    buffer_load_dwordx4 v[184:187], v2, s[56:59], s19 offen sc1
    s_add_u32 s19, s20, 198656
    buffer_load_dwordx4 v[188:191], v2, s[56:59], s19 offen sc1
    ds_read_b64_tr_b16 v[248:249], v6 offset:17408
    ds_read_b64_tr_b16 v[250:251], v6 offset:17664
    ds_read_b64_tr_b16 v[252:253], v6 offset:17440
    ds_read_b64_tr_b16 v[254:255], v6 offset:17696
    s_waitcnt vmcnt(24)
    s_waitcnt lgkmcnt(4)
    v_mfma_f32_16x16x32_bf16 v[120:123], v[192:195], v[240:243], v[120:123]
    v_mfma_f32_16x16x32_bf16 v[124:127], v[192:195], v[244:247], v[124:127]
    v_mfma_f32_16x16x32_bf16 v[136:139], v[196:199], v[240:243], v[136:139]
    v_mfma_f32_16x16x32_bf16 v[140:143], v[196:199], v[244:247], v[140:143]
    v_mfma_f32_16x16x32_bf16 v[152:155], v[200:203], v[240:243], v[152:155]
    v_mfma_f32_16x16x32_bf16 v[156:159], v[200:203], v[244:247], v[156:159]
    v_mfma_f32_16x16x32_bf16 v[168:171], v[204:207], v[240:243], v[168:171]
    v_mfma_f32_16x16x32_bf16 v[172:175], v[204:207], v[244:247], v[172:175]
    ds_read_b64_tr_b16 v[240:241], v6 offset:19456
    ds_read_b64_tr_b16 v[242:243], v6 offset:19712
    ds_read_b64_tr_b16 v[244:245], v6 offset:19488
    ds_read_b64_tr_b16 v[246:247], v6 offset:19744
    s_waitcnt vmcnt(20)
    s_waitcnt lgkmcnt(4)
    v_mfma_f32_16x16x32_bf16 v[120:123], v[208:211], v[248:251], v[120:123]
    v_mfma_f32_16x16x32_bf16 v[124:127], v[208:211], v[252:255], v[124:127]
    v_mfma_f32_16x16x32_bf16 v[136:139], v[212:215], v[248:251], v[136:139]
    v_mfma_f32_16x16x32_bf16 v[140:143], v[212:215], v[252:255], v[140:143]
    v_mfma_f32_16x16x32_bf16 v[152:155], v[216:219], v[248:251], v[152:155]
    v_mfma_f32_16x16x32_bf16 v[156:159], v[216:219], v[252:255], v[156:159]
    v_mfma_f32_16x16x32_bf16 v[168:171], v[220:223], v[248:251], v[168:171]
    v_mfma_f32_16x16x32_bf16 v[172:175], v[220:223], v[252:255], v[172:175]
    ds_read_b64_tr_b16 v[248:249], v6 offset:21504
    ds_read_b64_tr_b16 v[250:251], v6 offset:21760
    ds_read_b64_tr_b16 v[252:253], v6 offset:21536
    ds_read_b64_tr_b16 v[254:255], v6 offset:21792
    s_waitcnt vmcnt(16)
    s_waitcnt lgkmcnt(4)
    v_mfma_f32_16x16x32_bf16 v[120:123], v[224:227], v[240:243], v[120:123]
    v_mfma_f32_16x16x32_bf16 v[124:127], v[224:227], v[244:247], v[124:127]
    v_mfma_f32_16x16x32_bf16 v[136:139], v[228:231], v[240:243], v[136:139]
    v_mfma_f32_16x16x32_bf16 v[140:143], v[228:231], v[244:247], v[140:143]
    v_mfma_f32_16x16x32_bf16 v[152:155], v[232:235], v[240:243], v[152:155]
    v_mfma_f32_16x16x32_bf16 v[156:159], v[232:235], v[244:247], v[156:159]
    v_mfma_f32_16x16x32_bf16 v[168:171], v[236:239], v[240:243], v[168:171]
    v_mfma_f32_16x16x32_bf16 v[172:175], v[236:239], v[244:247], v[172:175]
    ds_read_b64_tr_b16 v[240:241], v6 offset:23552
    ds_read_b64_tr_b16 v[242:243], v6 offset:23808
    ds_read_b64_tr_b16 v[244:245], v6 offset:23584
    ds_read_b64_tr_b16 v[246:247], v6 offset:23840
    s_waitcnt vmcnt(12)
    s_waitcnt lgkmcnt(4)
    v_mfma_f32_16x16x32_bf16 v[120:123], v[8:11], v[248:251], v[120:123]
    v_mfma_f32_16x16x32_bf16 v[124:127], v[8:11], v[252:255], v[124:127]
    v_mfma_f32_16x16x32_bf16 v[136:139], v[12:15], v[248:251], v[136:139]
    v_mfma_f32_16x16x32_bf16 v[140:143], v[12:15], v[252:255], v[140:143]
    v_mfma_f32_16x16x32_bf16 v[152:155], v[16:19], v[248:251], v[152:155]
    v_mfma_f32_16x16x32_bf16 v[156:159], v[16:19], v[252:255], v[156:159]
    v_mfma_f32_16x16x32_bf16 v[168:171], v[20:23], v[248:251], v[168:171]
    v_mfma_f32_16x16x32_bf16 v[172:175], v[20:23], v[252:255], v[172:175]
    ds_read_b64_tr_b16 v[248:249], v6 offset:25600
    ds_read_b64_tr_b16 v[250:251], v6 offset:25856
    ds_read_b64_tr_b16 v[252:253], v6 offset:25632
    ds_read_b64_tr_b16 v[254:255], v6 offset:25888
    s_waitcnt vmcnt(8)
    s_waitcnt lgkmcnt(4)
    v_mfma_f32_16x16x32_bf16 v[120:123], v[24:27], v[240:243], v[120:123]
    v_mfma_f32_16x16x32_bf16 v[124:127], v[24:27], v[244:247], v[124:127]
    v_mfma_f32_16x16x32_bf16 v[136:139], v[28:31], v[240:243], v[136:139]
    v_mfma_f32_16x16x32_bf16 v[140:143], v[28:31], v[244:247], v[140:143]
    v_mfma_f32_16x16x32_bf16 v[152:155], v[32:35], v[240:243], v[152:155]
    v_mfma_f32_16x16x32_bf16 v[156:159], v[32:35], v[244:247], v[156:159]
    v_mfma_f32_16x16x32_bf16 v[168:171], v[36:39], v[240:243], v[168:171]
    v_mfma_f32_16x16x32_bf16 v[172:175], v[36:39], v[244:247], v[172:175]
    ds_read_b64_tr_b16 v[240:241], v6 offset:27648
    ds_read_b64_tr_b16 v[242:243], v6 offset:27904
    ds_read_b64_tr_b16 v[244:245], v6 offset:27680
    ds_read_b64_tr_b16 v[246:247], v6 offset:27936
    s_waitcnt vmcnt(4)
    s_waitcnt lgkmcnt(4)
    v_mfma_f32_16x16x32_bf16 v[120:123], v[40:43], v[248:251], v[120:123]
    v_mfma_f32_16x16x32_bf16 v[124:127], v[40:43], v[252:255], v[124:127]
    v_mfma_f32_16x16x32_bf16 v[136:139], v[44:47], v[248:251], v[136:139]
    v_mfma_f32_16x16x32_bf16 v[140:143], v[44:47], v[252:255], v[140:143]
    v_mfma_f32_16x16x32_bf16 v[152:155], v[48:51], v[248:251], v[152:155]
    v_mfma_f32_16x16x32_bf16 v[156:159], v[48:51], v[252:255], v[156:159]
    v_mfma_f32_16x16x32_bf16 v[168:171], v[52:55], v[248:251], v[168:171]
    v_mfma_f32_16x16x32_bf16 v[172:175], v[52:55], v[252:255], v[172:175]
    s_waitcnt vmcnt(0)
    s_waitcnt lgkmcnt(0)
    v_mfma_f32_16x16x32_bf16 v[120:123], v[176:179], v[240:243], v[120:123]
    v_mfma_f32_16x16x32_bf16 v[124:127], v[176:179], v[244:247], v[124:127]
    v_mfma_f32_16x16x32_bf16 v[136:139], v[180:183], v[240:243], v[136:139]
    v_mfma_f32_16x16x32_bf16 v[140:143], v[180:183], v[244:247], v[140:143]
    v_mfma_f32_16x16x32_bf16 v[152:155], v[184:187], v[240:243], v[152:155]
    v_mfma_f32_16x16x32_bf16 v[156:159], v[184:187], v[244:247], v[156:159]
    v_mfma_f32_16x16x32_bf16 v[168:171], v[188:191], v[240:243], v[168:171]
    v_mfma_f32_16x16x32_bf16 v[172:175], v[188:191], v[244:247], v[172:175]
    v_and_b32 v6, 15, v0
    v_mul_u32_u24 v6, 1808, v6
    v_lshrrev_b32 v7, 4, v0
    s_lshl_b32 s16, s14, 6
    v_lshlrev_b32 v8, 4, v7
    v_add_u32 v8, s16, v8
    v_add_u32 v9, v6, v8
    v_add_u32 v9, 30720, v9
    v_sub_u32 v10, v6, v8
    v_add_u32 v10, 31732, v10
    v_add_f32 v12, v112, v120
    v_sub_f32 v13, v112, v120
    ds_write_b32 v9, v12 offset:0
    ds_write_b32 v10, v13 offset:780
    v_add_f32 v14, v113, v121
    v_sub_f32 v15, v113, v121
    ds_write_b32 v9, v14 offset:4
    ds_write_b32 v10, v15 offset:776
    v_add_f32 v12, v114, v122
    v_sub_f32 v13, v114, v122
    ds_write_b32 v9, v12 offset:8
    ds_write_b32 v10, v13 offset:772
    v_add_f32 v14, v115, v123
    v_sub_f32 v15, v115, v123
    ds_write_b32 v9, v14 offset:12
    ds_write_b32 v10, v15 offset:768
    v_add_f32 v12, v116, v124
    v_sub_f32 v13, v116, v124
    ds_write_b32 v9, v12 offset:28928
    ds_write_b32 v10, v13 offset:29708
    v_add_f32 v14, v117, v125
    v_sub_f32 v15, v117, v125
    ds_write_b32 v9, v14 offset:28932
    ds_write_b32 v10, v15 offset:29704
    v_add_f32 v12, v118, v126
    v_sub_f32 v13, v118, v126
    ds_write_b32 v9, v12 offset:28936
    ds_write_b32 v10, v13 offset:29700
    v_add_f32 v14, v119, v127
    v_sub_f32 v15, v119, v127
    ds_write_b32 v9, v14 offset:28940
    ds_write_b32 v10, v15 offset:29696
    v_add_f32 v12, v128, v136
    v_sub_f32 v13, v128, v136
    ds_write_b32 v9, v12 offset:256
    ds_write_b32 v10, v13 offset:524
    v_add_f32 v14, v129, v137
    v_sub_f32 v15, v129, v137
    ds_write_b32 v9, v14 offset:260
    ds_write_b32 v10, v15 offset:520
    v_add_f32 v12, v130, v138
    v_sub_f32 v13, v130, v138
    ds_write_b32 v9, v12 offset:264
    ds_write_b32 v10, v13 offset:516
    v_add_f32 v14, v131, v139
    v_sub_f32 v15, v131, v139
    ds_write_b32 v9, v14 offset:268
    ds_write_b32 v10, v15 offset:512
    v_add_f32 v12, v132, v140
    v_sub_f32 v13, v132, v140
    ds_write_b32 v9, v12 offset:29184
    ds_write_b32 v10, v13 offset:29452
    v_add_f32 v14, v133, v141
    v_sub_f32 v15, v133, v141
    ds_write_b32 v9, v14 offset:29188
    ds_write_b32 v10, v15 offset:29448
    v_add_f32 v12, v134, v142
    v_sub_f32 v13, v134, v142
    ds_write_b32 v9, v12 offset:29192
    ds_write_b32 v10, v13 offset:29444
    v_add_f32 v14, v135, v143
    v_sub_f32 v15, v135, v143
    ds_write_b32 v9, v14 offset:29196
    ds_write_b32 v10, v15 offset:29440
    v_add_f32 v12, v144, v152
    v_sub_f32 v13, v144, v152
    ds_write_b32 v9, v12 offset:512
    ds_write_b32 v10, v13 offset:268
    v_add_f32 v14, v145, v153
    v_sub_f32 v15, v145, v153
    ds_write_b32 v9, v14 offset:516
    ds_write_b32 v10, v15 offset:264
    v_add_f32 v12, v146, v154
    v_sub_f32 v13, v146, v154
    ds_write_b32 v9, v12 offset:520
    ds_write_b32 v10, v13 offset:260
    v_add_f32 v14, v147, v155
    v_sub_f32 v15, v147, v155
    ds_write_b32 v9, v14 offset:524
    ds_write_b32 v10, v15 offset:256
    v_add_f32 v12, v148, v156
    v_sub_f32 v13, v148, v156
    ds_write_b32 v9, v12 offset:29440
    ds_write_b32 v10, v13 offset:29196
    v_add_f32 v14, v149, v157
    v_sub_f32 v15, v149, v157
    ds_write_b32 v9, v14 offset:29444
    ds_write_b32 v10, v15 offset:29192
    v_add_f32 v12, v150, v158
    v_sub_f32 v13, v150, v158
    ds_write_b32 v9, v12 offset:29448
    ds_write_b32 v10, v13 offset:29188
    v_add_f32 v14, v151, v159
    v_sub_f32 v15, v151, v159
    ds_write_b32 v9, v14 offset:29452
    ds_write_b32 v10, v15 offset:29184
    s_cmp_eq_u32 s14, 3
    s_cbranch_scc1 F3_noy
    s_cmp_eq_u32 s14, 2
    s_cbranch_scc1 F3_ylast
    v_add_f32 v12, v160, v168
    v_sub_f32 v13, v160, v168
    ds_write_b32 v9, v12 offset:768
    ds_write_b32 v10, v13 offset:12
    v_add_f32 v14, v161, v169
    v_sub_f32 v15, v161, v169
    ds_write_b32 v9, v14 offset:772
    ds_write_b32 v10, v15 offset:8
    v_add_f32 v12, v162, v170
    v_sub_f32 v13, v162, v170
    ds_write_b32 v9, v12 offset:776
    ds_write_b32 v10, v13 offset:4
    v_add_f32 v14, v163, v171
    v_sub_f32 v15, v163, v171
    ds_write_b32 v9, v14 offset:780
    ds_write_b32 v10, v15 offset:0
    v_add_f32 v12, v164, v172
    v_sub_f32 v13, v164, v172
    ds_write_b32 v9, v12 offset:29696
    ds_write_b32 v10, v13 offset:28940
    v_add_f32 v14, v165, v173
    v_sub_f32 v15, v165, v173
    ds_write_b32 v9, v14 offset:29700
    ds_write_b32 v10, v15 offset:28936
    v_add_f32 v12, v166, v174
    v_sub_f32 v13, v166, v174
    ds_write_b32 v9, v12 offset:29704
    ds_write_b32 v10, v13 offset:28932
    v_add_f32 v14, v167, v175
    v_sub_f32 v15, v167, v175
    ds_write_b32 v9, v14 offset:29708
    ds_write_b32 v10, v15 offset:28928
    s_branch F3_noy
F3_ylast:
    s_mov_b64 exec, 0xffff
    v_add_f32 v12, v160, v168
    v_sub_f32 v13, v160, v168
    ds_write_b32 v9, v12 offset:768
    ds_write_b32 v10, v13 offset:12
    v_add_f32 v12, v164, v172
    v_sub_f32 v13, v164, v172
    ds_write_b32 v9, v12 offset:29696
    ds_write_b32 v10, v13 offset:28940
    s_mov_b64 exec, -1
F3_noy:
    s_waitcnt lgkmcnt(0)
    s_barrier
    v_mul_u32_u24 v96, 1808, v106
    v_lshl_add_u32 v96, v107, 5, v96
    v_add_u32 v96, 30720, v96
    ds_read_b128 v[4:7], v96 offset:0
    ds_read_b128 v[8:11], v96 offset:16
    ds_read_b128 v[12:15], v96 offset:256
    ds_read_b128 v[16:19], v96 offset:272
    ds_read_b128 v[20:23], v96 offset:512
    ds_read_b128 v[24:27], v96 offset:528
    ds_read_b128 v[28:31], v96 offset:768
    ds_read_b128 v[32:35], v96 offset:784
    s_waitcnt lgkmcnt(0)
    ds_read_b128 v[36:39], v96 offset:1024
    ds_read_b128 v[40:43], v96 offset:1040
    ds_read_b128 v[44:47], v96 offset:1280
    ds_read_b128 v[48:51], v96 offset:1296
    ds_read_b128 v[52:55], v96 offset:1536
    ds_read_b128 v[56:59], v96 offset:1552
    s_waitcnt lgkmcnt(0)
    v_cvt_pk_bf16_f32 v92, v4, v5
    v_lshlrev_b32 v93, 16, v92
    v_and_b32 v92, 0xffff0000, v92
    v_lshlrev_b32 v94, 16, v64
    v_and_b32 v95, 0xffff0000, v64
    v_add_f32 v93, v93, v94
    v_add_f32 v92, v92, v95
    v_cvt_pk_bf16_f32 v64, v93, v92
    v_cvt_pk_bf16_f32 v92, v6, v7
    v_lshlrev_b32 v93, 16, v92
    v_and_b32 v92, 0xffff0000, v92
    v_lshlrev_b32 v94, 16, v65
    v_and_b32 v95, 0xffff0000, v65
    v_add_f32 v93, v93, v94
    v_add_f32 v92, v92, v95
    v_cvt_pk_bf16_f32 v65, v93, v92
    v_cvt_pk_bf16_f32 v92, v8, v9
    v_lshlrev_b32 v93, 16, v92
    v_and_b32 v92, 0xffff0000, v92
    v_lshlrev_b32 v94, 16, v66
    v_and_b32 v95, 0xffff0000, v66
    v_add_f32 v93, v93, v94
    v_add_f32 v92, v92, v95
    v_cvt_pk_bf16_f32 v66, v93, v92
    v_cvt_pk_bf16_f32 v92, v10, v11
    v_lshlrev_b32 v93, 16, v92
    v_and_b32 v92, 0xffff0000, v92
    v_lshlrev_b32 v94, 16, v67
    v_and_b32 v95, 0xffff0000, v67
    v_add_f32 v93, v93, v94
    v_add_f32 v92, v92, v95
    v_cvt_pk_bf16_f32 v67, v93, v92
    v_cvt_pk_bf16_f32 v92, v12, v13
    v_lshlrev_b32 v93, 16, v92
    v_and_b32 v92, 0xffff0000, v92
    v_lshlrev_b32 v94, 16, v68
    v_and_b32 v95, 0xffff0000, v68
    v_add_f32 v93, v93, v94
    v_add_f32 v92, v92, v95
    v_cvt_pk_bf16_f32 v68, v93, v92
    v_cvt_pk_bf16_f32 v92, v14, v15
    v_lshlrev_b32 v93, 16, v92
    v_and_b32 v92, 0xffff0000, v92
    v_lshlrev_b32 v94, 16, v69
    v_and_b32 v95, 0xffff0000, v69
    v_add_f32 v93, v93, v94
    v_add_f32 v92, v92, v95
    v_cvt_pk_bf16_f32 v69, v93, v92
    v_cvt_pk_bf16_f32 v92, v16, v17
    v_lshlrev_b32 v93, 16, v92
    v_and_b32 v92, 0xffff0000, v92
    v_lshlrev_b32 v94, 16, v70
    v_and_b32 v95, 0xffff0000, v70
    v_add_f32 v93, v93, v94
    v_add_f32 v92, v92, v95
    v_cvt_pk_bf16_f32 v70, v93, v92
    v_cvt_pk_bf16_f32 v92, v18, v19
    v_lshlrev_b32 v93, 16, v92
    v_and_b32 v92, 0xffff0000, v92
    v_lshlrev_b32 v94, 16, v71
    v_and_b32 v95, 0xffff0000, v71
    v_add_f32 v93, v93, v94
    v_add_f32 v92, v92, v95
    v_cvt_pk_bf16_f32 v71, v93, v92
    v_cvt_pk_bf16_f32 v92, v20, v21
    v_lshlrev_b32 v93, 16, v92
    v_and_b32 v92, 0xffff0000, v92
    v_lshlrev_b32 v94, 16, v72
    v_and_b32 v95, 0xffff0000, v72
    v_add_f32 v93, v93, v94
    v_add_f32 v92, v92, v95
    v_cvt_pk_bf16_f32 v72, v93, v92
    v_cvt_pk_bf16_f32 v92, v22, v23
    v_lshlrev_b32 v93, 16, v92
    v_and_b32 v92, 0xffff0000, v92
    v_lshlrev_b32 v94, 16, v73
    v_and_b32 v95, 0xffff0000, v73
    v_add_f32 v93, v93, v94
    v_add_f32 v92, v92, v95
    v_cvt_pk_bf16_f32 v73, v93, v92
    v_cvt_pk_bf16_f32 v92, v24, v25
    v_lshlrev_b32 v93, 16, v92
    v_and_b32 v92, 0xffff0000, v92
    v_lshlrev_b32 v94, 16, v74
    v_and_b32 v95, 0xffff0000, v74
    v_add_f32 v93, v93, v94
    v_add_f32 v92, v92, v95
    v_cvt_pk_bf16_f32 v74, v93, v92
    v_cvt_pk_bf16_f32 v92, v26, v27
    v_lshlrev_b32 v93, 16, v92
    v_and_b32 v92, 0xffff0000, v92
    v_lshlrev_b32 v94, 16, v75
    v_and_b32 v95, 0xffff0000, v75
    v_add_f32 v93, v93, v94
    v_add_f32 v92, v92, v95
    v_cvt_pk_bf16_f32 v75, v93, v92
    v_cvt_pk_bf16_f32 v92, v28, v29
    v_lshlrev_b32 v93, 16, v92
    v_and_b32 v92, 0xffff0000, v92
    v_lshlrev_b32 v94, 16, v76
    v_and_b32 v95, 0xffff0000, v76
    v_add_f32 v93, v93, v94
    v_add_f32 v92, v92, v95
    v_cvt_pk_bf16_f32 v76, v93, v92
    v_cvt_pk_bf16_f32 v92, v30, v31
    v_lshlrev_b32 v93, 16, v92
    v_and_b32 v92, 0xffff0000, v92
    v_lshlrev_b32 v94, 16, v77
    v_and_b32 v95, 0xffff0000, v77
    v_add_f32 v93, v93, v94
    v_add_f32 v92, v92, v95
    v_cvt_pk_bf16_f32 v77, v93, v92
    v_cvt_pk_bf16_f32 v92, v32, v33
    v_lshlrev_b32 v93, 16, v92
    v_and_b32 v92, 0xffff0000, v92
    v_lshlrev_b32 v94, 16, v78
    v_and_b32 v95, 0xffff0000, v78
    v_add_f32 v93, v93, v94
    v_add_f32 v92, v92, v95
    v_cvt_pk_bf16_f32 v78, v93, v92
    v_cvt_pk_bf16_f32 v92, v34, v35
    v_lshlrev_b32 v93, 16, v92
    v_and_b32 v92, 0xffff0000, v92
    v_lshlrev_b32 v94, 16, v79
    v_and_b32 v95, 0xffff0000, v79
    v_add_f32 v93, v93, v94
    v_add_f32 v92, v92, v95
    v_cvt_pk_bf16_f32 v79, v93, v92
    v_cvt_pk_bf16_f32 v92, v36, v37
    v_lshlrev_b32 v93, 16, v92
    v_and_b32 v92, 0xffff0000, v92
    v_lshlrev_b32 v94, 16, v80
    v_and_b32 v95, 0xffff0000, v80
    v_add_f32 v93, v93, v94
    v_add_f32 v92, v92, v95
    v_cvt_pk_bf16_f32 v80, v93, v92
    v_cvt_pk_bf16_f32 v92, v38, v39
    v_lshlrev_b32 v93, 16, v92
    v_and_b32 v92, 0xffff0000, v92
    v_lshlrev_b32 v94, 16, v81
    v_and_b32 v95, 0xffff0000, v81
    v_add_f32 v93, v93, v94
    v_add_f32 v92, v92, v95
    v_cvt_pk_bf16_f32 v81, v93, v92
    v_cvt_pk_bf16_f32 v92, v40, v41
    v_lshlrev_b32 v93, 16, v92
    v_and_b32 v92, 0xffff0000, v92
    v_lshlrev_b32 v94, 16, v82
    v_and_b32 v95, 0xffff0000, v82
    v_add_f32 v93, v93, v94
    v_add_f32 v92, v92, v95
    v_cvt_pk_bf16_f32 v82, v93, v92
    v_cvt_pk_bf16_f32 v92, v42, v43
    v_lshlrev_b32 v93, 16, v92
    v_and_b32 v92, 0xffff0000, v92
    v_lshlrev_b32 v94, 16, v83
    v_and_b32 v95, 0xffff0000, v83
    v_add_f32 v93, v93, v94
    v_add_f32 v92, v92, v95
    v_cvt_pk_bf16_f32 v83, v93, v92
    v_cvt_pk_bf16_f32 v92, v44, v45
    v_lshlrev_b32 v93, 16, v92
    v_and_b32 v92, 0xffff0000, v92
    v_lshlrev_b32 v94, 16, v84
    v_and_b32 v95, 0xffff0000, v84
    v_add_f32 v93, v93, v94
    v_add_f32 v92, v92, v95
    v_cvt_pk_bf16_f32 v84, v93, v92
    v_cvt_pk_bf16_f32 v92, v46, v47
    v_lshlrev_b32 v93, 16, v92
    v_and_b32 v92, 0xffff0000, v92
    v_lshlrev_b32 v94, 16, v85
    v_and_b32 v95, 0xffff0000, v85
    v_add_f32 v93, v93, v94
    v_add_f32 v92, v92, v95
    v_cvt_pk_bf16_f32 v85, v93, v92
    v_cvt_pk_bf16_f32 v92, v48, v49
    v_lshlrev_b32 v93, 16, v92
    v_and_b32 v92, 0xffff0000, v92
    v_lshlrev_b32 v94, 16, v86
    v_and_b32 v95, 0xffff0000, v86
    v_add_f32 v93, v93, v94
    v_add_f32 v92, v92, v95
    v_cvt_pk_bf16_f32 v86, v93, v92
    v_cvt_pk_bf16_f32 v92, v50, v51
    v_lshlrev_b32 v93, 16, v92
    v_and_b32 v92, 0xffff0000, v92
    v_lshlrev_b32 v94, 16, v87
    v_and_b32 v95, 0xffff0000, v87
    v_add_f32 v93, v93, v94
    v_add_f32 v92, v92, v95
    v_cvt_pk_bf16_f32 v87, v93, v92
    v_cvt_pk_bf16_f32 v92, v52, v53
    v_lshlrev_b32 v93, 16, v92
    v_and_b32 v92, 0xffff0000, v92
    v_lshlrev_b32 v94, 16, v88
    v_and_b32 v95, 0xffff0000, v88
    v_add_f32 v93, v93, v94
    v_add_f32 v92, v92, v95
    v_cvt_pk_bf16_f32 v88, v93, v92
    v_cvt_pk_bf16_f32 v92, v54, v55
    v_lshlrev_b32 v93, 16, v92
    v_and_b32 v92, 0xffff0000, v92
    v_lshlrev_b32 v94, 16, v89
    v_and_b32 v95, 0xffff0000, v89
    v_add_f32 v93, v93, v94
    v_add_f32 v92, v92, v95
    v_cvt_pk_bf16_f32 v89, v93, v92
    v_cvt_pk_bf16_f32 v92, v56, v57
    v_lshlrev_b32 v93, 16, v92
    v_and_b32 v92, 0xffff0000, v92
    v_lshlrev_b32 v94, 16, v90
    v_and_b32 v95, 0xffff0000, v90
    v_add_f32 v93, v93, v94
    v_add_f32 v92, v92, v95
    v_cvt_pk_bf16_f32 v90, v93, v92
    v_cvt_pk_bf16_f32 v92, v58, v59
    v_lshlrev_b32 v93, 16, v92
    v_and_b32 v92, 0xffff0000, v92
    v_lshlrev_b32 v94, 16, v91
    v_and_b32 v95, 0xffff0000, v91
    v_add_f32 v93, v93, v94
    v_add_f32 v92, v92, v95
    v_cvt_pk_bf16_f32 v91, v93, v92
    s_mov_b32 s18, 74027008
    buffer_store_dwordx4 v[64:67], v105, s[4:7], s18 offen offset:0 sc1
    buffer_store_dwordx4 v[68:71], v105, s[4:7], s18 offen offset:128 sc1
    buffer_store_dwordx4 v[72:75], v105, s[4:7], s18 offen offset:256 sc1
    buffer_store_dwordx4 v[76:79], v105, s[4:7], s18 offen offset:384 sc1
    buffer_store_dwordx4 v[80:83], v105, s[4:7], s18 offen offset:512 sc1
    buffer_store_dwordx4 v[84:87], v105, s[4:7], s18 offen offset:640 sc1
    buffer_store_dwordx4 v[88:91], v105, s[4:7], s18 offen offset:768 sc1
    v_lshlrev_b32 v4, 16, v64
    v_and_b32 v5, 0xffff0000, v64
    v_lshlrev_b32 v6, 16, v65
    v_and_b32 v7, 0xffff0000, v65
    v_lshlrev_b32 v8, 16, v66
    v_and_b32 v9, 0xffff0000, v66
    v_lshlrev_b32 v10, 16, v67
    v_and_b32 v11, 0xffff0000, v67
    v_lshlrev_b32 v12, 16, v68
    v_and_b32 v13, 0xffff0000, v68
    v_lshlrev_b32 v14, 16, v69
    v_and_b32 v15, 0xffff0000, v69
    v_lshlrev_b32 v16, 16, v70
    v_and_b32 v17, 0xffff0000, v70
    v_lshlrev_b32 v18, 16, v71
    v_and_b32 v19, 0xffff0000, v71
    v_lshlrev_b32 v20, 16, v72
    v_and_b32 v21, 0xffff0000, v72
    v_lshlrev_b32 v22, 16, v73
    v_and_b32 v23, 0xffff0000, v73
    v_lshlrev_b32 v24, 16, v74
    v_and_b32 v25, 0xffff0000, v74
    v_lshlrev_b32 v26, 16, v75
    v_and_b32 v27, 0xffff0000, v75
    v_lshlrev_b32 v28, 16, v76
    v_and_b32 v29, 0xffff0000, v76
    v_lshlrev_b32 v30, 16, v77
    v_and_b32 v31, 0xffff0000, v77
    v_lshlrev_b32 v32, 16, v78
    v_and_b32 v33, 0xffff0000, v78
    v_lshlrev_b32 v34, 16, v79
    v_and_b32 v35, 0xffff0000, v79
    v_lshlrev_b32 v36, 16, v80
    v_and_b32 v37, 0xffff0000, v80
    v_lshlrev_b32 v38, 16, v81
    v_and_b32 v39, 0xffff0000, v81
    v_lshlrev_b32 v40, 16, v82
    v_and_b32 v41, 0xffff0000, v82
    v_lshlrev_b32 v42, 16, v83
    v_and_b32 v43, 0xffff0000, v83
    v_lshlrev_b32 v44, 16, v84
    v_and_b32 v45, 0xffff0000, v84
    v_lshlrev_b32 v46, 16, v85
    v_and_b32 v47, 0xffff0000, v85
    v_lshlrev_b32 v48, 16, v86
    v_and_b32 v49, 0xffff0000, v86
    v_lshlrev_b32 v50, 16, v87
    v_and_b32 v51, 0xffff0000, v87
    v_lshlrev_b32 v52, 16, v88
    v_and_b32 v53, 0xffff0000, v88
    v_lshlrev_b32 v54, 16, v89
    v_and_b32 v55, 0xffff0000, v89
    v_lshlrev_b32 v56, 16, v90
    v_and_b32 v57, 0xffff0000, v90
    v_lshlrev_b32 v58, 16, v91
    v_and_b32 v59, 0xffff0000, v91
    v_add_f32 v100, v4, v5
    v_add_f32 v101, v6, v7
    v_add_f32 v100, v100, v8
    v_add_f32 v101, v101, v9
    v_add_f32 v100, v100, v10
    v_add_f32 v101, v101, v11
    v_add_f32 v100, v100, v12
    v_add_f32 v101, v101, v13
    v_add_f32 v100, v100, v14
    v_add_f32 v101, v101, v15
    v_add_f32 v100, v100, v16
    v_add_f32 v101, v101, v17
    v_add_f32 v100, v100, v18
    v_add_f32 v101, v101, v19
    v_add_f32 v100, v100, v20
    v_add_f32 v101, v101, v21
    v_add_f32 v100, v100, v22
    v_add_f32 v101, v101, v23
    v_add_f32 v100, v100, v24
    v_add_f32 v101, v101, v25
    v_add_f32 v100, v100, v26
    v_add_f32 v101, v101, v27
    v_add_f32 v100, v100, v28
    v_add_f32 v101, v101, v29
    v_add_f32 v100, v100, v30
    v_add_f32 v101, v101, v31
    v_add_f32 v100, v100, v32
    v_add_f32 v101, v101, v33
    v_add_f32 v100, v100, v34
    v_add_f32 v101, v101, v35
    v_add_f32 v100, v100, v36
    v_add_f32 v101, v101, v37
    v_add_f32 v100, v100, v38
    v_add_f32 v101, v101, v39
    v_add_f32 v100, v100, v40
    v_add_f32 v101, v101, v41
    v_add_f32 v100, v100, v42
    v_add_f32 v101, v101, v43
    v_add_f32 v100, v100, v44
    v_add_f32 v101, v101, v45
    v_add_f32 v100, v100, v46
    v_add_f32 v101, v101, v47
    v_add_f32 v100, v100, v48
    v_add_f32 v101, v101, v49
    v_add_f32 v100, v100, v50
    v_add_f32 v101, v101, v51
    v_add_f32 v100, v100, v52
    v_add_f32 v101, v101, v53
    v_add_f32 v100, v100, v54
    v_add_f32 v101, v101, v55
    v_add_f32 v100, v100, v56
    v_add_f32 v101, v101, v57
    v_add_f32 v100, v100, v58
    v_add_f32 v101, v101, v59
    v_add_f32 v100, v100, v101
    s_nop 1
    v_add_f32_dpp v100, v100, v100 quad_perm:[1,0,3,2] row_mask:0xf bank_mask:0xf
    s_nop 1
    v_add_f32_dpp v100, v100, v100 quad_perm:[2,3,0,1] row_mask:0xf bank_mask:0xf
    s_nop 1
    v_add_f32_dpp v100, v100, v100 row_half_mirror row_mask:0xf bank_mask:0xf
    v_mul_f32 v100, 0x3b124925, v100
    v_sub_f32 v92, v4, v100
    v_mul_f32 v101, v92, v92
    v_sub_f32 v93, v5, v100
    v_mul_f32 v102, v93, v93
    v_sub_f32 v92, v6, v100
    v_sub_f32 v93, v7, v100
    v_fmac_f32 v101, v92, v92
    v_fmac_f32 v102, v93, v93
    v_sub_f32 v92, v8, v100
    v_sub_f32 v93, v9, v100
    v_fmac_f32 v101, v92, v92
    v_fmac_f32 v102, v93, v93
    v_sub_f32 v92, v10, v100
    v_sub_f32 v93, v11, v100
    v_fmac_f32 v101, v92, v92
    v_fmac_f32 v102, v93, v93
    v_sub_f32 v92, v12, v100
    v_sub_f32 v93, v13, v100
    v_fmac_f32 v101, v92, v92
    v_fmac_f32 v102, v93, v93
    v_sub_f32 v92, v14, v100
    v_sub_f32 v93, v15, v100
    v_fmac_f32 v101, v92, v92
    v_fmac_f32 v102, v93, v93
    v_sub_f32 v92, v16, v100
    v_sub_f32 v93, v17, v100
    v_fmac_f32 v101, v92, v92
    v_fmac_f32 v102, v93, v93
    v_sub_f32 v92, v18, v100
    v_sub_f32 v93, v19, v100
    v_fmac_f32 v101, v92, v92
    v_fmac_f32 v102, v93, v93
    v_sub_f32 v92, v20, v100
    v_sub_f32 v93, v21, v100
    v_fmac_f32 v101, v92, v92
    v_fmac_f32 v102, v93, v93
    v_sub_f32 v92, v22, v100
    v_sub_f32 v93, v23, v100
    v_fmac_f32 v101, v92, v92
    v_fmac_f32 v102, v93, v93
    v_sub_f32 v92, v24, v100
    v_sub_f32 v93, v25, v100
    v_fmac_f32 v101, v92, v92
    v_fmac_f32 v102, v93, v93
    v_sub_f32 v92, v26, v100
    v_sub_f32 v93, v27, v100
    v_fmac_f32 v101, v92, v92
    v_fmac_f32 v102, v93, v93
    v_sub_f32 v92, v28, v100
    v_sub_f32 v93, v29, v100
    v_fmac_f32 v101, v92, v92
    v_fmac_f32 v102, v93, v93
    v_sub_f32 v92, v30, v100
    v_sub_f32 v93, v31, v100
    v_fmac_f32 v101, v92, v92
    v_fmac_f32 v102, v93, v93
    v_sub_f32 v92, v32, v100
    v_sub_f32 v93, v33, v100
    v_fmac_f32 v101, v92, v92
    v_fmac_f32 v102, v93, v93
    v_sub_f32 v92, v34, v100
    v_sub_f32 v93, v35, v100
    v_fmac_f32 v101, v92, v92
    v_fmac_f32 v102, v93, v93
    v_sub_f32 v92, v36, v100
    v_sub_f32 v93, v37, v100
    v_fmac_f32 v101, v92, v92
    v_fmac_f32 v102, v93, v93
    v_sub_f32 v92, v38, v100
    v_sub_f32 v93, v39, v100
    v_fmac_f32 v101, v92, v92
    v_fmac_f32 v102, v93, v93
    v_sub_f32 v92, v40, v100
    v_sub_f32 v93, v41, v100
    v_fmac_f32 v101, v92, v92
    v_fmac_f32 v102, v93, v93
    v_sub_f32 v92, v42, v100
    v_sub_f32 v93, v43, v100
    v_fmac_f32 v101, v92, v92
    v_fmac_f32 v102, v93, v93
    v_sub_f32 v92, v44, v100
    v_sub_f32 v93, v45, v100
    v_fmac_f32 v101, v92, v92
    v_fmac_f32 v102, v93, v93
    v_sub_f32 v92, v46, v100
    v_sub_f32 v93, v47, v100
    v_fmac_f32 v101, v92, v92
    v_fmac_f32 v102, v93, v93
    v_sub_f32 v92, v48, v100
    v_sub_f32 v93, v49, v100
    v_fmac_f32 v101, v92, v92
    v_fmac_f32 v102, v93, v93
    v_sub_f32 v92, v50, v100
    v_sub_f32 v93, v51, v100
    v_fmac_f32 v101, v92, v92
    v_fmac_f32 v102, v93, v93
    v_sub_f32 v92, v52, v100
    v_sub_f32 v93, v53, v100
    v_fmac_f32 v101, v92, v92
    v_fmac_f32 v102, v93, v93
    v_sub_f32 v92, v54, v100
    v_sub_f32 v93, v55, v100
    v_fmac_f32 v101, v92, v92
    v_fmac_f32 v102, v93, v93
    v_sub_f32 v92, v56, v100
    v_sub_f32 v93, v57, v100
    v_fmac_f32 v101, v92, v92
    v_fmac_f32 v102, v93, v93
    v_sub_f32 v92, v58, v100
    v_sub_f32 v93, v59, v100
    v_fmac_f32 v101, v92, v92
    v_fmac_f32 v102, v93, v93
    v_add_f32 v101, v101, v102
    s_nop 1
    v_add_f32_dpp v101, v101, v101 quad_perm:[1,0,3,2] row_mask:0xf bank_mask:0xf
    s_nop 1
    v_add_f32_dpp v101, v101, v101 quad_perm:[2,3,0,1] row_mask:0xf bank_mask:0xf
    s_nop 1
    v_add_f32_dpp v101, v101, v101 row_half_mirror row_mask:0xf bank_mask:0xf
    v_mul_f32 v101, 0x3b124925, v101
    v_cvt_pk_bf16_f32 v100, v100, v100
    v_lshlrev_b32 v100, 16, v100
    v_cvt_pk_bf16_f32 v101, v101, v101
    v_lshlrev_b32 v101, 16, v101
    v_add_f32 v101, 0x3727c5ac, v101
    v_cvt_pk_bf16_f32 v101, v101, v101
    v_lshlrev_b32 v101, 16, v101
    v_sqrt_f32 v101, v101
    s_nop 0
    v_cvt_pk_bf16_f32 v101, v101, v101
    v_lshlrev_b32 v101, 16, v101
    v_rcp_f32 v101, v101
    v_sub_f32 v4, v4, v100
    v_sub_f32 v5, v5, v100
    v_cvt_pk_bf16_f32 v92, v4, v5
    v_lshlrev_b32 v4, 16, v92
    v_and_b32 v5, 0xffff0000, v92
    v_mul_f32 v4, v4, v101
    v_mul_f32 v5, v5, v101
    v_sub_f32 v6, v6, v100
    v_sub_f32 v7, v7, v100
    v_cvt_pk_bf16_f32 v92, v6, v7
    v_lshlrev_b32 v6, 16, v92
    v_and_b32 v7, 0xffff0000, v92
    v_mul_f32 v6, v6, v101
    v_mul_f32 v7, v7, v101
    v_sub_f32 v8, v8, v100
    v_sub_f32 v9, v9, v100
    v_cvt_pk_bf16_f32 v92, v8, v9
    v_lshlrev_b32 v8, 16, v92
    v_and_b32 v9, 0xffff0000, v92
    v_mul_f32 v8, v8, v101
    v_mul_f32 v9, v9, v101
    v_sub_f32 v10, v10, v100
    v_sub_f32 v11, v11, v100
    v_cvt_pk_bf16_f32 v92, v10, v11
    v_lshlrev_b32 v10, 16, v92
    v_and_b32 v11, 0xffff0000, v92
    v_mul_f32 v10, v10, v101
    v_mul_f32 v11, v11, v101
    v_sub_f32 v12, v12, v100
    v_sub_f32 v13, v13, v100
    v_cvt_pk_bf16_f32 v92, v12, v13
    v_lshlrev_b32 v12, 16, v92
    v_and_b32 v13, 0xffff0000, v92
    v_mul_f32 v12, v12, v101
    v_mul_f32 v13, v13, v101
    v_sub_f32 v14, v14, v100
    v_sub_f32 v15, v15, v100
    v_cvt_pk_bf16_f32 v92, v14, v15
    v_lshlrev_b32 v14, 16, v92
    v_and_b32 v15, 0xffff0000, v92
    v_mul_f32 v14, v14, v101
    v_mul_f32 v15, v15, v101
    v_sub_f32 v16, v16, v100
    v_sub_f32 v17, v17, v100
    v_cvt_pk_bf16_f32 v92, v16, v17
    v_lshlrev_b32 v16, 16, v92
    v_and_b32 v17, 0xffff0000, v92
    v_mul_f32 v16, v16, v101
    v_mul_f32 v17, v17, v101
    v_sub_f32 v18, v18, v100
    v_sub_f32 v19, v19, v100
    v_cvt_pk_bf16_f32 v92, v18, v19
    v_lshlrev_b32 v18, 16, v92
    v_and_b32 v19, 0xffff0000, v92
    v_mul_f32 v18, v18, v101
    v_mul_f32 v19, v19, v101
    v_sub_f32 v20, v20, v100
    v_sub_f32 v21, v21, v100
    v_cvt_pk_bf16_f32 v92, v20, v21
    v_lshlrev_b32 v20, 16, v92
    v_and_b32 v21, 0xffff0000, v92
    v_mul_f32 v20, v20, v101
    v_mul_f32 v21, v21, v101
    v_sub_f32 v22, v22, v100
    v_sub_f32 v23, v23, v100
    v_cvt_pk_bf16_f32 v92, v22, v23
    v_lshlrev_b32 v22, 16, v92
    v_and_b32 v23, 0xffff0000, v92
    v_mul_f32 v22, v22, v101
    v_mul_f32 v23, v23, v101
    v_sub_f32 v24, v24, v100
    v_sub_f32 v25, v25, v100
    v_cvt_pk_bf16_f32 v92, v24, v25
    v_lshlrev_b32 v24, 16, v92
    v_and_b32 v25, 0xffff0000, v92
    v_mul_f32 v24, v24, v101
    v_mul_f32 v25, v25, v101
    v_sub_f32 v26, v26, v100
    v_sub_f32 v27, v27, v100
    v_cvt_pk_bf16_f32 v92, v26, v27
    v_lshlrev_b32 v26, 16, v92
    v_and_b32 v27, 0xffff0000, v92
    v_mul_f32 v26, v26, v101
    v_mul_f32 v27, v27, v101
    v_sub_f32 v28, v28, v100
    v_sub_f32 v29, v29, v100
    v_cvt_pk_bf16_f32 v92, v28, v29
    v_lshlrev_b32 v28, 16, v92
    v_and_b32 v29, 0xffff0000, v92
    v_mul_f32 v28, v28, v101
    v_mul_f32 v29, v29, v101
    v_sub_f32 v30, v30, v100
    v_sub_f32 v31, v31, v100
    v_cvt_pk_bf16_f32 v92, v30, v31
    v_lshlrev_b32 v30, 16, v92
    v_and_b32 v31, 0xffff0000, v92
    v_mul_f32 v30, v30, v101
    v_mul_f32 v31, v31, v101
    v_sub_f32 v32, v32, v100
    v_sub_f32 v33, v33, v100
    v_cvt_pk_bf16_f32 v92, v32, v33
    v_lshlrev_b32 v32, 16, v92
    v_and_b32 v33, 0xffff0000, v92
    v_mul_f32 v32, v32, v101
    v_mul_f32 v33, v33, v101
    v_sub_f32 v34, v34, v100
    v_sub_f32 v35, v35, v100
    v_cvt_pk_bf16_f32 v92, v34, v35
    v_lshlrev_b32 v34, 16, v92
    v_and_b32 v35, 0xffff0000, v92
    v_mul_f32 v34, v34, v101
    v_mul_f32 v35, v35, v101
    v_sub_f32 v36, v36, v100
    v_sub_f32 v37, v37, v100
    v_cvt_pk_bf16_f32 v92, v36, v37
    v_lshlrev_b32 v36, 16, v92
    v_and_b32 v37, 0xffff0000, v92
    v_mul_f32 v36, v36, v101
    v_mul_f32 v37, v37, v101
    v_sub_f32 v38, v38, v100
    v_sub_f32 v39, v39, v100
    v_cvt_pk_bf16_f32 v92, v38, v39
    v_lshlrev_b32 v38, 16, v92
    v_and_b32 v39, 0xffff0000, v92
    v_mul_f32 v38, v38, v101
    v_mul_f32 v39, v39, v101
    v_sub_f32 v40, v40, v100
    v_sub_f32 v41, v41, v100
    v_cvt_pk_bf16_f32 v92, v40, v41
    v_lshlrev_b32 v40, 16, v92
    v_and_b32 v41, 0xffff0000, v92
    v_mul_f32 v40, v40, v101
    v_mul_f32 v41, v41, v101
    v_sub_f32 v42, v42, v100
    v_sub_f32 v43, v43, v100
    v_cvt_pk_bf16_f32 v92, v42, v43
    v_lshlrev_b32 v42, 16, v92
    v_and_b32 v43, 0xffff0000, v92
    v_mul_f32 v42, v42, v101
    v_mul_f32 v43, v43, v101
    v_sub_f32 v44, v44, v100
    v_sub_f32 v45, v45, v100
    v_cvt_pk_bf16_f32 v92, v44, v45
    v_lshlrev_b32 v44, 16, v92
    v_and_b32 v45, 0xffff0000, v92
    v_mul_f32 v44, v44, v101
    v_mul_f32 v45, v45, v101
    v_sub_f32 v46, v46, v100
    v_sub_f32 v47, v47, v100
    v_cvt_pk_bf16_f32 v92, v46, v47
    v_lshlrev_b32 v46, 16, v92
    v_and_b32 v47, 0xffff0000, v92
    v_mul_f32 v46, v46, v101
    v_mul_f32 v47, v47, v101
    v_sub_f32 v48, v48, v100
    v_sub_f32 v49, v49, v100
    v_cvt_pk_bf16_f32 v92, v48, v49
    v_lshlrev_b32 v48, 16, v92
    v_and_b32 v49, 0xffff0000, v92
    v_mul_f32 v48, v48, v101
    v_mul_f32 v49, v49, v101
    v_sub_f32 v50, v50, v100
    v_sub_f32 v51, v51, v100
    v_cvt_pk_bf16_f32 v92, v50, v51
    v_lshlrev_b32 v50, 16, v92
    v_and_b32 v51, 0xffff0000, v92
    v_mul_f32 v50, v50, v101
    v_mul_f32 v51, v51, v101
    v_sub_f32 v52, v52, v100
    v_sub_f32 v53, v53, v100
    v_cvt_pk_bf16_f32 v92, v52, v53
    v_lshlrev_b32 v52, 16, v92
    v_and_b32 v53, 0xffff0000, v92
    v_mul_f32 v52, v52, v101
    v_mul_f32 v53, v53, v101
    v_sub_f32 v54, v54, v100
    v_sub_f32 v55, v55, v100
    v_cvt_pk_bf16_f32 v92, v54, v55
    v_lshlrev_b32 v54, 16, v92
    v_and_b32 v55, 0xffff0000, v92
    v_mul_f32 v54, v54, v101
    v_mul_f32 v55, v55, v101
    v_sub_f32 v56, v56, v100
    v_sub_f32 v57, v57, v100
    v_cvt_pk_bf16_f32 v92, v56, v57
    v_lshlrev_b32 v56, 16, v92
    v_and_b32 v57, 0xffff0000, v92
    v_mul_f32 v56, v56, v101
    v_mul_f32 v57, v57, v101
    v_sub_f32 v58, v58, v100
    v_sub_f32 v59, v59, v100
    v_cvt_pk_bf16_f32 v92, v58, v59
    v_lshlrev_b32 v58, 16, v92
    v_and_b32 v59, 0xffff0000, v92
    v_mul_f32 v58, v58, v101
    v_mul_f32 v59, v59, v101
    v_lshrrev_b32 v96, 5, v104
    v_mul_u32_u24 v96, 28672, v96
    v_and_b32 v97, 1, v104
    v_mul_u32_u24 v97, 14336, v97
    v_add_u32 v96, v96, v97
    v_bfe_u32 v97, v104, 2, 2
    v_lshl_add_u32 v96, v97, 6, v96
    v_bfe_u32 v97, v104, 4, 1
    v_lshl_add_u32 v96, v97, 5, v96
    v_bfe_u32 v97, v104, 1, 1
    v_lshl_add_u32 v96, v97, 4, v96
    v_lshrrev_b32 v97, 2, v107
    v_lshl_add_u32 v96, v97, 10, v96
    v_and_b32 v97, 3, v107
    v_lshl_add_u32 v96, v97, 8, v96
    s_mov_b32 s18, 0
    v_cvt_pk_bf16_f32 v64, v4, v5
    v_cvt_pk_bf16_f32 v65, v6, v7
    v_cvt_pk_bf16_f32 v66, v8, v9
    v_cvt_pk_bf16_f32 v67, v10, v11
    buffer_store_dwordx4 v[64:67], v96, s[4:7], s18 offen offset:0 sc1
    s_nop 1
    v_cvt_pk_bf16_f32 v68, v12, v13
    v_cvt_pk_bf16_f32 v69, v14, v15
    v_cvt_pk_bf16_f32 v70, v16, v17
    v_cvt_pk_bf16_f32 v71, v18, v19
    buffer_store_dwordx4 v[68:71], v96, s[4:7], s18 offen offset:2048 sc1
    s_nop 1
    v_cvt_pk_bf16_f32 v64, v20, v21
    v_cvt_pk_bf16_f32 v65, v22, v23
    v_cvt_pk_bf16_f32 v66, v24, v25
    v_cvt_pk_bf16_f32 v67, v26, v27
    s_add_u32 s19, s18, 4096
    buffer_store_dwordx4 v[64:67], v96, s[4:7], s19 offen sc1
    s_nop 1
    v_cvt_pk_bf16_f32 v68, v28, v29
    v_cvt_pk_bf16_f32 v69, v30, v31
    v_cvt_pk_bf16_f32 v70, v32, v33
    v_cvt_pk_bf16_f32 v71, v34, v35
    s_add_u32 s19, s18, 6144
    buffer_store_dwordx4 v[68:71], v96, s[4:7], s19 offen sc1
    s_nop 1
    v_cvt_pk_bf16_f32 v64, v36, v37
    v_cvt_pk_bf16_f32 v65, v38, v39
    v_cvt_pk_bf16_f32 v66, v40, v41
    v_cvt_pk_bf16_f32 v67, v42, v43
    s_add_u32 s19, s18, 8192
    buffer_store_dwordx4 v[64:67], v96, s[4:7], s19 offen sc1
    s_nop 1
    v_cvt_pk_bf16_f32 v68, v44, v45
    v_cvt_pk_bf16_f32 v69, v46, v47
    v_cvt_pk_bf16_f32 v70, v48, v49
    v_cvt_pk_bf16_f32 v71, v50, v51
    s_add_u32 s19, s18, 10240
    buffer_store_dwordx4 v[68:71], v96, s[4:7], s19 offen sc1
    s_nop 1
    v_cvt_pk_bf16_f32 v64, v52, v53
    v_cvt_pk_bf16_f32 v65, v54, v55
    v_cvt_pk_bf16_f32 v66, v56, v57
    v_cvt_pk_bf16_f32 v67, v58, v59
    s_add_u32 s19, s18, 12288
    buffer_store_dwordx4 v[64:67], v96, s[4:7], s19 offen sc1
    s_nop 1
    s_waitcnt vmcnt(0)
    s_barrier
    s_cmp_eq_u32 s76, 0
    s_cbranch_scc0 K_ff3
    s_lshl_b32 s53, s64, 4
    s_add_u32 s53, s53, 78635008
    s_mov_b64 exec, 1
    v_mov_b32 v2, 1
    buffer_store_dword v2, off, s[4:7], s53 sc1
    s_mov_b64 exec, -1
K_ff3:
K_nof3:
    s_cmp_eq_u32 s65, 0
    s_cbranch_scc0 K_now2
    s_cmp_eq_u32 s76, 0
    s_cbranch_scc0 K_wprep_ok
    v_mbcnt_lo_u32_b32 v2, -1, 0
    v_mbcnt_hi_u32_b32 v2, -1, v2
    v_add_u32 v3, 0, v2
    v_min_u32 v3, 127, v3
    v_lshlrev_b32 v3, 4, v3
    v_add_u32 v4, 64, v2
    v_min_u32 v4, 127, v4
    v_lshlrev_b32 v4, 4, v4
    s_mov_b32 s53, 78622720
    s_mov_b32 s54, 1048576
K_wprep:
    buffer_load_dword v5, v3, s[4:7], s53 offen sc1
    buffer_load_dword v6, v4, s[4:7], s53 offen sc1
    s_mov_b32 s90, 33
    s_sub_u32 s54, s54, 1
    s_cmp_eq_u32 s54, 0
    s_cbranch_scc1 L_abort1
    s_waitcnt vmcnt(0)
    v_and_b32 v5, v5, v6
    v_cmp_ne_u32 vcc, 1, v5
    s_cbranch_vccz K_wprep_ok
    s_sleep 2
    s_branch K_wprep
K_wprep_ok:
    s_barrier
    s_cmp_eq_u32 s76, 0
    s_cbranch_scc0 K_wprep2_ok
    v_mbcnt_lo_u32_b32 v2, -1, 0
    v_mbcnt_hi_u32_b32 v2, -1, v2
    v_add_u32 v3, 0, v2
    v_min_u32 v3, 95, v3
    v_lshlrev_b32 v3, 4, v3
    v_add_u32 v4, 64, v2
    v_min_u32 v4, 95, v4
    v_lshlrev_b32 v4, 4, v4
    s_mov_b32 s53, 78647296
    s_mov_b32 s54, 1048576
K_wprep2:
    buffer_load_dword v5, v3, s[4:7], s53 offen sc1
    buffer_load_dword v6, v4, s[4:7], s53 offen sc1
    s_mov_b32 s90, 34
    s_sub_u32 s54, s54, 1
    s_cmp_eq_u32 s54, 0
    s_cbranch_scc1 L_abort1
    s_waitcnt vmcnt(0)
    v_and_b32 v5, v5, v6
    v_cmp_ne_u32 vcc, 1, v5
    s_cbranch_vccz K_wprep2_ok
    s_sleep 2
    s_branch K_wprep2
K_wprep2_ok:
    s_barrier
    v_accvgpr_read_b32 v0, a255
    v_and_b32 v0, 63, v0
    v_lshlrev_b32 v2, 4, v0
    s_mul_i32 s34, s64, 28672
    s_add_u32 s34, s34, 19267584
    buffer_load_dwordx4 a[0:3], v2, s[56:59], s34 offen offset:0 sc1
    buffer_load_dwordx4 a[4:7], v2, s[56:59], s34 offen offset:1024 sc1
    buffer_load_dwordx4 a[8:11], v2, s[56:59], s34 offen offset:2048 sc1
    buffer_load_dwordx4 a[12:15], v2, s[56:59], s34 offen offset:3072 sc1
    s_add_u32 s34, s34, 4096
    buffer_load_dwordx4 a[16:19], v2, s[56:59], s34 offen offset:0 sc1
    buffer_load_dwordx4 a[20:23], v2, s[56:59], s34 offen offset:1024 sc1
    buffer_load_dwordx4 a[24:27], v2, s[56:59], s34 offen offset:2048 sc1
    buffer_load_dwordx4 a[28:31], v2, s[56:59], s34 offen offset:3072 sc1
    s_add_u32 s34, s34, 4096
    buffer_load_dwordx4 a[32:35], v2, s[56:59], s34 offen offset:0 sc1
    buffer_load_dwordx4 a[36:39], v2, s[56:59], s34 offen offset:1024 sc1
    buffer_load_dwordx4 a[40:43], v2, s[56:59], s34 offen offset:2048 sc1
    buffer_load_dwordx4 a[44:47], v2, s[56:59], s34 offen offset:3072 sc1
    s_add_u32 s34, s34, 4096
    buffer_load_dwordx4 a[48:51], v2, s[56:59], s34 offen offset:0 sc1
    buffer_load_dwordx4 a[52:55], v2, s[56:59], s34 offen offset:1024 sc1
    buffer_load_dwordx4 a[56:59], v2, s[56:59], s34 offen offset:2048 sc1
    buffer_load_dwordx4 a[60:63], v2, s[56:59], s34 offen offset:3072 sc1
    s_add_u32 s34, s34, 4096
    buffer_load_dwordx4 a[64:67], v2, s[56:59], s34 offen offset:0 sc1
    buffer_load_dwordx4 a[68:71], v2, s[56:59], s34 offen offset:1024 sc1
    buffer_load_dwordx4 a[72:75], v2, s[56:59], s34 offen offset:2048 sc1
    buffer_load_dwordx4 a[76:79], v2, s[56:59], s34 offen offset:3072 sc1
    s_add_u32 s34, s34, 4096
    buffer_load_dwordx4 a[80:83], v2, s[56:59], s34 offen offset:0 sc1
    buffer_load_dwordx4 a[84:87], v2, s[56:59], s34 offen offset:1024 sc1
    buffer_load_dwordx4 a[88:91], v2, s[56:59], s34 offen offset:2048 sc1
    buffer_load_dwordx4 a[92:95], v2, s[56:59], s34 offen offset:3072 sc1
    s_add_u32 s34, s34, 4096
    buffer_load_dwordx4 a[96:99], v2, s[56:59], s34 offen offset:0 sc1
    buffer_load_dwordx4 a[100:103], v2, s[56:59], s34 offen offset:1024 sc1
    buffer_load_dwordx4 a[104:107], v2, s[56:59], s34 offen offset:2048 sc1
    buffer_load_dwordx4 a[108:111], v2, s[56:59], s34 offen offset:3072 sc1
    s_add_u32 s34, s34, 4096
    s_mul_i32 s34, s64, 28672
    s_add_u32 s34, s34, 12845056
    buffer_load_dwordx4 a[112:115], v2, s[56:59], s34 offen offset:0 sc1
    buffer_load_dwordx4 a[116:119], v2, s[56:59], s34 offen offset:1024 sc1
    buffer_load_dwordx4 a[120:123], v2, s[56:59], s34 offen offset:2048 sc1
    buffer_load_dwordx4 a[124:127], v2, s[56:59], s34 offen offset:3072 sc1
    s_add_u32 s34, s34, 4096
    buffer_load_dwordx4 a[128:131], v2, s[56:59], s34 offen offset:0 sc1
    buffer_load_dwordx4 a[132:135], v2, s[56:59], s34 offen offset:1024 sc1
    buffer_load_dwordx4 a[136:139], v2, s[56:59], s34 offen offset:2048 sc1
    buffer_load_dwordx4 a[140:143], v2, s[56:59], s34 offen offset:3072 sc1
    s_add_u32 s34, s34, 4096
    buffer_load_dwordx4 a[144:147], v2, s[56:59], s34 offen offset:0 sc1
    buffer_load_dwordx4 a[148:151], v2, s[56:59], s34 offen offset:1024 sc1
    buffer_load_dwordx4 a[152:155], v2, s[56:59], s34 offen offset:2048 sc1
    buffer_load_dwordx4 a[156:159], v2, s[56:59], s34 offen offset:3072 sc1
    s_add_u32 s34, s34, 4096
    buffer_load_dwordx4 a[160:163], v2, s[56:59], s34 offen offset:0 sc1
    buffer_load_dwordx4 a[164:167], v2, s[56:59], s34 offen offset:1024 sc1
    buffer_load_dwordx4 a[168:171], v2, s[56:59], s34 offen offset:2048 sc1
    buffer_load_dwordx4 a[172:175], v2, s[56:59], s34 offen offset:3072 sc1
    s_add_u32 s34, s34, 4096
    buffer_load_dwordx4 a[176:179], v2, s[56:59], s34 offen offset:0 sc1
    buffer_load_dwordx4 a[180:183], v2, s[56:59], s34 offen offset:1024 sc1
    buffer_load_dwordx4 a[184:187], v2, s[56:59], s34 offen offset:2048 sc1
    buffer_load_dwordx4 a[188:191], v2, s[56:59], s34 offen offset:3072 sc1
    s_add_u32 s34, s34, 4096
    buffer_load_dwordx4 a[192:195], v2, s[56:59], s34 offen offset:0 sc1
    buffer_load_dwordx4 a[196:199], v2, s[56:59], s34 offen offset:1024 sc1
    buffer_load_dwordx4 a[200:203], v2, s[56:59], s34 offen offset:2048 sc1
    buffer_load_dwordx4 a[204:207], v2, s[56:59], s34 offen offset:3072 sc1
    s_add_u32 s34, s34, 4096
    buffer_load_dwordx4 a[208:211], v2, s[56:59], s34 offen offset:0 sc1
    buffer_load_dwordx4 a[212:215], v2, s[56:59], s34 offen offset:1024 sc1
    buffer_load_dwordx4 a[216:219], v2, s[56:59], s34 offen offset:2048 sc1
    buffer_load_dwordx4 a[220:223], v2, s[56:59], s34 offen offset:3072 sc1
    s_add_u32 s34, s34, 4096
    s_cmp_eq_u32 s76, 0
    s_cbranch_scc0 K_wfill_ok
    v_mbcnt_lo_u32_b32 v2, -1, 0
    v_mbcnt_hi_u32_b32 v2, -1, v2
    v_add_u32 v3, 0, v2
    v_min_u32 v3, 14, v3
    v_lshlrev_b32 v3, 4, v3
    s_mov_b32 s53, 78639104
    s_mov_b32 s54, 1048576
K_wfill:
    buffer_load_dword v4, v3, s[4:7], s53 offen sc1
    s_mov_b32 s90, 35
    s_sub_u32 s54, s54, 1
    s_cmp_eq_u32 s54, 0
    s_cbranch_scc1 L_abort1
    s_waitcnt vmcnt(0)
    v_cmp_ne_u32 vcc, 1, v4
    s_cbranch_vccz K_wfill_ok
    s_sleep 2
    s_branch K_wfill
K_wfill_ok:
    s_barrier
K_now2:
    s_cmp_eq_u32 s76, 0
    s_cbranch_scc0 K_wf3_ok
    v_mbcnt_lo_u32_b32 v2, -1, 0
    v_mbcnt_hi_u32_b32 v2, -1, v2
    v_add_u32 v3, 0, v2
    v_min_u32 v3, 63, v3
    v_lshlrev_b32 v3, 4, v3
    s_mov_b32 s53, 78635008
    s_mov_b32 s54, 1048576
K_wf3:
    buffer_load_dword v4, v3, s[4:7], s53 offen sc1
    s_mov_b32 s90, 36
    s_sub_u32 s54, s54, 1
    s_cmp_eq_u32 s54, 0
    s_cbranch_scc1 L_abort1
    s_waitcnt vmcnt(0)
    v_cmp_ne_u32 vcc, 1, v4
    s_cbranch_vccz K_wf3_ok
    s_sleep 2
    s_branch K_wf3
K_wf3_ok:
    s_barrier
    v_accvgpr_read_b32 v0, a255
    s_mov_b32 s28, s76
    v_and_b32 v0, 63, v0
    s_mov_b32 s33, 153391690
    s_mul_hi_u32 s29, s64, s33
    s_mul_i32 s30, s29, 28
    s_sub_u32 s30, s64, s30
    s_mov_b32 s33, 306783379
    s_mul_hi_u32 s31, s64, s33
    s_mul_i32 s32, s31, 14
    s_sub_u32 s32, s64, s32
    v_lshlrev_b32 v5, 4, v0
    v_lshlrev_b32 v7, 4, v0
    s_lshr_b32 s34, s30, 1
    s_lshl_b32 s34, s34, 2
    s_lshr_b32 s35, s29, 1
    s_add_u32 s34, s34, s35
    s_lshl_b32 s34, s34, 13
    s_and_b32 s35, s29, 1
    s_lshl_b32 s35, s35, 12
    s_add_u32 s34, s34, s35
    s_and_b32 s35, s30, 1
    s_lshl_b32 s35, s35, 11
    s_add_u32 s34, s34, s35
    s_mul_i32 s35, s28, 458752
    s_add_u32 s34, s34, s35
    s_add_u32 s36, s34, 11112448
    s_mul_i32 s34, s31, 14
    s_add_u32 s34, s34, s32
    s_lshl_b32 s34, s34, 11
    s_add_u32 s34, s34, s35
    s_add_u32 s37, s34, 40472576
    s_mul_i32 s38, s28, 28672
    s_add_u32 s38, s38, 0
    s_add_u32 s39, s38, 0
    buffer_load_dwordx4 v[16:19], v5, s[4:7], s39 offen sc1
    s_add_u32 s39, s38, 14336
    buffer_load_dwordx4 v[72:75], v5, s[4:7], s39 offen sc1
    s_add_u32 s39, s38, 1024
    buffer_load_dwordx4 v[20:23], v5, s[4:7], s39 offen sc1
    s_add_u32 s39, s38, 15360
    buffer_load_dwordx4 v[76:79], v5, s[4:7], s39 offen sc1
    s_add_u32 s39, s38, 2048
    buffer_load_dwordx4 v[24:27], v5, s[4:7], s39 offen sc1
    s_add_u32 s39, s38, 16384
    buffer_load_dwordx4 v[80:83], v5, s[4:7], s39 offen sc1
    s_add_u32 s39, s38, 3072
    buffer_load_dwordx4 v[28:31], v5, s[4:7], s39 offen sc1
    s_add_u32 s39, s38, 17408
    buffer_load_dwordx4 v[84:87], v5, s[4:7], s39 offen sc1
    s_add_u32 s39, s38, 4096
    buffer_load_dwordx4 v[32:35], v5, s[4:7], s39 offen sc1
    s_add_u32 s39, s38, 18432
    buffer_load_dwordx4 v[88:91], v5, s[4:7], s39 offen sc1
    s_add_u32 s39, s38, 5120
    buffer_load_dwordx4 v[36:39], v5, s[4:7], s39 offen sc1
    s_add_u32 s39, s38, 19456
    buffer_load_dwordx4 v[92:95], v5, s[4:7], s39 offen sc1
    s_add_u32 s39, s38, 6144
    buffer_load_dwordx4 v[40:43], v5, s[4:7], s39 offen sc1
    s_add_u32 s39, s38, 20480
    buffer_load_dwordx4 v[96:99], v5, s[4:7], s39 offen sc1
    s_add_u32 s39, s38, 7168
    buffer_load_dwordx4 v[44:47], v5, s[4:7], s39 offen sc1
    s_add_u32 s39, s38, 21504
    buffer_load_dwordx4 v[100:103], v5, s[4:7], s39 offen sc1
    s_add_u32 s39, s38, 8192
    buffer_load_dwordx4 v[48:51], v5, s[4:7], s39 offen sc1
    s_add_u32 s39, s38, 22528
    buffer_load_dwordx4 v[104:107], v5, s[4:7], s39 offen sc1
    s_add_u32 s39, s38, 9216
    buffer_load_dwordx4 v[52:55], v5, s[4:7], s39 offen sc1
    s_add_u32 s39, s38, 23552
    buffer_load_dwordx4 v[108:111], v5, s[4:7], s39 offen sc1
    s_add_u32 s39, s38, 10240
    buffer_load_dwordx4 v[56:59], v5, s[4:7], s39 offen sc1
    s_add_u32 s39, s38, 24576
    buffer_load_dwordx4 v[112:115], v5, s[4:7], s39 offen sc1
    s_add_u32 s39, s38, 11264
    buffer_load_dwordx4 v[60:63], v5, s[4:7], s39 offen sc1
    s_add_u32 s39, s38, 25600
    buffer_load_dwordx4 v[116:119], v5, s[4:7], s39 offen sc1
    s_add_u32 s39, s38, 12288
    buffer_load_dwordx4 v[64:67], v5, s[4:7], s39 offen sc1
    s_add_u32 s39, s38, 26624
    buffer_load_dwordx4 v[120:123], v5, s[4:7], s39 offen sc1
    s_add_u32 s39, s38, 13312
    buffer_load_dwordx4 v[68:71], v5, s[4:7], s39 offen sc1
    s_add_u32 s39, s38, 27648
    buffer_load_dwordx4 v[124:127], v5, s[4:7], s39 offen sc1
    s_add_u32 s40, s38, 114688
    s_mov_b32 s41, 0
    s_lshl_b32 s42, s66, 5
    s_add_u32 s42, s42, s67
    s_lshl_b32 s42, s42, 4
    s_add_u32 s42, s42, 78483456
    s_waitcnt vmcnt(0)
    v_mov_b32 v9, 1
    v_mfma_f32_16x16x32_bf16 v[128:131], v[16:19], a[0:3], 0
    v_mfma_f32_16x16x32_bf16 v[132:135], v[72:75], a[0:3], 0
    v_mfma_f32_16x16x32_bf16 v[136:139], v[16:19], a[56:59], 0
    v_mfma_f32_16x16x32_bf16 v[140:143], v[72:75], a[56:59], 0
    v_mfma_f32_16x16x32_bf16 v[128:131], v[20:23], a[4:7], v[128:131]
    v_mfma_f32_16x16x32_bf16 v[132:135], v[76:79], a[4:7], v[132:135]
    v_mfma_f32_16x16x32_bf16 v[136:139], v[20:23], a[60:63], v[136:139]
    v_mfma_f32_16x16x32_bf16 v[140:143], v[76:79], a[60:63], v[140:143]
    v_mfma_f32_16x16x32_bf16 v[128:131], v[24:27], a[8:11], v[128:131]
    v_mfma_f32_16x16x32_bf16 v[132:135], v[80:83], a[8:11], v[132:135]
    v_mfma_f32_16x16x32_bf16 v[136:139], v[24:27], a[64:67], v[136:139]
    v_mfma_f32_16x16x32_bf16 v[140:143], v[80:83], a[64:67], v[140:143]
    v_mfma_f32_16x16x32_bf16 v[128:131], v[28:31], a[12:15], v[128:131]
    v_mfma_f32_16x16x32_bf16 v[132:135], v[84:87], a[12:15], v[132:135]
    v_mfma_f32_16x16x32_bf16 v[136:139], v[28:31], a[68:71], v[136:139]
    v_mfma_f32_16x16x32_bf16 v[140:143], v[84:87], a[68:71], v[140:143]
    v_mfma_f32_16x16x32_bf16 v[128:131], v[32:35], a[16:19], v[128:131]
    v_mfma_f32_16x16x32_bf16 v[132:135], v[88:91], a[16:19], v[132:135]
    v_mfma_f32_16x16x32_bf16 v[136:139], v[32:35], a[72:75], v[136:139]
    v_mfma_f32_16x16x32_bf16 v[140:143], v[88:91], a[72:75], v[140:143]
    v_mfma_f32_16x16x32_bf16 v[128:131], v[36:39], a[20:23], v[128:131]
    v_mfma_f32_16x16x32_bf16 v[132:135], v[92:95], a[20:23], v[132:135]
    v_mfma_f32_16x16x32_bf16 v[136:139], v[36:39], a[76:79], v[136:139]
    v_mfma_f32_16x16x32_bf16 v[140:143], v[92:95], a[76:79], v[140:143]
    v_mfma_f32_16x16x32_bf16 v[128:131], v[40:43], a[24:27], v[128:131]
    v_mfma_f32_16x16x32_bf16 v[132:135], v[96:99], a[24:27], v[132:135]
    v_mfma_f32_16x16x32_bf16 v[136:139], v[40:43], a[80:83], v[136:139]
    v_mfma_f32_16x16x32_bf16 v[140:143], v[96:99], a[80:83], v[140:143]
    v_mfma_f32_16x16x32_bf16 v[128:131], v[44:47], a[28:31], v[128:131]
    v_mfma_f32_16x16x32_bf16 v[132:135], v[100:103], a[28:31], v[132:135]
    v_mfma_f32_16x16x32_bf16 v[136:139], v[44:47], a[84:87], v[136:139]
    v_mfma_f32_16x16x32_bf16 v[140:143], v[100:103], a[84:87], v[140:143]
    v_mfma_f32_16x16x32_bf16 v[128:131], v[48:51], a[32:35], v[128:131]
    v_mfma_f32_16x16x32_bf16 v[132:135], v[104:107], a[32:35], v[132:135]
    v_mfma_f32_16x16x32_bf16 v[136:139], v[48:51], a[88:91], v[136:139]
    v_mfma_f32_16x16x32_bf16 v[140:143], v[104:107], a[88:91], v[140:143]
    v_mfma_f32_16x16x32_bf16 v[128:131], v[52:55], a[36:39], v[128:131]
    v_mfma_f32_16x16x32_bf16 v[132:135], v[108:111], a[36:39], v[132:135]
    v_mfma_f32_16x16x32_bf16 v[136:139], v[52:55], a[92:95], v[136:139]
    v_mfma_f32_16x16x32_bf16 v[140:143], v[108:111], a[92:95], v[140:143]
    v_mfma_f32_16x16x32_bf16 v[128:131], v[56:59], a[40:43], v[128:131]
    v_mfma_f32_16x16x32_bf16 v[132:135], v[112:115], a[40:43], v[132:135]
    v_mfma_f32_16x16x32_bf16 v[136:139], v[56:59], a[96:99], v[136:139]
    v_mfma_f32_16x16x32_bf16 v[140:143], v[112:115], a[96:99], v[140:143]
    v_mfma_f32_16x16x32_bf16 v[128:131], v[60:63], a[44:47], v[128:131]
    v_mfma_f32_16x16x32_bf16 v[132:135], v[116:119], a[44:47], v[132:135]
    v_mfma_f32_16x16x32_bf16 v[136:139], v[60:63], a[100:103], v[136:139]
    v_mfma_f32_16x16x32_bf16 v[140:143], v[116:119], a[100:103], v[140:143]
    v_mfma_f32_16x16x32_bf16 v[128:131], v[64:67], a[48:51], v[128:131]
    v_mfma_f32_16x16x32_bf16 v[132:135], v[120:123], a[48:51], v[132:135]
    v_mfma_f32_16x16x32_bf16 v[136:139], v[64:67], a[104:107], v[136:139]
    v_mfma_f32_16x16x32_bf16 v[140:143], v[120:123], a[104:107], v[140:143]
    v_mfma_f32_16x16x32_bf16 v[128:131], v[68:71], a[52:55], v[128:131]
    v_mfma_f32_16x16x32_bf16 v[132:135], v[124:127], a[52:55], v[132:135]
    v_mfma_f32_16x16x32_bf16 v[136:139], v[68:71], a[108:111], v[136:139]
    v_mfma_f32_16x16x32_bf16 v[140:143], v[124:127], a[108:111], v[140:143]
    s_nop 5
    v_cvt_pk_bf16_f32 v192, v128, v132
    s_nop 0
    v_cvt_pk_bf16_f32 v193, v136, v140
    v_cvt_pk_bf16_f32 v194, v129, v133
    v_cvt_pk_bf16_f32 v195, v137, v141
    buffer_store_dwordx4 v[192:195], v7, s[4:7], s36 offen offset:0 sc1
    v_cvt_pk_bf16_f32 v196, v130, v134
    v_cvt_pk_bf16_f32 v197, v138, v142
    v_cvt_pk_bf16_f32 v198, v131, v135
    v_cvt_pk_bf16_f32 v199, v139, v143
    buffer_store_dwordx4 v[196:199], v7, s[4:7], s36 offen offset:1024 sc1
    v_mfma_f32_16x16x32_bf16 v[144:147], a[112:115], v[16:19], 0
    v_mfma_f32_16x16x32_bf16 v[148:151], a[112:115], v[72:75], 0
    v_mfma_f32_16x16x32_bf16 v[152:155], a[168:171], v[16:19], 0
    v_mfma_f32_16x16x32_bf16 v[156:159], a[168:171], v[72:75], 0
    s_add_u32 s39, s40, 0
    buffer_load_dwordx4 v[16:19], v5, s[4:7], s39 offen sc1
    s_add_u32 s39, s40, 14336
    buffer_load_dwordx4 v[72:75], v5, s[4:7], s39 offen sc1
    v_mfma_f32_16x16x32_bf16 v[144:147], a[116:119], v[20:23], v[144:147]
    v_mfma_f32_16x16x32_bf16 v[148:151], a[116:119], v[76:79], v[148:151]
    v_mfma_f32_16x16x32_bf16 v[152:155], a[172:175], v[20:23], v[152:155]
    v_mfma_f32_16x16x32_bf16 v[156:159], a[172:175], v[76:79], v[156:159]
    s_add_u32 s39, s40, 1024
    buffer_load_dwordx4 v[20:23], v5, s[4:7], s39 offen sc1
    s_add_u32 s39, s40, 15360
    buffer_load_dwordx4 v[76:79], v5, s[4:7], s39 offen sc1
    v_mfma_f32_16x16x32_bf16 v[144:147], a[120:123], v[24:27], v[144:147]
    v_mfma_f32_16x16x32_bf16 v[148:151], a[120:123], v[80:83], v[148:151]
    v_mfma_f32_16x16x32_bf16 v[152:155], a[176:179], v[24:27], v[152:155]
    v_mfma_f32_16x16x32_bf16 v[156:159], a[176:179], v[80:83], v[156:159]
    s_add_u32 s39, s40, 2048
    buffer_load_dwordx4 v[24:27], v5, s[4:7], s39 offen sc1
    s_add_u32 s39, s40, 16384
    buffer_load_dwordx4 v[80:83], v5, s[4:7], s39 offen sc1
    v_mfma_f32_16x16x32_bf16 v[144:147], a[124:127], v[28:31], v[144:147]
    v_mfma_f32_16x16x32_bf16 v[148:151], a[124:127], v[84:87], v[148:151]
    v_mfma_f32_16x16x32_bf16 v[152:155], a[180:183], v[28:31], v[152:155]
    v_mfma_f32_16x16x32_bf16 v[156:159], a[180:183], v[84:87], v[156:159]
    s_add_u32 s39, s40, 3072
    buffer_load_dwordx4 v[28:31], v5, s[4:7], s39 offen sc1
    s_add_u32 s39, s40, 17408
    buffer_load_dwordx4 v[84:87], v5, s[4:7], s39 offen sc1
    v_mfma_f32_16x16x32_bf16 v[144:147], a[128:131], v[32:35], v[144:147]
    v_mfma_f32_16x16x32_bf16 v[148:151], a[128:131], v[88:91], v[148:151]
    v_mfma_f32_16x16x32_bf16 v[152:155], a[184:187], v[32:35], v[152:155]
    v_mfma_f32_16x16x32_bf16 v[156:159], a[184:187], v[88:91], v[156:159]
    s_add_u32 s39, s40, 4096
    buffer_load_dwordx4 v[32:35], v5, s[4:7], s39 offen sc1
    s_add_u32 s39, s40, 18432
    buffer_load_dwordx4 v[88:91], v5, s[4:7], s39 offen sc1
    v_mfma_f32_16x16x32_bf16 v[144:147], a[132:135], v[36:39], v[144:147]
    v_mfma_f32_16x16x32_bf16 v[148:151], a[132:135], v[92:95], v[148:151]
    v_mfma_f32_16x16x32_bf16 v[152:155], a[188:191], v[36:39], v[152:155]
    v_mfma_f32_16x16x32_bf16 v[156:159], a[188:191], v[92:95], v[156:159]
    s_add_u32 s39, s40, 5120
    buffer_load_dwordx4 v[36:39], v5, s[4:7], s39 offen sc1
    s_add_u32 s39, s40, 19456
    buffer_load_dwordx4 v[92:95], v5, s[4:7], s39 offen sc1
    v_mfma_f32_16x16x32_bf16 v[144:147], a[136:139], v[40:43], v[144:147]
    v_mfma_f32_16x16x32_bf16 v[148:151], a[136:139], v[96:99], v[148:151]
    v_mfma_f32_16x16x32_bf16 v[152:155], a[192:195], v[40:43], v[152:155]
    v_mfma_f32_16x16x32_bf16 v[156:159], a[192:195], v[96:99], v[156:159]
    s_add_u32 s39, s40, 6144
    buffer_load_dwordx4 v[40:43], v5, s[4:7], s39 offen sc1
    s_add_u32 s39, s40, 20480
    buffer_load_dwordx4 v[96:99], v5, s[4:7], s39 offen sc1
    v_mfma_f32_16x16x32_bf16 v[144:147], a[140:143], v[44:47], v[144:147]
    v_mfma_f32_16x16x32_bf16 v[148:151], a[140:143], v[100:103], v[148:151]
    v_mfma_f32_16x16x32_bf16 v[152:155], a[196:199], v[44:47], v[152:155]
    v_mfma_f32_16x16x32_bf16 v[156:159], a[196:199], v[100:103], v[156:159]
    s_add_u32 s39, s40, 7168
    buffer_load_dwordx4 v[44:47], v5, s[4:7], s39 offen sc1
    s_add_u32 s39, s40, 21504
    buffer_load_dwordx4 v[100:103], v5, s[4:7], s39 offen sc1
    v_mfma_f32_16x16x32_bf16 v[144:147], a[144:147], v[48:51], v[144:147]
    v_mfma_f32_16x16x32_bf16 v[148:151], a[144:147], v[104:107], v[148:151]
    v_mfma_f32_16x16x32_bf16 v[152:155], a[200:203], v[48:51], v[152:155]
    v_mfma_f32_16x16x32_bf16 v[156:159], a[200:203], v[104:107], v[156:159]
    s_add_u32 s39, s40, 8192
    buffer_load_dwordx4 v[48:51], v5, s[4:7], s39 offen sc1
    s_add_u32 s39, s40, 22528
    buffer_load_dwordx4 v[104:107], v5, s[4:7], s39 offen sc1
    v_mfma_f32_16x16x32_bf16 v[144:147], a[148:151], v[52:55], v[144:147]
    v_mfma_f32_16x16x32_bf16 v[148:151], a[148:151], v[108:111], v[148:151]
    v_mfma_f32_16x16x32_bf16 v[152:155], a[204:207], v[52:55], v[152:155]
    v_mfma_f32_16x16x32_bf16 v[156:159], a[204:207], v[108:111], v[156:159]
    s_add_u32 s39, s40, 9216
    buffer_load_dwordx4 v[52:55], v5, s[4:7], s39 offen sc1
    s_add_u32 s39, s40, 23552
    buffer_load_dwordx4 v[108:111], v5, s[4:7], s39 offen sc1
    v_mfma_f32_16x16x32_bf16 v[144:147], a[152:155], v[56:59], v[144:147]
    v_mfma_f32_16x16x32_bf16 v[148:151], a[152:155], v[112:115], v[148:151]
    v_mfma_f32_16x16x32_bf16 v[152:155], a[208:211], v[56:59], v[152:155]
    v_mfma_f32_16x16x32_bf16 v[156:159], a[208:211], v[112:115], v[156:159]
    s_add_u32 s39, s40, 10240
    buffer_load_dwordx4 v[56:59], v5, s[4:7], s39 offen sc1
    s_add_u32 s39, s40, 24576
    buffer_load_dwordx4 v[112:115], v5, s[4:7], s39 offen sc1
    v_mfma_f32_16x16x32_bf16 v[144:147], a[156:159], v[60:63], v[144:147]
    v_mfma_f32_16x16x32_bf16 v[148:151], a[156:159], v[116:119], v[148:151]
    v_mfma_f32_16x16x32_bf16 v[152:155], a[212:215], v[60:63], v[152:155]
    v_mfma_f32_16x16x32_bf16 v[156:159], a[212:215], v[116:119], v[156:159]
    s_add_u32 s39, s40, 11264
    buffer_load_dwordx4 v[60:63], v5, s[4:7], s39 offen sc1
    s_add_u32 s39, s40, 25600
    buffer_load_dwordx4 v[116:119], v5, s[4:7], s39 offen sc1
    v_mfma_f32_16x16x32_bf16 v[144:147], a[160:163], v[64:67], v[144:147]
    v_mfma_f32_16x16x32_bf16 v[148:151], a[160:163], v[120:123], v[148:151]
    v_mfma_f32_16x16x32_bf16 v[152:155], a[216:219], v[64:67], v[152:155]
    v_mfma_f32_16x16x32_bf16 v[156:159], a[216:219], v[120:123], v[156:159]
    s_add_u32 s39, s40, 12288
    buffer_load_dwordx4 v[64:67], v5, s[4:7], s39 offen sc1
    s_add_u32 s39, s40, 26624
    buffer_load_dwordx4 v[120:123], v5, s[4:7], s39 offen sc1
    v_mfma_f32_16x16x32_bf16 v[144:147], a[164:167], v[68:71], v[144:147]
    v_mfma_f32_16x16x32_bf16 v[148:151], a[164:167], v[124:127], v[148:151]
    v_mfma_f32_16x16x32_bf16 v[152:155], a[220:223], v[68:71], v[152:155]
    v_mfma_f32_16x16x32_bf16 v[156:159], a[220:223], v[124:127], v[156:159]
    s_add_u32 s39, s40, 13312
    buffer_load_dwordx4 v[68:71], v5, s[4:7], s39 offen sc1
    s_add_u32 s39, s40, 27648
    buffer_load_dwordx4 v[124:127], v5, s[4:7], s39 offen sc1
    s_waitcnt vmcnt(28)
    s_lshl_b32 s43, s64, 4
    s_add_u32 s43, s43, 78619136
    s_barrier
    s_cmp_eq_u32 s28, 0
    s_cbranch_scc0 G1_sge
    s_mov_b64 exec, 1
    buffer_store_dword v9, off, s[4:7], s43 sc1
    s_mov_b64 exec, -1
G1_sge:
    v_cvt_pk_bf16_f32 v200, v144, v145
    v_cvt_pk_bf16_f32 v201, v146, v147
    v_cvt_pk_bf16_f32 v202, v152, v153
    v_cvt_pk_bf16_f32 v203, v154, v155
    buffer_store_dwordx4 v[200:203], v7, s[4:7], s37 offen offset:0 sc1
    v_cvt_pk_bf16_f32 v204, v148, v149
    v_cvt_pk_bf16_f32 v205, v150, v151
    v_cvt_pk_bf16_f32 v206, v156, v157
    v_cvt_pk_bf16_f32 v207, v158, v159
    buffer_store_dwordx4 v[204:207], v7, s[4:7], s37 offen offset:1024 sc1
    s_waitcnt vmcnt(0)
    s_barrier
    s_cmp_eq_u32 s28, 0
    s_cbranch_scc0 G1_sg0
    s_mov_b64 exec, 1
    buffer_store_dword v9, off, s[4:7], s42 sc1
    s_mov_b64 exec, -1
G1_sg0:
    s_add_u32 s36, s36, 1835008
    s_add_u32 s37, s37, 1835008
    s_add_u32 s40, s40, 114688
    s_add_u32 s42, s42, 4096
    s_add_u32 s41, s41, 1
G1_loop:
    s_waitcnt vmcnt(30)
    v_mfma_f32_16x16x32_bf16 v[128:131], v[16:19], a[0:3], 0
    v_mfma_f32_16x16x32_bf16 v[132:135], v[72:75], a[0:3], 0
    v_mfma_f32_16x16x32_bf16 v[136:139], v[16:19], a[56:59], 0
    v_mfma_f32_16x16x32_bf16 v[140:143], v[72:75], a[56:59], 0
    v_mfma_f32_16x16x32_bf16 v[144:147], a[112:115], v[16:19], 0
    v_mfma_f32_16x16x32_bf16 v[148:151], a[112:115], v[72:75], 0
    v_mfma_f32_16x16x32_bf16 v[152:155], a[168:171], v[16:19], 0
    v_mfma_f32_16x16x32_bf16 v[156:159], a[168:171], v[72:75], 0
    s_add_u32 s39, s40, 0
    buffer_load_dwordx4 v[16:19], v5, s[4:7], s39 offen sc1
    s_add_u32 s39, s40, 14336
    buffer_load_dwordx4 v[72:75], v5, s[4:7], s39 offen sc1
    s_waitcnt vmcnt(30)
    v_mfma_f32_16x16x32_bf16 v[128:131], v[20:23], a[4:7], v[128:131]
    v_mfma_f32_16x16x32_bf16 v[132:135], v[76:79], a[4:7], v[132:135]
    v_mfma_f32_16x16x32_bf16 v[136:139], v[20:23], a[60:63], v[136:139]
    v_mfma_f32_16x16x32_bf16 v[140:143], v[76:79], a[60:63], v[140:143]
    v_mfma_f32_16x16x32_bf16 v[144:147], a[116:119], v[20:23], v[144:147]
    v_mfma_f32_16x16x32_bf16 v[148:151], a[116:119], v[76:79], v[148:151]
    v_mfma_f32_16x16x32_bf16 v[152:155], a[172:175], v[20:23], v[152:155]
    v_mfma_f32_16x16x32_bf16 v[156:159], a[172:175], v[76:79], v[156:159]
    s_add_u32 s39, s40, 1024
    buffer_load_dwordx4 v[20:23], v5, s[4:7], s39 offen sc1
    s_add_u32 s39, s40, 15360
    buffer_load_dwordx4 v[76:79], v5, s[4:7], s39 offen sc1
    s_waitcnt vmcnt(30)
    v_mfma_f32_16x16x32_bf16 v[128:131], v[24:27], a[8:11], v[128:131]
    v_mfma_f32_16x16x32_bf16 v[132:135], v[80:83], a[8:11], v[132:135]
    v_mfma_f32_16x16x32_bf16 v[136:139], v[24:27], a[64:67], v[136:139]
    v_mfma_f32_16x16x32_bf16 v[140:143], v[80:83], a[64:67], v[140:143]
    v_mfma_f32_16x16x32_bf16 v[144:147], a[120:123], v[24:27], v[144:147]
    v_mfma_f32_16x16x32_bf16 v[148:151], a[120:123], v[80:83], v[148:151]
    v_mfma_f32_16x16x32_bf16 v[152:155], a[176:179], v[24:27], v[152:155]
    v_mfma_f32_16x16x32_bf16 v[156:159], a[176:179], v[80:83], v[156:159]
    s_add_u32 s39, s40, 2048
    buffer_load_dwordx4 v[24:27], v5, s[4:7], s39 offen sc1
    s_add_u32 s39, s40, 16384
    buffer_load_dwordx4 v[80:83], v5, s[4:7], s39 offen sc1
    s_waitcnt vmcnt(30)
    v_mfma_f32_16x16x32_bf16 v[128:131], v[28:31], a[12:15], v[128:131]
    v_mfma_f32_16x16x32_bf16 v[132:135], v[84:87], a[12:15], v[132:135]
    v_mfma_f32_16x16x32_bf16 v[136:139], v[28:31], a[68:71], v[136:139]
    v_mfma_f32_16x16x32_bf16 v[140:143], v[84:87], a[68:71], v[140:143]
    v_mfma_f32_16x16x32_bf16 v[144:147], a[124:127], v[28:31], v[144:147]
    v_mfma_f32_16x16x32_bf16 v[148:151], a[124:127], v[84:87], v[148:151]
    v_mfma_f32_16x16x32_bf16 v[152:155], a[180:183], v[28:31], v[152:155]
    v_mfma_f32_16x16x32_bf16 v[156:159], a[180:183], v[84:87], v[156:159]
    s_add_u32 s39, s40, 3072
    buffer_load_dwordx4 v[28:31], v5, s[4:7], s39 offen sc1
    s_add_u32 s39, s40, 17408
    buffer_load_dwordx4 v[84:87], v5, s[4:7], s39 offen sc1
    s_waitcnt vmcnt(30)
    v_mfma_f32_16x16x32_bf16 v[128:131], v[32:35], a[16:19], v[128:131]
    v_mfma_f32_16x16x32_bf16 v[132:135], v[88:91], a[16:19], v[132:135]
    v_mfma_f32_16x16x32_bf16 v[136:139], v[32:35], a[72:75], v[136:139]
    v_mfma_f32_16x16x32_bf16 v[140:143], v[88:91], a[72:75], v[140:143]
    v_mfma_f32_16x16x32_bf16 v[144:147], a[128:131], v[32:35], v[144:147]
    v_mfma_f32_16x16x32_bf16 v[148:151], a[128:131], v[88:91], v[148:151]
    v_mfma_f32_16x16x32_bf16 v[152:155], a[184:187], v[32:35], v[152:155]
    v_mfma_f32_16x16x32_bf16 v[156:159], a[184:187], v[88:91], v[156:159]
    s_add_u32 s39, s40, 4096
    buffer_load_dwordx4 v[32:35], v5, s[4:7], s39 offen sc1
    s_add_u32 s39, s40, 18432
    buffer_load_dwordx4 v[88:91], v5, s[4:7], s39 offen sc1
    s_waitcnt vmcnt(30)
    v_mfma_f32_16x16x32_bf16 v[128:131], v[36:39], a[20:23], v[128:131]
    v_mfma_f32_16x16x32_bf16 v[132:135], v[92:95], a[20:23], v[132:135]
    v_mfma_f32_16x16x32_bf16 v[136:139], v[36:39], a[76:79], v[136:139]
    v_mfma_f32_16x16x32_bf16 v[140:143], v[92:95], a[76:79], v[140:143]
    v_mfma_f32_16x16x32_bf16 v[144:147], a[132:135], v[36:39], v[144:147]
    v_mfma_f32_16x16x32_bf16 v[148:151], a[132:135], v[92:95], v[148:151]
    v_mfma_f32_16x16x32_bf16 v[152:155], a[188:191], v[36:39], v[152:155]
    v_mfma_f32_16x16x32_bf16 v[156:159], a[188:191], v[92:95], v[156:159]
    s_add_u32 s39, s40, 5120
    buffer_load_dwordx4 v[36:39], v5, s[4:7], s39 offen sc1
    s_add_u32 s39, s40, 19456
    buffer_load_dwordx4 v[92:95], v5, s[4:7], s39 offen sc1
    s_waitcnt vmcnt(30)
    v_mfma_f32_16x16x32_bf16 v[128:131], v[40:43], a[24:27], v[128:131]
    v_mfma_f32_16x16x32_bf16 v[132:135], v[96:99], a[24:27], v[132:135]
    v_mfma_f32_16x16x32_bf16 v[136:139], v[40:43], a[80:83], v[136:139]
    v_mfma_f32_16x16x32_bf16 v[140:143], v[96:99], a[80:83], v[140:143]
    v_mfma_f32_16x16x32_bf16 v[144:147], a[136:139], v[40:43], v[144:147]
    v_mfma_f32_16x16x32_bf16 v[148:151], a[136:139], v[96:99], v[148:151]
    v_mfma_f32_16x16x32_bf16 v[152:155], a[192:195], v[40:43], v[152:155]
    v_mfma_f32_16x16x32_bf16 v[156:159], a[192:195], v[96:99], v[156:159]
    s_add_u32 s39, s40, 6144
    buffer_load_dwordx4 v[40:43], v5, s[4:7], s39 offen sc1
    s_add_u32 s39, s40, 20480
    buffer_load_dwordx4 v[96:99], v5, s[4:7], s39 offen sc1
    s_waitcnt vmcnt(30)
    v_mfma_f32_16x16x32_bf16 v[128:131], v[44:47], a[28:31], v[128:131]
    v_mfma_f32_16x16x32_bf16 v[132:135], v[100:103], a[28:31], v[132:135]
    v_mfma_f32_16x16x32_bf16 v[136:139], v[44:47], a[84:87], v[136:139]
    v_mfma_f32_16x16x32_bf16 v[140:143], v[100:103], a[84:87], v[140:143]
    v_mfma_f32_16x16x32_bf16 v[144:147], a[140:143], v[44:47], v[144:147]
    v_mfma_f32_16x16x32_bf16 v[148:151], a[140:143], v[100:103], v[148:151]
    v_mfma_f32_16x16x32_bf16 v[152:155], a[196:199], v[44:47], v[152:155]
    v_mfma_f32_16x16x32_bf16 v[156:159], a[196:199], v[100:103], v[156:159]
    s_add_u32 s39, s40, 7168
    buffer_load_dwordx4 v[44:47], v5, s[4:7], s39 offen sc1
    s_add_u32 s39, s40, 21504
    buffer_load_dwordx4 v[100:103], v5, s[4:7], s39 offen sc1
    s_waitcnt vmcnt(30)
    v_mfma_f32_16x16x32_bf16 v[128:131], v[48:51], a[32:35], v[128:131]
    v_mfma_f32_16x16x32_bf16 v[132:135], v[104:107], a[32:35], v[132:135]
    v_mfma_f32_16x16x32_bf16 v[136:139], v[48:51], a[88:91], v[136:139]
    v_mfma_f32_16x16x32_bf16 v[140:143], v[104:107], a[88:91], v[140:143]
    v_mfma_f32_16x16x32_bf16 v[144:147], a[144:147], v[48:51], v[144:147]
    v_mfma_f32_16x16x32_bf16 v[148:151], a[144:147], v[104:107], v[148:151]
    v_mfma_f32_16x16x32_bf16 v[152:155], a[200:203], v[48:51], v[152:155]
    v_mfma_f32_16x16x32_bf16 v[156:159], a[200:203], v[104:107], v[156:159]
    s_add_u32 s39, s40, 8192
    buffer_load_dwordx4 v[48:51], v5, s[4:7], s39 offen sc1
    s_add_u32 s39, s40, 22528
    buffer_load_dwordx4 v[104:107], v5, s[4:7], s39 offen sc1
    s_waitcnt vmcnt(30)
    v_mfma_f32_16x16x32_bf16 v[128:131], v[52:55], a[36:39], v[128:131]
    v_mfma_f32_16x16x32_bf16 v[132:135], v[108:111], a[36:39], v[132:135]
    v_mfma_f32_16x16x32_bf16 v[136:139], v[52:55], a[92:95], v[136:139]
    v_mfma_f32_16x16x32_bf16 v[140:143], v[108:111], a[92:95], v[140:143]
    v_mfma_f32_16x16x32_bf16 v[144:147], a[148:151], v[52:55], v[144:147]
    v_mfma_f32_16x16x32_bf16 v[148:151], a[148:151], v[108:111], v[148:151]
    v_mfma_f32_16x16x32_bf16 v[152:155], a[204:207], v[52:55], v[152:155]
    v_mfma_f32_16x16x32_bf16 v[156:159], a[204:207], v[108:111], v[156:159]
    s_add_u32 s39, s40, 9216
    buffer_load_dwordx4 v[52:55], v5, s[4:7], s39 offen sc1
    s_add_u32 s39, s40, 23552
    buffer_load_dwordx4 v[108:111], v5, s[4:7], s39 offen sc1
    s_waitcnt vmcnt(30)
    v_mfma_f32_16x16x32_bf16 v[128:131], v[56:59], a[40:43], v[128:131]
    v_mfma_f32_16x16x32_bf16 v[132:135], v[112:115], a[40:43], v[132:135]
    v_mfma_f32_16x16x32_bf16 v[136:139], v[56:59], a[96:99], v[136:139]
    v_mfma_f32_16x16x32_bf16 v[140:143], v[112:115], a[96:99], v[140:143]
    v_mfma_f32_16x16x32_bf16 v[144:147], a[152:155], v[56:59], v[144:147]
    v_mfma_f32_16x16x32_bf16 v[148:151], a[152:155], v[112:115], v[148:151]
    v_mfma_f32_16x16x32_bf16 v[152:155], a[208:211], v[56:59], v[152:155]
    v_mfma_f32_16x16x32_bf16 v[156:159], a[208:211], v[112:115], v[156:159]
    s_add_u32 s39, s40, 10240
    buffer_load_dwordx4 v[56:59], v5, s[4:7], s39 offen sc1
    s_add_u32 s39, s40, 24576
    buffer_load_dwordx4 v[112:115], v5, s[4:7], s39 offen sc1
    s_waitcnt vmcnt(30)
    v_mfma_f32_16x16x32_bf16 v[128:131], v[60:63], a[44:47], v[128:131]
    v_mfma_f32_16x16x32_bf16 v[132:135], v[116:119], a[44:47], v[132:135]
    v_mfma_f32_16x16x32_bf16 v[136:139], v[60:63], a[100:103], v[136:139]
    v_mfma_f32_16x16x32_bf16 v[140:143], v[116:119], a[100:103], v[140:143]
    v_mfma_f32_16x16x32_bf16 v[144:147], a[156:159], v[60:63], v[144:147]
    v_mfma_f32_16x16x32_bf16 v[148:151], a[156:159], v[116:119], v[148:151]
    v_mfma_f32_16x16x32_bf16 v[152:155], a[212:215], v[60:63], v[152:155]
    v_mfma_f32_16x16x32_bf16 v[156:159], a[212:215], v[116:119], v[156:159]
    s_add_u32 s39, s40, 11264
    buffer_load_dwordx4 v[60:63], v5, s[4:7], s39 offen sc1
    s_add_u32 s39, s40, 25600
    buffer_load_dwordx4 v[116:119], v5, s[4:7], s39 offen sc1
    s_waitcnt vmcnt(30)
    v_mfma_f32_16x16x32_bf16 v[128:131], v[64:67], a[48:51], v[128:131]
    v_mfma_f32_16x16x32_bf16 v[132:135], v[120:123], a[48:51], v[132:135]
    v_mfma_f32_16x16x32_bf16 v[136:139], v[64:67], a[104:107], v[136:139]
    v_mfma_f32_16x16x32_bf16 v[140:143], v[120:123], a[104:107], v[140:143]
    v_mfma_f32_16x16x32_bf16 v[144:147], a[160:163], v[64:67], v[144:147]
    v_mfma_f32_16x16x32_bf16 v[148:151], a[160:163], v[120:123], v[148:151]
    v_mfma_f32_16x16x32_bf16 v[152:155], a[216:219], v[64:67], v[152:155]
    v_mfma_f32_16x16x32_bf16 v[156:159], a[216:219], v[120:123], v[156:159]
    s_add_u32 s39, s40, 12288
    buffer_load_dwordx4 v[64:67], v5, s[4:7], s39 offen sc1
    s_add_u32 s39, s40, 26624
    buffer_load_dwordx4 v[120:123], v5, s[4:7], s39 offen sc1
    s_waitcnt vmcnt(30)
    v_mfma_f32_16x16x32_bf16 v[128:131], v[68:71], a[52:55], v[128:131]
    v_mfma_f32_16x16x32_bf16 v[132:135], v[124:127], a[52:55], v[132:135]
    v_mfma_f32_16x16x32_bf16 v[136:139], v[68:71], a[108:111], v[136:139]
    v_mfma_f32_16x16x32_bf16 v[140:143], v[124:127], a[108:111], v[140:143]
    v_mfma_f32_16x16x32_bf16 v[144:147], a[164:167], v[68:71], v[144:147]
    v_mfma_f32_16x16x32_bf16 v[148:151], a[164:167], v[124:127], v[148:151]
    v_mfma_f32_16x16x32_bf16 v[152:155], a[220:223], v[68:71], v[152:155]
    v_mfma_f32_16x16x32_bf16 v[156:159], a[220:223], v[124:127], v[156:159]
    s_add_u32 s39, s40, 13312
    buffer_load_dwordx4 v[68:71], v5, s[4:7], s39 offen sc1
    s_add_u32 s39, s40, 27648
    buffer_load_dwordx4 v[124:127], v5, s[4:7], s39 offen sc1
    s_cmp_ge_u32 s41, 2
    s_cbranch_scc0 G1_sig2
    s_waitcnt vmcnt(28)
    s_sub_u32 s43, s42, 4096
    s_barrier
    s_cmp_eq_u32 s28, 0
    s_cbranch_scc0 G1_sg1
    s_mov_b64 exec, 1
    buffer_store_dword v9, off, s[4:7], s43 sc1
    s_mov_b64 exec, -1
G1_sg1:
G1_sig2:
    v_cvt_pk_bf16_f32 v192, v128, v132
    v_cvt_pk_bf16_f32 v193, v136, v140
    v_cvt_pk_bf16_f32 v194, v129, v133
    v_cvt_pk_bf16_f32 v195, v137, v141
    buffer_store_dwordx4 v[192:195], v7, s[4:7], s36 offen offset:0 sc1
    v_cvt_pk_bf16_f32 v196, v130, v134
    v_cvt_pk_bf16_f32 v197, v138, v142
    v_cvt_pk_bf16_f32 v198, v131, v135
    v_cvt_pk_bf16_f32 v199, v139, v143
    buffer_store_dwordx4 v[196:199], v7, s[4:7], s36 offen offset:1024 sc1
    v_cvt_pk_bf16_f32 v200, v144, v145
    v_cvt_pk_bf16_f32 v201, v146, v147
    v_cvt_pk_bf16_f32 v202, v152, v153
    v_cvt_pk_bf16_f32 v203, v154, v155
    buffer_store_dwordx4 v[200:203], v7, s[4:7], s37 offen offset:0 sc1
    v_cvt_pk_bf16_f32 v204, v148, v149
    v_cvt_pk_bf16_f32 v205, v150, v151
    v_cvt_pk_bf16_f32 v206, v156, v157
    v_cvt_pk_bf16_f32 v207, v158, v159
    buffer_store_dwordx4 v[204:207], v7, s[4:7], s37 offen offset:1024 sc1
    s_add_u32 s36, s36, 1835008
    s_add_u32 s37, s37, 1835008
    s_add_u32 s40, s40, 114688
    s_add_u32 s42, s42, 4096
    s_add_u32 s41, s41, 1
    s_cmp_lt_u32 s41, 16
    s_cbranch_scc1 G1_loop
    s_waitcnt vmcnt(0)
    s_sub_u32 s43, s42, 4096
    s_barrier
    s_cmp_eq_u32 s28, 0
    s_cbranch_scc0 G1_sgl
    s_mov_b64 exec, 1
    buffer_store_dword v9, off, s[4:7], s43 sc1
    s_mov_b64 exec, -1
G1_sgl:
    s_waitcnt vmcnt(0)
    s_cmp_lt_u32 s64, 112
    s_cbranch_scc1 C_pk
    s_cmp_lt_u32 s64, 210
    s_cbranch_scc1 C_ok
    s_cmp_eq_u32 s65, 0
    s_cbranch_scc1 K_spare
    s_endpgm
K_spare:
    s_mov_b32 s65, 1
    s_mul_i32 s53, s65, 79691776
    s_add_u32 s53, s53, 30408704
    s_add_u32 s4, s68, s53
    s_addc_u32 s5, s69, 0
    s_and_b32 s5, s5, 0xffff
    s_mov_b32 s6, 79691776
    s_mov_b32 s7, 0x20000
    s_add_u32 s8, s68, 28311552
    s_addc_u32 s9, s69, 0
    s_and_b32 s9, s9, 0xffff
    s_mov_b32 s10, 1835008
    s_mov_b32 s11, 0x20000
    s_sub_u32 s55, s64, 210
    s_mov_b32 s77, 1
    s_branch K_f1
K_spare_next:
    s_add_u32 s55, s55, 14
    s_cmp_lt_u32 s55, 256
    s_cbranch_scc1 K_f1
    s_branch K_layer
C_pk:
    s_and_b32 s13, s64, 7
    s_lshr_b32 s12, s64, 3
PK_loop:
    s_cmp_eq_u32 s76, 0
    s_cbranch_scc0 PK_cnt_ok
    s_mov_b32 s48, 78618752
    s_mov_b32 s54, 1048576
PK_cnt:
    buffer_load_dword v2, off, s[4:7], s48 sc1
    s_mov_b32 s90, 37
    s_sub_u32 s54, s54, 1
    s_cmp_eq_u32 s54, 0
    s_cbranch_scc1 L_abort1
    s_waitcnt vmcnt(0)
    v_readfirstlane_b32 s49, v2
    s_nop 0
    s_cmp_gt_u32 s49, s12
    s_cbranch_scc1 PK_cnt_ok
    s_cmp_ge_u32 s12, 56
    s_cbranch_scc1 PK_cnt
    s_sleep 16
    s_branch PK_cnt
PK_cnt_ok:
    s_barrier
    v_accvgpr_read_b32 v0, a255
    s_mov_b32 s28, s76
    v_and_b32 v0, 63, v0
    s_lshr_b32 s29, s28, 1
    s_and_b32 s30, s28, 1
    s_lshl_b32 s31, s13, 1
    s_add_u32 s31, s31, s29
    v_lshlrev_b32 v5, 4, v0
    v_lshlrev_b32 v7, 4, v0
    s_mul_i32 s34, s12, 458752
    s_mul_i32 s35, s31, 28672
    s_add_u32 s34, s34, s35
    s_lshl_b32 s35, s30, 10
    s_add_u32 s34, s34, s35
    s_add_u32 s34, s34, 40472576
    buffer_load_dwordx4 v[16:19], v7, s[4:7], s34 offen sc1
    s_add_u32 s34, s34, 2048
    buffer_load_dwordx4 v[20:23], v7, s[4:7], s34 offen sc1
    s_add_u32 s34, s34, 2048
    buffer_load_dwordx4 v[24:27], v7, s[4:7], s34 offen sc1
    s_add_u32 s34, s34, 2048
    buffer_load_dwordx4 v[28:31], v7, s[4:7], s34 offen sc1
    s_add_u32 s34, s34, 2048
    buffer_load_dwordx4 v[32:35], v7, s[4:7], s34 offen sc1
    s_add_u32 s34, s34, 2048
    buffer_load_dwordx4 v[36:39], v7, s[4:7], s34 offen sc1
    s_add_u32 s34, s34, 2048
    buffer_load_dwordx4 v[40:43], v7, s[4:7], s34 offen sc1
    s_add_u32 s34, s34, 2048
    buffer_load_dwordx4 v[44:47], v7, s[4:7], s34 offen sc1
    s_add_u32 s34, s34, 2048
    buffer_load_dwordx4 v[48:51], v7, s[4:7], s34 offen sc1
    s_add_u32 s34, s34, 2048
    buffer_load_dwordx4 v[52:55], v7, s[4:7], s34 offen sc1
    s_add_u32 s34, s34, 2048
    buffer_load_dwordx4 v[56:59], v7, s[4:7], s34 offen sc1
    s_add_u32 s34, s34, 2048
    buffer_load_dwordx4 v[60:63], v7, s[4:7], s34 offen sc1
    s_add_u32 s34, s34, 2048
    buffer_load_dwordx4 v[64:67], v7, s[4:7], s34 offen sc1
    s_add_u32 s34, s34, 2048
    buffer_load_dwordx4 v[68:71], v7, s[4:7], s34 offen sc1
    s_add_u32 s34, s34, 2048
    s_mul_i32 s35, s12, 28672
    s_add_u32 s35, s35, 0
    s_add_u32 s36, s35, 0
    buffer_load_dwordx4 v[72:75], v5, s[4:7], s36 offen sc1
    s_add_u32 s36, s35, 14336
    buffer_load_dwordx4 v[76:79], v5, s[4:7], s36 offen sc1
    s_add_u32 s36, s35, 1024
    buffer_load_dwordx4 v[80:83], v5, s[4:7], s36 offen sc1
    s_add_u32 s36, s35, 15360
    buffer_load_dwordx4 v[84:87], v5, s[4:7], s36 offen sc1
    s_add_u32 s36, s35, 2048
    buffer_load_dwordx4 v[88:91], v5, s[4:7], s36 offen sc1
    s_add_u32 s36, s35, 16384
    buffer_load_dwordx4 v[92:95], v5, s[4:7], s36 offen sc1
    s_add_u32 s36, s35, 3072
    buffer_load_dwordx4 v[96:99], v5, s[4:7], s36 offen sc1
    s_add_u32 s36, s35, 17408
    buffer_load_dwordx4 v[100:103], v5, s[4:7], s36 offen sc1
    s_add_u32 s36, s35, 4096
    buffer_load_dwordx4 v[104:107], v5, s[4:7], s36 offen sc1
    s_add_u32 s36, s35, 18432
    buffer_load_dwordx4 v[108:111], v5, s[4:7], s36 offen sc1
    s_add_u32 s36, s35, 5120
    buffer_load_dwordx4 v[112:115], v5, s[4:7], s36 offen sc1
    s_add_u32 s36, s35, 19456
    buffer_load_dwordx4 v[116:119], v5, s[4:7], s36 offen sc1
    s_add_u32 s36, s35, 6144
    buffer_load_dwordx4 v[120:123], v5, s[4:7], s36 offen sc1
    s_add_u32 s36, s35, 20480
    buffer_load_dwordx4 v[124:127], v5, s[4:7], s36 offen sc1
    v_bfe_u32 v8, v0, 2, 2
    v_lshlrev_b32 v8, 1, v8
    v_and_b32 v9, 3, v0
    v_add_u32 v8, v8, v9
    v_min_u32 v8, 7, v8
    v_lshlrev_b32 v8, 4, v8
    v_lshrrev_b32 v9, 4, v0
    v_lshl_add_u32 v8, v9, 7, v8
    s_waitcnt vmcnt(12)
    v_mfma_f32_16x16x32_bf16 v[184:187], v[72:75], v[16:19], 0
    v_mfma_f32_16x16x32_bf16 v[188:191], v[76:79], v[16:19], 0
    s_add_u32 s36, s35, 7168
    buffer_load_dwordx4 v[72:75], v5, s[4:7], s36 offen sc1
    s_add_u32 s36, s35, 21504
    buffer_load_dwordx4 v[76:79], v5, s[4:7], s36 offen sc1
    s_waitcnt vmcnt(12)
    v_mfma_f32_16x16x32_bf16 v[184:187], v[80:83], v[20:23], v[184:187]
    v_mfma_f32_16x16x32_bf16 v[188:191], v[84:87], v[20:23], v[188:191]
    s_add_u32 s36, s35, 8192
    buffer_load_dwordx4 v[80:83], v5, s[4:7], s36 offen sc1
    s_add_u32 s36, s35, 22528
    buffer_load_dwordx4 v[84:87], v5, s[4:7], s36 offen sc1
    s_waitcnt vmcnt(12)
    v_mfma_f32_16x16x32_bf16 v[184:187], v[88:91], v[24:27], v[184:187]
    v_mfma_f32_16x16x32_bf16 v[188:191], v[92:95], v[24:27], v[188:191]
    s_add_u32 s36, s35, 9216
    buffer_load_dwordx4 v[88:91], v5, s[4:7], s36 offen sc1
    s_add_u32 s36, s35, 23552
    buffer_load_dwordx4 v[92:95], v5, s[4:7], s36 offen sc1
    s_waitcnt vmcnt(12)
    v_mfma_f32_16x16x32_bf16 v[184:187], v[96:99], v[28:31], v[184:187]
    v_mfma_f32_16x16x32_bf16 v[188:191], v[100:103], v[28:31], v[188:191]
    s_add_u32 s36, s35, 10240
    buffer_load_dwordx4 v[96:99], v5, s[4:7], s36 offen sc1
    s_add_u32 s36, s35, 24576
    buffer_load_dwordx4 v[100:103], v5, s[4:7], s36 offen sc1
    s_waitcnt vmcnt(12)
    v_mfma_f32_16x16x32_bf16 v[184:187], v[104:107], v[32:35], v[184:187]
    v_mfma_f32_16x16x32_bf16 v[188:191], v[108:111], v[32:35], v[188:191]
    s_add_u32 s36, s35, 11264
    buffer_load_dwordx4 v[104:107], v5, s[4:7], s36 offen sc1
    s_add_u32 s36, s35, 25600
    buffer_load_dwordx4 v[108:111], v5, s[4:7], s36 offen sc1
    s_waitcnt vmcnt(12)
    v_mfma_f32_16x16x32_bf16 v[184:187], v[112:115], v[36:39], v[184:187]
    v_mfma_f32_16x16x32_bf16 v[188:191], v[116:119], v[36:39], v[188:191]
    s_add_u32 s36, s35, 12288
    buffer_load_dwordx4 v[112:115], v5, s[4:7], s36 offen sc1
    s_add_u32 s36, s35, 26624
    buffer_load_dwordx4 v[116:119], v5, s[4:7], s36 offen sc1
    s_waitcnt vmcnt(12)
    v_mfma_f32_16x16x32_bf16 v[184:187], v[120:123], v[40:43], v[184:187]
    v_mfma_f32_16x16x32_bf16 v[188:191], v[124:127], v[40:43], v[188:191]
    s_add_u32 s36, s35, 13312
    buffer_load_dwordx4 v[120:123], v5, s[4:7], s36 offen sc1
    s_add_u32 s36, s35, 27648
    buffer_load_dwordx4 v[124:127], v5, s[4:7], s36 offen sc1
    s_waitcnt vmcnt(12)
    v_mfma_f32_16x16x32_bf16 v[184:187], v[72:75], v[44:47], v[184:187]
    v_mfma_f32_16x16x32_bf16 v[188:191], v[76:79], v[44:47], v[188:191]
    s_waitcnt vmcnt(10)
    v_mfma_f32_16x16x32_bf16 v[184:187], v[80:83], v[48:51], v[184:187]
    v_mfma_f32_16x16x32_bf16 v[188:191], v[84:87], v[48:51], v[188:191]
    s_waitcnt vmcnt(8)
    v_mfma_f32_16x16x32_bf16 v[184:187], v[88:91], v[52:55], v[184:187]
    v_mfma_f32_16x16x32_bf16 v[188:191], v[92:95], v[52:55], v[188:191]
    s_waitcnt vmcnt(6)
    v_mfma_f32_16x16x32_bf16 v[184:187], v[96:99], v[56:59], v[184:187]
    v_mfma_f32_16x16x32_bf16 v[188:191], v[100:103], v[56:59], v[188:191]
    s_waitcnt vmcnt(4)
    v_mfma_f32_16x16x32_bf16 v[184:187], v[104:107], v[60:63], v[184:187]
    v_mfma_f32_16x16x32_bf16 v[188:191], v[108:111], v[60:63], v[188:191]
    s_waitcnt vmcnt(2)
    v_mfma_f32_16x16x32_bf16 v[184:187], v[112:115], v[64:67], v[184:187]
    v_mfma_f32_16x16x32_bf16 v[188:191], v[116:119], v[64:67], v[188:191]
    s_waitcnt vmcnt(0)
    v_mfma_f32_16x16x32_bf16 v[184:187], v[120:123], v[68:71], v[184:187]
    v_mfma_f32_16x16x32_bf16 v[188:191], v[124:127], v[68:71], v[188:191]
    s_cmp_eq_u32 s76, 0
    s_cbranch_scc0 PK_fm_ok
    s_add_u32 s49, s12, 0
    s_mov_b32 s48, 78616576
    s_mov_b32 s54, 1048576
PK_fm:
    buffer_load_dword v2, off, s[4:7], s48 sc1
    s_mov_b32 s90, 38
    s_sub_u32 s54, s54, 1
    s_cmp_eq_u32 s54, 0
    s_cbranch_scc1 L_abort1
    s_waitcnt vmcnt(0)
    v_readfirstlane_b32 s50, v2
    s_nop 0
    s_cmp_ge_u32 s50, s49
    s_cbranch_scc1 PK_fm_ok
    s_cmp_ge_u32 s12, 56
    s_cbranch_scc1 PK_fm
    s_sleep 16
    s_branch PK_fm
PK_fm_ok:
    s_barrier
    s_mul_i32 s44, s12, 7168
    s_add_u32 s44, s44, 10649600
    s_add_u32 s45, s44, 4096
    s_mov_b32 s54, 1048576
PK_mp:
    buffer_load_dwordx4 v[128:131], v8, s[4:7], s44 offen offset:0 sc1
    buffer_load_dwordx4 v[132:135], v8, s[4:7], s44 offen offset:512 sc1
    buffer_load_dwordx4 v[136:139], v8, s[4:7], s44 offen offset:1024 sc1
    buffer_load_dwordx4 v[140:143], v8, s[4:7], s44 offen offset:1536 sc1
    buffer_load_dwordx4 v[144:147], v8, s[4:7], s44 offen offset:2048 sc1
    buffer_load_dwordx4 v[148:151], v8, s[4:7], s44 offen offset:2560 sc1
    buffer_load_dwordx4 v[152:155], v8, s[4:7], s44 offen offset:3072 sc1
    buffer_load_dwordx4 v[156:159], v8, s[4:7], s44 offen offset:3584 sc1
    buffer_load_dwordx4 v[160:163], v8, s[4:7], s45 offen offset:0 sc1
    buffer_load_dwordx4 v[164:167], v8, s[4:7], s45 offen offset:512 sc1
    buffer_load_dwordx4 v[168:171], v8, s[4:7], s45 offen offset:1024 sc1
    buffer_load_dwordx4 v[172:175], v8, s[4:7], s45 offen offset:1536 sc1
    buffer_load_dwordx4 v[176:179], v8, s[4:7], s45 offen offset:2048 sc1
    buffer_load_dwordx4 v[180:183], v8, s[4:7], s45 offen offset:2560 sc1
    s_mov_b32 s90, 39
    s_sub_u32 s54, s54, 1
    s_cmp_eq_u32 s54, 0
    s_cbranch_scc1 L_abort1
    s_waitcnt vmcnt(13)
    v_mfma_f32_16x16x32_bf16 v[192:195], v[128:131], v[16:19], 0
    v_max3_u32 v9, v128, v129, v130
    v_max_u32 v9, v9, v131
    s_waitcnt vmcnt(12)
    v_mfma_f32_16x16x32_bf16 v[192:195], v[132:135], v[20:23], v[192:195]
    v_max3_u32 v9, v9, v132, v133
    v_max3_u32 v9, v9, v134, v135
    s_waitcnt vmcnt(11)
    v_mfma_f32_16x16x32_bf16 v[192:195], v[136:139], v[24:27], v[192:195]
    v_max3_u32 v9, v9, v136, v137
    v_max3_u32 v9, v9, v138, v139
    s_waitcnt vmcnt(10)
    v_mfma_f32_16x16x32_bf16 v[192:195], v[140:143], v[28:31], v[192:195]
    v_max3_u32 v9, v9, v140, v141
    v_max3_u32 v9, v9, v142, v143
    s_waitcnt vmcnt(9)
    v_mfma_f32_16x16x32_bf16 v[192:195], v[144:147], v[32:35], v[192:195]
    v_max3_u32 v9, v9, v144, v145
    v_max3_u32 v9, v9, v146, v147
    s_waitcnt vmcnt(8)
    v_mfma_f32_16x16x32_bf16 v[192:195], v[148:151], v[36:39], v[192:195]
    v_max3_u32 v9, v9, v148, v149
    v_max3_u32 v9, v9, v150, v151
    s_waitcnt vmcnt(7)
    v_mfma_f32_16x16x32_bf16 v[192:195], v[152:155], v[40:43], v[192:195]
    v_max3_u32 v9, v9, v152, v153
    v_max3_u32 v9, v9, v154, v155
    s_waitcnt vmcnt(6)
    v_mfma_f32_16x16x32_bf16 v[192:195], v[156:159], v[44:47], v[192:195]
    v_max3_u32 v9, v9, v156, v157
    v_max3_u32 v9, v9, v158, v159
    s_waitcnt vmcnt(5)
    v_mfma_f32_16x16x32_bf16 v[192:195], v[160:163], v[48:51], v[192:195]
    v_max3_u32 v9, v9, v160, v161
    v_max3_u32 v9, v9, v162, v163
    s_waitcnt vmcnt(4)
    v_mfma_f32_16x16x32_bf16 v[192:195], v[164:167], v[52:55], v[192:195]
    v_max3_u32 v9, v9, v164, v165
    v_max3_u32 v9, v9, v166, v167
    s_waitcnt vmcnt(3)
    v_mfma_f32_16x16x32_bf16 v[192:195], v[168:171], v[56:59], v[192:195]
    v_max3_u32 v9, v9, v168, v169
    v_max3_u32 v9, v9, v170, v171
    s_waitcnt vmcnt(2)
    v_mfma_f32_16x16x32_bf16 v[192:195], v[172:175], v[60:63], v[192:195]
    v_max3_u32 v9, v9, v172, v173
    v_max3_u32 v9, v9, v174, v175
    s_waitcnt vmcnt(1)
    v_mfma_f32_16x16x32_bf16 v[192:195], v[176:179], v[64:67], v[192:195]
    v_max3_u32 v9, v9, v176, v177
    v_max3_u32 v9, v9, v178, v179
    s_waitcnt vmcnt(0)
    v_mfma_f32_16x16x32_bf16 v[192:195], v[180:183], v[68:71], v[192:195]
    v_max3_u32 v9, v9, v180, v181
    v_max3_u32 v9, v9, v182, v183
    v_cmp_eq_u32 vcc, -1, v9
    s_cbranch_vccz PK_mok
    s_sleep 1
    s_branch PK_mp
PK_mok:
    v_bfe_u32 v10, v0, 1, 1
    v_lshlrev_b32 v10, 3, v10
    v_bfe_u32 v11, v0, 2, 2
    v_lshl_add_u32 v10, v11, 1, v10
    v_and_b32 v11, 1, v0
    v_add_u32 v10, v10, v11
    v_lshlrev_b32 v10, 1, v10
    v_add_u32 v10, s30, v10
    v_lshrrev_b32 v11, 4, v0
    v_lshlrev_b32 v11, 2, v11
    v_mov_b32 v12, 0xf149f2ca
    v_add_u32 v13, 0, v11
    v_cmp_le_u32 vcc, v13, v10
    s_nop 1
    v_cndmask_b32 v184, v12, v184, vcc
    v_cmp_lt_u32 vcc, v13, v10
    s_nop 1
    v_cndmask_b32 v188, v12, v188, vcc
    v_add_u32 v13, 2, v11
    v_cmp_le_u32 vcc, v13, v10
    s_nop 1
    v_cndmask_b32 v185, v12, v185, vcc
    v_cmp_lt_u32 vcc, v13, v10
    s_nop 1
    v_cndmask_b32 v189, v12, v189, vcc
    v_add_u32 v13, 16, v11
    v_cmp_le_u32 vcc, v13, v10
    s_nop 1
    v_cndmask_b32 v186, v12, v186, vcc
    v_cmp_lt_u32 vcc, v13, v10
    s_nop 1
    v_cndmask_b32 v190, v12, v190, vcc
    v_add_u32 v13, 18, v11
    v_cmp_le_u32 vcc, v13, v10
    s_nop 1
    v_cndmask_b32 v187, v12, v187, vcc
    v_cmp_lt_u32 vcc, v13, v10
    s_nop 1
    v_cndmask_b32 v191, v12, v191, vcc
    v_max3_f32 v13, v184, v185, v186
    v_max3_f32 v14, v187, v188, v189
    v_max3_f32 v13, v13, v190, v191
    v_max3_f32 v14, v14, v192, v193
    v_max_f32 v13, v13, v14
    v_mov_b32 v14, v13
    s_nop 1
    v_permlane32_swap_b32 v13, v14
    v_max_f32 v13, v13, v14
    v_mov_b32 v14, v13
    s_nop 1
    v_permlane16_swap_b32 v13, v14
    v_max_f32 v13, v13, v14
    v_sub_f32 v184, v184, v13
    v_sub_f32 v185, v185, v13
    v_sub_f32 v186, v186, v13
    v_sub_f32 v187, v187, v13
    v_sub_f32 v188, v188, v13
    v_sub_f32 v189, v189, v13
    v_sub_f32 v190, v190, v13
    v_sub_f32 v191, v191, v13
    v_sub_f32 v192, v192, v13
    v_sub_f32 v193, v193, v13
    v_exp_f32 v184, v184
    v_exp_f32 v185, v185
    v_exp_f32 v186, v186
    v_exp_f32 v187, v187
    v_exp_f32 v188, v188
    v_exp_f32 v189, v189
    v_exp_f32 v190, v190
    v_exp_f32 v191, v191
    v_exp_f32 v192, v192
    v_exp_f32 v193, v193
    v_add_f32 v13, v184, v185
    v_add_f32 v13, v13, v186
    v_add_f32 v13, v13, v187
    v_add_f32 v13, v13, v188
    v_add_f32 v13, v13, v189
    v_add_f32 v13, v13, v190
    v_add_f32 v13, v13, v191
    v_add_f32 v13, v13, v192
    v_add_f32 v13, v13, v193
    v_mov_b32 v14, v13
    s_nop 1
    v_permlane32_swap_b32 v13, v14
    v_add_f32 v13, v13, v14
    v_mov_b32 v14, v13
    s_nop 1
    v_permlane16_swap_b32 v13, v14
    v_add_f32 v13, v13, v14
    v_rcp_f32 v13, v13
    s_nop 0
    v_mul_f32 v184, v184, v13
    v_mul_f32 v185, v185, v13
    v_mul_f32 v186, v186, v13
    v_mul_f32 v187, v187, v13
    v_mul_f32 v188, v188, v13
    v_mul_f32 v189, v189, v13
    v_mul_f32 v190, v190, v13
    v_mul_f32 v191, v191, v13
    v_mul_f32 v192, v192, v13
    v_mul_f32 v193, v193, v13
    s_lshl_b32 s34, s12, 3
    s_add_u32 s34, s34, s13
    s_lshl_b32 s34, s34, 1
    s_add_u32 s34, s34, s30
    s_lshl_b32 s34, s34, 11
    s_add_u32 s34, s34, 75862016
    s_lshl_b32 s35, s29, 2
    v_add_u32 v13, s35, v7
    v_cvt_pk_bf16_f32 v14, |v184|, |v188|
    buffer_store_dword v14, v13, s[4:7], s34 offen offset:0 sc1
    s_nop 0
    v_cvt_pk_bf16_f32 v14, |v185|, |v189|
    buffer_store_dword v14, v13, s[4:7], s34 offen offset:8 sc1
    s_nop 0
    v_cvt_pk_bf16_f32 v14, |v186|, |v190|
    buffer_store_dword v14, v13, s[4:7], s34 offen offset:1024 sc1
    s_nop 0
    v_cvt_pk_bf16_f32 v14, |v187|, |v191|
    buffer_store_dword v14, v13, s[4:7], s34 offen offset:1032 sc1
    s_nop 0
    s_lshl_b32 s34, s12, 2
    s_lshr_b32 s35, s31, 2
    s_add_u32 s34, s34, s35
    s_lshl_b32 s34, s34, 1
    s_add_u32 s34, s34, s30
    s_lshl_b32 s34, s34, 10
    s_add_u32 s34, s34, 77959168
    s_and_b32 s35, s31, 3
    s_lshl_b32 s35, s35, 2
    v_add_u32 v13, s35, v7
    v_cvt_pk_bf16_f32 v15, |v192|, |v193|
    buffer_store_dword v15, v13, s[4:7], s34 offen sc1
    s_add_u32 s12, s12, 14
    s_cmp_lt_u32 s12, 64
    s_cbranch_scc1 PK_loop
    s_branch K_next
C_ok:
    s_sub_u32 s48, s64, 112
    s_mov_b32 s49, 613566757
    s_mul_hi_u32 s12, s48, s49
    s_mul_i32 s13, s12, 7
    s_sub_u32 s13, s48, s13
OK_loop:
    s_cmp_eq_u32 s76, 0
    s_cbranch_scc0 OK_cnt_ok
    s_mov_b32 s48, 78618752
    s_mov_b32 s54, 1048576
OK_cnt:
    buffer_load_dword v2, off, s[4:7], s48 sc1
    s_mov_b32 s90, 40
    s_sub_u32 s54, s54, 1
    s_cmp_eq_u32 s54, 0
    s_cbranch_scc1 L_abort1
    s_waitcnt vmcnt(0)
    v_readfirstlane_b32 s49, v2
    s_nop 0
    s_cmp_gt_u32 s49, s12
    s_cbranch_scc1 OK_cnt_ok
    s_cmp_ge_u32 s12, 56
    s_cbranch_scc1 OK_cnt
    s_sleep 16
    s_branch OK_cnt
OK_cnt_ok:
    s_barrier
    v_accvgpr_read_b32 v0, a255
    s_mov_b32 s28, s76
    v_and_b32 v0, 63, v0
    s_lshl_b32 s29, s13, 2
    s_add_u32 s29, s29, s28
    v_lshlrev_b32 v7, 4, v0
    s_lshr_b32 s30, s29, 1
    s_lshl_b32 s30, s30, 15
    s_and_b32 s31, s29, 1
    s_lshl_b32 s31, s31, 11
    s_add_u32 s30, s30, s31
    s_mul_i32 s31, s12, 458752
    s_add_u32 s30, s30, s31
    s_add_u32 s30, s30, 11112448
    s_add_u32 s32, s30, 0
    buffer_load_dwordx4 v[16:19], v7, s[4:7], s32 offen offset:0 sc1
    buffer_load_dwordx4 v[20:23], v7, s[4:7], s32 offen offset:1024 sc1
    s_add_u32 s32, s30, 4096
    buffer_load_dwordx4 v[24:27], v7, s[4:7], s32 offen offset:0 sc1
    buffer_load_dwordx4 v[28:31], v7, s[4:7], s32 offen offset:1024 sc1
    s_add_u32 s32, s30, 8192
    buffer_load_dwordx4 v[32:35], v7, s[4:7], s32 offen offset:0 sc1
    buffer_load_dwordx4 v[36:39], v7, s[4:7], s32 offen offset:1024 sc1
    s_add_u32 s32, s30, 12288
    buffer_load_dwordx4 v[40:43], v7, s[4:7], s32 offen offset:0 sc1
    buffer_load_dwordx4 v[44:47], v7, s[4:7], s32 offen offset:1024 sc1
    s_add_u32 s32, s30, 16384
    buffer_load_dwordx4 v[48:51], v7, s[4:7], s32 offen offset:0 sc1
    buffer_load_dwordx4 v[52:55], v7, s[4:7], s32 offen offset:1024 sc1
    s_add_u32 s32, s30, 20480
    buffer_load_dwordx4 v[56:59], v7, s[4:7], s32 offen offset:0 sc1
    buffer_load_dwordx4 v[60:63], v7, s[4:7], s32 offen offset:1024 sc1
    s_add_u32 s32, s30, 24576
    buffer_load_dwordx4 v[64:67], v7, s[4:7], s32 offen offset:0 sc1
    buffer_load_dwordx4 v[68:71], v7, s[4:7], s32 offen offset:1024 sc1
    s_add_u32 s32, s30, 28672
    buffer_load_dwordx4 v[72:75], v7, s[4:7], s32 offen offset:0 sc1
    buffer_load_dwordx4 v[76:79], v7, s[4:7], s32 offen offset:1024 sc1
    v_bfe_u32 v10, v0, 1, 1
    v_lshlrev_b32 v10, 3, v10
    v_bfe_u32 v11, v0, 2, 2
    v_lshl_add_u32 v10, v11, 1, v10
    v_and_b32 v11, 1, v0
    v_add_u32 v10, v10, v11
    v_lshlrev_b32 v10, 1, v10
    s_lshl_b32 s31, s12, 5
    v_add_u32 v10, s31, v10
    v_mul_u32_u24 v10, 896, v10
    v_lshrrev_b32 v11, 4, v0
    v_lshl_add_u32 v10, v11, 3, v10
    s_lshl_b32 s31, s29, 5
    v_add_u32 v10, s31, v10
    s_mov_b32 s31, 74027008
    buffer_load_dwordx2 v[8:9], v10, s[4:7], s31 offen sc1
    buffer_load_dwordx2 v[12:13], v10, s[4:7], s31 offen offset:896 sc1
    s_cmp_eq_u32 s76, 0
    s_cbranch_scc0 OK_f1_ok
    s_add_u32 s49, s12, 1
    s_mov_b32 s48, 78616576
    s_mov_b32 s54, 1048576
OK_f1:
    buffer_load_dword v2, off, s[4:7], s48 sc1
    s_mov_b32 s90, 41
    s_sub_u32 s54, s54, 1
    s_cmp_eq_u32 s54, 0
    s_cbranch_scc1 L_abort1
    s_waitcnt vmcnt(0)
    v_readfirstlane_b32 s50, v2
    s_nop 0
    s_cmp_ge_u32 s50, s49
    s_cbranch_scc1 OK_f1_ok
    s_cmp_ge_u32 s12, 56
    s_cbranch_scc1 OK_f1
    s_sleep 16
    s_branch OK_f1
OK_f1_ok:
    s_barrier
    s_cmp_eq_u32 s76, 0
    s_cbranch_scc0 OK_fp_ok
    v_accvgpr_read_b32 v2, a255
    v_and_b32 v2, 63, v2
    v_lshlrev_b32 v4, 4, v2
    s_lshl_b32 s48, s12, 13
    s_add_u32 s48, s48, 77959168
    s_add_u32 s49, s48, 4096
    s_mov_b32 s54, 1048576
OK_fp:
    buffer_load_dwordx4 v[96:99], v4, s[4:7], s48 offen offset:0 sc1
    buffer_load_dwordx4 v[100:103], v4, s[4:7], s48 offen offset:1024 sc1
    buffer_load_dwordx4 v[104:107], v4, s[4:7], s48 offen offset:2048 sc1
    buffer_load_dwordx4 v[108:111], v4, s[4:7], s48 offen offset:3072 sc1
    buffer_load_dwordx4 v[112:115], v4, s[4:7], s49 offen offset:0 sc1
    buffer_load_dwordx4 v[116:119], v4, s[4:7], s49 offen offset:1024 sc1
    buffer_load_dwordx4 v[120:123], v4, s[4:7], s49 offen offset:2048 sc1
    buffer_load_dwordx4 v[124:127], v4, s[4:7], s49 offen offset:3072 sc1
    s_mov_b32 s90, 42
    s_sub_u32 s54, s54, 1
    s_cmp_eq_u32 s54, 0
    s_cbranch_scc1 L_abort1
    s_waitcnt vmcnt(0)
    v_or3_b32 v2, v96, v97, v98
    v_or3_b32 v2, v2, v99, v100
    v_or3_b32 v2, v2, v101, v102
    v_or3_b32 v2, v2, v103, v104
    v_or3_b32 v2, v2, v105, v106
    v_or3_b32 v2, v2, v107, v108
    v_or3_b32 v2, v2, v109, v110
    v_or3_b32 v2, v2, v111, v112
    v_or3_b32 v2, v2, v113, v114
    v_or3_b32 v2, v2, v115, v116
    v_or3_b32 v2, v2, v117, v118
    v_or3_b32 v2, v2, v119, v120
    v_or3_b32 v2, v2, v121, v122
    v_or3_b32 v2, v2, v123, v124
    v_or3_b32 v2, v2, v125, v126
    v_or_b32 v2, v2, v127
    v_and_b32 v2, 0x80008000, v2
    v_cmp_ne_u32 vcc, 0, v2
    s_cbranch_vccz OK_fp_ok
    s_cmp_ge_u32 s12, 56
    s_cbranch_scc1 OK_fp
    s_sleep 2
    s_branch OK_fp
OK_fp_ok:
    s_barrier
    s_cmp_eq_u32 s76, 0
    s_cbranch_scc0 OK_fy_ok
    s_add_u32 s49, s12, 2
    s_mov_b32 s48, 78616576
    s_mov_b32 s54, 1048576
OK_fy:
    buffer_load_dword v2, off, s[4:7], s48 sc1
    s_mov_b32 s90, 43
    s_sub_u32 s54, s54, 1
    s_cmp_eq_u32 s54, 0
    s_cbranch_scc1 L_abort1
    s_waitcnt vmcnt(0)
    v_readfirstlane_b32 s50, v2
    s_nop 0
    s_cmp_ge_u32 s50, s49
    s_cbranch_scc1 OK_fy_ok
    s_cmp_ge_u32 s12, 56
    s_cbranch_scc1 OK_fy
    s_sleep 16
    s_branch OK_fy
OK_fy_ok:
    s_barrier
    s_lshr_b32 s30, s29, 1
    s_lshl_b32 s30, s30, 13
    s_and_b32 s31, s29, 1
    s_lshl_b32 s31, s31, 10
    s_add_u32 s30, s30, s31
    s_mul_i32 s31, s12, 114688
    s_add_u32 s30, s30, s31
    s_add_u32 s30, s30, 3309568
    s_add_u32 s32, s30, 0
    buffer_load_dwordx4 v[80:83], v7, s[4:7], s32 offen sc1
    s_add_u32 s32, s30, 2048
    buffer_load_dwordx4 v[84:87], v7, s[4:7], s32 offen sc1
    s_add_u32 s32, s30, 4096
    buffer_load_dwordx4 v[88:91], v7, s[4:7], s32 offen sc1
    s_add_u32 s32, s30, 6144
    buffer_load_dwordx4 v[92:95], v7, s[4:7], s32 offen sc1
    v_mov_b32 v14, v7
    v_mov_b32 v15, v10
    s_mov_b32 s54, 1048576
OK_pp:
    s_lshl_b32 s30, s12, 15
    s_add_u32 s30, s30, 75862016
    s_lshl_b32 s33, s12, 13
    s_add_u32 s33, s33, 77959168
    s_add_u32 s32, s30, 0
    buffer_load_dwordx4 v[96:99], v14, s[4:7], s32 offen offset:0 sc1
    buffer_load_dwordx4 v[100:103], v14, s[4:7], s32 offen offset:1024 sc1
    s_add_u32 s32, s30, 2048
    buffer_load_dwordx4 v[176:179], v14, s[4:7], s32 offen offset:0 sc1
    buffer_load_dwordx4 v[180:183], v14, s[4:7], s32 offen offset:1024 sc1
    s_add_u32 s32, s30, 4096
    buffer_load_dwordx4 v[104:107], v14, s[4:7], s32 offen offset:0 sc1
    buffer_load_dwordx4 v[108:111], v14, s[4:7], s32 offen offset:1024 sc1
    s_add_u32 s32, s30, 6144
    buffer_load_dwordx4 v[184:187], v14, s[4:7], s32 offen offset:0 sc1
    buffer_load_dwordx4 v[188:191], v14, s[4:7], s32 offen offset:1024 sc1
    s_add_u32 s32, s30, 8192
    buffer_load_dwordx4 v[112:115], v14, s[4:7], s32 offen offset:0 sc1
    buffer_load_dwordx4 v[116:119], v14, s[4:7], s32 offen offset:1024 sc1
    s_add_u32 s32, s30, 10240
    buffer_load_dwordx4 v[192:195], v14, s[4:7], s32 offen offset:0 sc1
    buffer_load_dwordx4 v[196:199], v14, s[4:7], s32 offen offset:1024 sc1
    s_add_u32 s32, s30, 12288
    buffer_load_dwordx4 v[120:123], v14, s[4:7], s32 offen offset:0 sc1
    buffer_load_dwordx4 v[124:127], v14, s[4:7], s32 offen offset:1024 sc1
    s_add_u32 s32, s30, 14336
    buffer_load_dwordx4 v[200:203], v14, s[4:7], s32 offen offset:0 sc1
    buffer_load_dwordx4 v[204:207], v14, s[4:7], s32 offen offset:1024 sc1
    s_add_u32 s32, s30, 16384
    buffer_load_dwordx4 v[128:131], v14, s[4:7], s32 offen offset:0 sc1
    buffer_load_dwordx4 v[132:135], v14, s[4:7], s32 offen offset:1024 sc1
    s_add_u32 s32, s30, 18432
    buffer_load_dwordx4 v[208:211], v14, s[4:7], s32 offen offset:0 sc1
    buffer_load_dwordx4 v[212:215], v14, s[4:7], s32 offen offset:1024 sc1
    s_add_u32 s32, s30, 20480
    buffer_load_dwordx4 v[136:139], v14, s[4:7], s32 offen offset:0 sc1
    buffer_load_dwordx4 v[140:143], v14, s[4:7], s32 offen offset:1024 sc1
    s_add_u32 s32, s30, 22528
    buffer_load_dwordx4 v[216:219], v14, s[4:7], s32 offen offset:0 sc1
    buffer_load_dwordx4 v[220:223], v14, s[4:7], s32 offen offset:1024 sc1
    s_add_u32 s32, s30, 24576
    buffer_load_dwordx4 v[144:147], v14, s[4:7], s32 offen offset:0 sc1
    buffer_load_dwordx4 v[148:151], v14, s[4:7], s32 offen offset:1024 sc1
    s_add_u32 s32, s30, 26624
    buffer_load_dwordx4 v[224:227], v14, s[4:7], s32 offen offset:0 sc1
    buffer_load_dwordx4 v[228:231], v14, s[4:7], s32 offen offset:1024 sc1
    s_add_u32 s32, s30, 28672
    buffer_load_dwordx4 v[152:155], v14, s[4:7], s32 offen offset:0 sc1
    buffer_load_dwordx4 v[156:159], v14, s[4:7], s32 offen offset:1024 sc1
    s_add_u32 s32, s30, 30720
    buffer_load_dwordx4 v[232:235], v14, s[4:7], s32 offen offset:0 sc1
    buffer_load_dwordx4 v[236:239], v14, s[4:7], s32 offen offset:1024 sc1
    s_add_u32 s32, s33, 0
    buffer_load_dwordx4 v[160:163], v14, s[4:7], s32 offen sc1
    s_add_u32 s32, s33, 1024
    buffer_load_dwordx4 v[240:243], v14, s[4:7], s32 offen sc1
    s_add_u32 s32, s33, 2048
    buffer_load_dwordx4 v[164:167], v14, s[4:7], s32 offen sc1
    s_add_u32 s32, s33, 3072
    buffer_load_dwordx4 v[244:247], v14, s[4:7], s32 offen sc1
    s_add_u32 s32, s33, 4096
    buffer_load_dwordx4 v[168:171], v14, s[4:7], s32 offen sc1
    s_add_u32 s32, s33, 5120
    buffer_load_dwordx4 v[248:251], v14, s[4:7], s32 offen sc1
    s_add_u32 s32, s33, 6144
    buffer_load_dwordx4 v[172:175], v14, s[4:7], s32 offen sc1
    s_add_u32 s32, s33, 7168
    buffer_load_dwordx4 v[252:255], v14, s[4:7], s32 offen sc1
    s_mov_b32 s90, 44
    s_sub_u32 s54, s54, 1
    s_cmp_eq_u32 s54, 0
    s_cbranch_scc1 L_abort1
    s_waitcnt vmcnt(8)
    v_mfma_f32_16x16x32_bf16 v[0:3], v[16:19], v[96:99], 0
    v_or3_b32 v11, v96, v97, v98
    v_or_b32 v11, v11, v99
    v_mfma_f32_16x16x32_bf16 v[4:7], v[16:19], v[176:179], 0
    v_or3_b32 v11, v11, v176, v177
    v_or3_b32 v11, v11, v178, v179
    v_mfma_f32_16x16x32_bf16 v[0:3], v[20:23], v[100:103], v[0:3]
    v_or3_b32 v11, v11, v100, v101
    v_or3_b32 v11, v11, v102, v103
    v_mfma_f32_16x16x32_bf16 v[4:7], v[20:23], v[180:183], v[4:7]
    v_or3_b32 v11, v11, v180, v181
    v_or3_b32 v11, v11, v182, v183
    v_mfma_f32_16x16x32_bf16 v[0:3], v[24:27], v[104:107], v[0:3]
    v_or3_b32 v11, v11, v104, v105
    v_or3_b32 v11, v11, v106, v107
    v_mfma_f32_16x16x32_bf16 v[4:7], v[24:27], v[184:187], v[4:7]
    v_or3_b32 v11, v11, v184, v185
    v_or3_b32 v11, v11, v186, v187
    v_mfma_f32_16x16x32_bf16 v[0:3], v[28:31], v[108:111], v[0:3]
    v_or3_b32 v11, v11, v108, v109
    v_or3_b32 v11, v11, v110, v111
    v_mfma_f32_16x16x32_bf16 v[4:7], v[28:31], v[188:191], v[4:7]
    v_or3_b32 v11, v11, v188, v189
    v_or3_b32 v11, v11, v190, v191
    v_mfma_f32_16x16x32_bf16 v[0:3], v[32:35], v[112:115], v[0:3]
    v_or3_b32 v11, v11, v112, v113
    v_or3_b32 v11, v11, v114, v115
    v_mfma_f32_16x16x32_bf16 v[4:7], v[32:35], v[192:195], v[4:7]
    v_or3_b32 v11, v11, v192, v193
    v_or3_b32 v11, v11, v194, v195
    v_mfma_f32_16x16x32_bf16 v[0:3], v[36:39], v[116:119], v[0:3]
    v_or3_b32 v11, v11, v116, v117
    v_or3_b32 v11, v11, v118, v119
    v_mfma_f32_16x16x32_bf16 v[4:7], v[36:39], v[196:199], v[4:7]
    v_or3_b32 v11, v11, v196, v197
    v_or3_b32 v11, v11, v198, v199
    v_mfma_f32_16x16x32_bf16 v[0:3], v[40:43], v[120:123], v[0:3]
    v_or3_b32 v11, v11, v120, v121
    v_or3_b32 v11, v11, v122, v123
    v_mfma_f32_16x16x32_bf16 v[4:7], v[40:43], v[200:203], v[4:7]
    v_or3_b32 v11, v11, v200, v201
    v_or3_b32 v11, v11, v202, v203
    v_mfma_f32_16x16x32_bf16 v[0:3], v[44:47], v[124:127], v[0:3]
    v_or3_b32 v11, v11, v124, v125
    v_or3_b32 v11, v11, v126, v127
    v_mfma_f32_16x16x32_bf16 v[4:7], v[44:47], v[204:207], v[4:7]
    v_or3_b32 v11, v11, v204, v205
    v_or3_b32 v11, v11, v206, v207
    v_mfma_f32_16x16x32_bf16 v[0:3], v[48:51], v[128:131], v[0:3]
    v_or3_b32 v11, v11, v128, v129
    v_or3_b32 v11, v11, v130, v131
    v_mfma_f32_16x16x32_bf16 v[4:7], v[48:51], v[208:211], v[4:7]
    v_or3_b32 v11, v11, v208, v209
    v_or3_b32 v11, v11, v210, v211
    v_mfma_f32_16x16x32_bf16 v[0:3], v[52:55], v[132:135], v[0:3]
    v_or3_b32 v11, v11, v132, v133
    v_or3_b32 v11, v11, v134, v135
    v_mfma_f32_16x16x32_bf16 v[4:7], v[52:55], v[212:215], v[4:7]
    v_or3_b32 v11, v11, v212, v213
    v_or3_b32 v11, v11, v214, v215
    v_mfma_f32_16x16x32_bf16 v[0:3], v[56:59], v[136:139], v[0:3]
    v_or3_b32 v11, v11, v136, v137
    v_or3_b32 v11, v11, v138, v139
    v_mfma_f32_16x16x32_bf16 v[4:7], v[56:59], v[216:219], v[4:7]
    v_or3_b32 v11, v11, v216, v217
    v_or3_b32 v11, v11, v218, v219
    v_mfma_f32_16x16x32_bf16 v[0:3], v[60:63], v[140:143], v[0:3]
    v_or3_b32 v11, v11, v140, v141
    v_or3_b32 v11, v11, v142, v143
    v_mfma_f32_16x16x32_bf16 v[4:7], v[60:63], v[220:223], v[4:7]
    v_or3_b32 v11, v11, v220, v221
    v_or3_b32 v11, v11, v222, v223
    v_mfma_f32_16x16x32_bf16 v[0:3], v[64:67], v[144:147], v[0:3]
    v_or3_b32 v11, v11, v144, v145
    v_or3_b32 v11, v11, v146, v147
    v_mfma_f32_16x16x32_bf16 v[4:7], v[64:67], v[224:227], v[4:7]
    v_or3_b32 v11, v11, v224, v225
    v_or3_b32 v11, v11, v226, v227
    v_mfma_f32_16x16x32_bf16 v[0:3], v[68:71], v[148:151], v[0:3]
    v_or3_b32 v11, v11, v148, v149
    v_or3_b32 v11, v11, v150, v151
    v_mfma_f32_16x16x32_bf16 v[4:7], v[68:71], v[228:231], v[4:7]
    v_or3_b32 v11, v11, v228, v229
    v_or3_b32 v11, v11, v230, v231
    v_mfma_f32_16x16x32_bf16 v[0:3], v[72:75], v[152:155], v[0:3]
    v_or3_b32 v11, v11, v152, v153
    v_or3_b32 v11, v11, v154, v155
    v_mfma_f32_16x16x32_bf16 v[4:7], v[72:75], v[232:235], v[4:7]
    v_or3_b32 v11, v11, v232, v233
    v_or3_b32 v11, v11, v234, v235
    v_mfma_f32_16x16x32_bf16 v[0:3], v[76:79], v[156:159], v[0:3]
    v_or3_b32 v11, v11, v156, v157
    v_or3_b32 v11, v11, v158, v159
    v_mfma_f32_16x16x32_bf16 v[4:7], v[76:79], v[236:239], v[4:7]
    v_or3_b32 v11, v11, v236, v237
    v_or3_b32 v11, v11, v238, v239
    s_waitcnt vmcnt(0)
    v_mfma_f32_16x16x32_bf16 v[0:3], v[80:83], v[160:163], v[0:3]
    v_or3_b32 v11, v11, v160, v161
    v_or3_b32 v11, v11, v162, v163
    v_mfma_f32_16x16x32_bf16 v[4:7], v[80:83], v[240:243], v[4:7]
    v_or3_b32 v11, v11, v240, v241
    v_or3_b32 v11, v11, v242, v243
    v_mfma_f32_16x16x32_bf16 v[0:3], v[84:87], v[164:167], v[0:3]
    v_or3_b32 v11, v11, v164, v165
    v_or3_b32 v11, v11, v166, v167
    v_mfma_f32_16x16x32_bf16 v[4:7], v[84:87], v[244:247], v[4:7]
    v_or3_b32 v11, v11, v244, v245
    v_or3_b32 v11, v11, v246, v247
    v_mfma_f32_16x16x32_bf16 v[0:3], v[88:91], v[168:171], v[0:3]
    v_or3_b32 v11, v11, v168, v169
    v_or3_b32 v11, v11, v170, v171
    v_mfma_f32_16x16x32_bf16 v[4:7], v[88:91], v[248:251], v[4:7]
    v_or3_b32 v11, v11, v248, v249
    v_or3_b32 v11, v11, v250, v251
    v_mfma_f32_16x16x32_bf16 v[0:3], v[92:95], v[172:175], v[0:3]
    v_or3_b32 v11, v11, v172, v173
    v_or3_b32 v11, v11, v174, v175
    v_mfma_f32_16x16x32_bf16 v[4:7], v[92:95], v[252:255], v[4:7]
    v_or3_b32 v11, v11, v252, v253
    v_or3_b32 v11, v11, v254, v255
    v_and_b32 v11, 0x80008000, v11
    v_cmp_ne_u32 vcc, 0, v11
    s_cbranch_vccz OK_pok
    s_sleep 1
    s_branch OK_pp
OK_pok:
    v_cvt_pk_bf16_f32 v16, v0, v1
    v_cvt_pk_bf16_f32 v17, v2, v3
    v_lshlrev_b32 v18, 16, v16
    v_and_b32 v19, 0xffff0000, v16
    v_lshlrev_b32 v20, 16, v8
    v_and_b32 v21, 0xffff0000, v8
    v_add_f32 v18, v18, v20
    v_add_f32 v19, v19, v21
    v_cvt_pk_bf16_f32 v16, v18, v19
    v_lshlrev_b32 v18, 16, v17
    v_and_b32 v19, 0xffff0000, v17
    v_lshlrev_b32 v20, 16, v9
    v_and_b32 v21, 0xffff0000, v9
    v_add_f32 v18, v18, v20
    v_add_f32 v19, v19, v21
    v_cvt_pk_bf16_f32 v17, v18, v19
    buffer_store_dwordx2 v[16:17], v15, s[60:63], 0 offen offset:0 sc1
    v_cvt_pk_bf16_f32 v24, v4, v5
    v_cvt_pk_bf16_f32 v25, v6, v7
    v_lshlrev_b32 v26, 16, v24
    v_and_b32 v27, 0xffff0000, v24
    v_lshlrev_b32 v28, 16, v12
    v_and_b32 v29, 0xffff0000, v12
    v_add_f32 v26, v26, v28
    v_add_f32 v27, v27, v29
    v_cvt_pk_bf16_f32 v24, v26, v27
    v_lshlrev_b32 v26, 16, v25
    v_and_b32 v27, 0xffff0000, v25
    v_lshlrev_b32 v28, 16, v13
    v_and_b32 v29, 0xffff0000, v13
    v_add_f32 v26, v26, v28
    v_add_f32 v27, v27, v29
    v_cvt_pk_bf16_f32 v25, v26, v27
    buffer_store_dwordx2 v[24:25], v15, s[60:63], 0 offen offset:896 sc1
    s_cmp_eq_u32 s65, 0
    s_cbranch_scc0 OK_nofl
    s_waitcnt vmcnt(0)
    s_barrier
    s_cmp_eq_u32 s76, 0
    s_cbranch_scc0 OK_nofl
    s_lshl_b32 s48, s12, 3
    s_add_u32 s48, s48, s13
    s_lshl_b32 s48, s48, 4
    s_add_u32 s48, s48, 78655488
    s_mov_b64 exec, 1
    v_mov_b32 v2, 1
    buffer_store_dword v2, off, s[4:7], s48 sc1
    s_mov_b64 exec, -1
OK_nofl:
    s_add_u32 s12, s12, 14
    s_cmp_lt_u32 s12, 64
    s_cbranch_scc1 OK_loop
K_next:
    s_cmp_eq_u32 s65, 0
    s_cbranch_scc1 K_more
    s_endpgm
K_more:
    s_mov_b32 s65, 1
    s_branch K_layer
L_abort1:
    s_mov_b32 s8, s70
    s_and_b32 s9, s71, 0xffff
    s_mov_b32 s10, 256
    s_mov_b32 s11, 0x20000
    s_lshl_b32 s91, s90, 24
    s_and_b32 s92, s67, 0xff
    s_lshl_b32 s92, s92, 16
    s_or_b32 s91, s91, s92
    s_cmp_eq_u32 s66, 0
    s_cselect_b32 s92, s15, s12
    s_and_b32 s92, s92, 0xff
    s_lshl_b32 s92, s92, 8
    s_or_b32 s91, s91, s92
    s_lshl_b32 s92, s65, 7
    s_or_b32 s91, s91, s92
    s_or_b32 s91, s91, s66
    s_mul_hi_u32 s92, s2, 0x924924a
    s_mul_i32 s92, s92, 28
    s_sub_u32 s92, s2, s92
    s_lshl_b32 s92, s92, 2
    s_add_u32 s92, s92, 144
    v_mov_b32 v1, s91
    v_mov_b32 v2, s92
    buffer_store_dword v1, v2, s[8:11], 0 offen
    s_waitcnt vmcnt(0)
    s_endpgm
.section .rodata,"a"
.p2align 6
.amdhsa_kernel interleave_layers__spectral_gfnet__memory_aug_recurrent_mem_tr__prompt_kernel
  .amdhsa_next_free_vgpr 512
  .amdhsa_next_free_sgpr 102
  .amdhsa_accum_offset 256
  .amdhsa_group_segment_fixed_size 0
  .amdhsa_kernarg_size 104
  .amdhsa_user_sgpr_count 2
  .amdhsa_user_sgpr_kernarg_segment_ptr 1
  .amdhsa_system_sgpr_workgroup_id_x 1
  .amdhsa_float_denorm_mode_32 3
.end_amdhsa_kernel
.text
```
